```python
import torch

def _softmax(x, axis=-1):
    return torch.softmax(x, dim=axis)
def _gelu(x):
    return torch.nn.functional.gelu(x, approximate="tanh")
def _silu(x):
    return torch.nn.functional.silu(x)
def _sigmoid(x):
    return torch.sigmoid(x)
def _layernorm(x, axis=-1, eps=1e-5):
    m = x.mean(dim=axis, keepdim=True)
    v = x.var(dim=axis, keepdim=True, unbiased=False)
    return (x - m) / torch.sqrt(v + eps)
def _scatter_add(tgt, idx, src, axis=0):
    return tgt.clone().index_add_(axis, idx, src)
def _segment_sum(src, seg, n):
    out = torch.zeros((n,) + src.shape[1:], dtype=src.dtype)
    return out.index_add_(0, seg, src)
def _pad(x, pw):
    flat = tuple(v for pair in reversed(pw) for v in pair)
    return torch.nn.functional.pad(x, flat)

kernel_name = 'recurrent_scan__gqa_block_cached__glu_gated_bilinear__prompt'

def setup_inputs():

    _w = (lambda a: (lambda t: t.to(torch.bfloat16) if t.is_floating_point() else t)(torch.as_tensor(a)))
    def _A_setup():
        B, Sq, D = 1, 2048, 640
        Hq, Hkv, Sk, Dh = 32, 32, 2048, 128
        assert Hq % Hkv == 0, (Hq, Hkv)
        return {
            "x": _w((lambda *s: torch.randn(*s, dtype=torch.bfloat16) * 0.05)(B, Sq, D)),
            "k_cache": _w((lambda *s: torch.randn(*s, dtype=torch.bfloat16) * 1.6)(B, Hkv, Sk, Dh)),
            "v_cache": _w((lambda *s: torch.randn(*s, dtype=torch.bfloat16) * 1.6)(B, Hkv, Sk, Dh)),
            "wq": _w((lambda *s: torch.randn(*s, dtype=torch.bfloat16) * 1.6)(D, Hq * Dh) * (D ** -0.5)),
            "wo": _w((lambda *s: torch.randn(*s, dtype=torch.bfloat16) * 1.6)(Hq * Dh, D) * ((Hq * Dh) ** -0.5)),
        }
    _A_in = _A_setup()

    def _B_setup():
        B, S, D, F = 1, 2048, 640, 1728
        return {
            "x": _w((lambda *s: torch.randn(*s, dtype=torch.bfloat16) * 0.05)(B, S, D)),
            "w_gate": _w((lambda *s: torch.randn(*s, dtype=torch.bfloat16) * 0.2)(D, F) * (D ** -0.5)),
            "w_up": _w((lambda *s: torch.randn(*s, dtype=torch.bfloat16) * 0.2)(D, F) * (D ** -0.5)),
            "w_down": _w((lambda *s: torch.randn(*s, dtype=torch.bfloat16) * 0.2)(F, D) * (F ** -0.5)),
        }
    _B_in = _B_setup()

    return {
        "A_x": _A_in["x"],
        "A_k_cache": _A_in["k_cache"],
        "A_v_cache": _A_in["v_cache"],
        "A_wq": _A_in["wq"],
        "A_wo": _A_in["wo"],
        "B_x": _B_in["x"],
        "B_w_gate": _B_in["w_gate"],
        "B_w_up": _B_in["w_up"],
        "B_w_down": _B_in["w_down"],
    }

def reference(A_x, A_k_cache, A_v_cache, A_wq, A_wo, B_x, B_w_gate, B_w_up, B_w_down):
    def _A_ref(x, k_cache, v_cache, wq, wo):
        B, Sq, D = x.shape
        Hq, Dh = 32, 128
        Hkv = k_cache.shape[1]
        rep = Hq // Hkv
        q = (lambda x, *d: x.permute(*d))((x @ wq).reshape(B, Sq, Hq, Dh), 0, 2, 1, 3)
        k = (lambda x, n, axis: torch.repeat_interleave(x, n, dim=axis))(k_cache, rep, axis=1)
        v = (lambda x, n, axis: torch.repeat_interleave(x, n, dim=axis))(v_cache, rep, axis=1)
        scores = torch.einsum("bhqd,bhkd->bhqk", q, k) * (Dh ** -0.5)
        p = _softmax(scores, axis=-1)
        o = torch.einsum("bhqk,bhkd->bhqd", p, v)
        return (lambda x, *d: x.permute(*d))(o, 0, 2, 1, 3).reshape(B, Sq, Hq * Dh) @ wo

    def _B_ref(x, w_gate, w_up, w_down):
        g = torch.einsum("bsd,df->bsf", x, w_gate)
        u = torch.einsum("bsd,df->bsf", x, w_up)
        h = g * u
        return torch.einsum("bsf,fd->bsd", h, w_down)

    x = A_x
    xn = _layernorm(x, axis=-1)
    s = _A_ref(xn, A_k_cache, A_v_cache, A_wq, A_wo)
    g = _silu(_B_ref(xn, B_w_gate, B_w_up, B_w_down))
    return x + s * g
```

```asm
; @launch kernel=recurrent_scan__gqa_block_cached__glu_gated_bilinear__prompt_kernel grid=(256,1,1) block=(256,1,1) lds=163840
.amdgcn_target "amdgcn-amd-amdhsa--gfx950"
.text
.globl recurrent_scan__gqa_block_cached__glu_gated_bilinear__prompt_kernel
.p2align 8
.type recurrent_scan__gqa_block_cached__glu_gated_bilinear__prompt_kernel,@function
recurrent_scan__gqa_block_cached__glu_gated_bilinear__prompt_kernel:
  s_cmp_ge_u32 s2, 256
  s_cbranch_scc1 L_a_end
  s_mov_b32 s53, 0
L_a_start:
  s_load_dwordx8 s[24:31], s[0:1], 0
  s_load_dwordx8 s[40:47], s[0:1], 64
  s_load_dwordx2 s[32:33], s[0:1], 32
  s_load_dwordx4 s[36:39], s[0:1], 48
  s_memrealtime s[4:5]
  s_getpc_b64 s[6:7]
L_pc_ln:
  s_add_u32 s6, s6, L_a_start-L_pc_ln
  s_addc_u32 s7, s7, -1
  s_lshr_b32 s3, s2, 3
  s_lshl_b32 s3, s3, 11
  v_lshl_add_u32 v98, v0, 3, s3
  v_min_u32 v98, L_a_last-L_a_start, v98
  v_mov_b32 v99, s7
  v_add_co_u32 v98, vcc, s6, v98
  s_nop 1
  v_addc_co_u32 v99, vcc, 0, v99, vcc
  global_load_dword v96, v[98:99], off
  v_lshrrev_b32 v40, 5, v0
  v_mul_u32_u24 v40, 1280, v40
  v_and_b32 v12, 31, v0
  v_lshl_add_u32 v40, v12, 3, v40
  s_mul_i32 s58, s2, 10240
  s_mov_b32 s14, 2621440
  s_mov_b32 s15, 0x20000
  s_waitcnt lgkmcnt(0)
  s_mov_b32 s12, s24
  s_mov_b32 s13, s25
  buffer_load_dwordx2 v[48:49], v40, s[12:15], s58 offen offset:0
  buffer_load_dwordx2 v[50:51], v40, s[12:15], s58 offen offset:256
  buffer_load_dwordx2 v[52:53], v40, s[12:15], s58 offen offset:512
  buffer_load_dwordx2 v[54:55], v40, s[12:15], s58 offen offset:768
  buffer_load_dwordx2 v[56:57], v40, s[12:15], s58 offen offset:1024
  v_lshrrev_b32 v1, 6, v0
  s_bfe_u32 s96, s2, 0x20001
  v_readfirstlane_b32 s54, v1
  s_bfe_u32 s98, s2, 0x20003
  s_and_b32 s60, s2, 1
  s_lshl2_add_u32 s58, s60, s98
  s_lshl3_add_u32 s55, s96, s58
  s_sub_u32 s35, s55, s96
  s_cmp_lt_u32 s58, 7
  s_cselect_b32 s35, s35, 31
  s_lshr_b32 s59, s2, 5
  s_lshl1_add_u32 s97, s59, s60
  s_lshr_b32 s60, s2, 6
  s_lshl_b32 s56, s59, 2
  s_add_u32 s56, s56, s54
  s_add_u32 s62, s98, s59
  s_and_b32 s62, s62, 3
  s_lshl_b32 s62, s62, 3
  s_or_b32 s62, s62, 0x80000
  s_mul_i32 s63, s56, 81920
  s_mul_i32 s51, s54, 4224
  v_and_b32 v1, 63, v0
  v_lshlrev_b32 v1, 4, v1
  v_add_u32 v124, 4096, v1
  v_bfe_u32 v12, v0, 5, 1
  v_bfe_u32 v13, v0, 4, 1
  v_lshlrev_b32 v12, 5, v12
  v_lshl_add_u32 v12, v13, 2, v12
  s_lshl_b32 s58, s54, 3
  v_add_u32 v12, s58, v12
  v_lshlrev_b32 v12, 13, v12
  v_and_b32 v13, 15, v0
  v_lshl_add_u32 v12, v13, 4, v12
  s_lshl_b32 s58, s55, 8
  v_add_u32 v32, s58, v12
  v_add_u32 v33, 8192, v32
  v_add_u32 v34, 16384, v32
  v_add_u32 v35, 24576, v32
  v_bfe_u32 v12, v0, 4, 1
  v_bfe_u32 v13, v0, 3, 1
  v_bfe_u32 v14, v0, 5, 1
  v_lshlrev_b32 v12, 5, v12
  v_lshl_add_u32 v12, v13, 2, v12
  v_lshl_add_u32 v12, v14, 4, v12
  v_bfe_u32 v13, v0, 6, 1
  v_lshl_add_u32 v12, v13, 3, v12
  v_mul_u32_u24 v12, 3456, v12
  v_and_b32 v13, 7, v0
  v_lshl_add_u32 v12, v13, 4, v12
  s_lshl_b32 s58, s35, 7
  s_cmp_lt_u32 s35, 27
  s_cselect_b32 s58, s58, 0x40000000
  v_add_u32 v36, s58, v12
  v_add_u32 v37, 3456, v36
  v_add_u32 v38, 6912, v36
  v_add_u32 v39, 10368, v36
  s_lshl1_add_u32 s3, s55, s54
  s_lshl_b32 s3, s3, 7
  s_mov_b32 s6, 8192
  s_cmp_lt_u32 s54, 2
  s_cselect_b32 s3, s3, s58
  s_cselect_b32 s6, s6, 3456
  s_cselect_b32 s77, 0x100000, 0
  s_lshl_b32 s80, s6, 6
  v_bfe_u32 v46, v0, 3, 3
  v_and_b32 v47, 7, v0
  v_lshl_add_u32 v46, v46, 6, v47
  v_lshl_add_u32 v46, s59, 3, v46
  v_mul_u32_u24 v46, s6, v46
  v_add_u32 v46, s3, v46
  v_mov_b32 v13, 0x7ff00000
  v_cmp_eq_u32 vcc, 0, v0
  s_nop 1
  v_cndmask_b32 v123, v13, v0, vcc
  s_mov_b32 s20, s30
  s_mov_b32 s21, s31
  s_mov_b32 s22, 0x500000
  s_mov_b32 s23, 0x20000
  s_mov_b32 s8, s46
  s_mov_b32 s9, s47
  s_mov_b32 s10, 0x4000000
  s_mov_b32 s11, 0x20000
  s_mov_b32 s16, s44
  s_mov_b32 s17, s45
  s_mov_b32 s18, 0x100
  s_mov_b32 s19, 0x20000
  s_cmp_lt_u32 s54, 2
  s_cselect_b32 s44, s36, s38
  s_cselect_b32 s45, s37, s39
  s_mov_b32 s46, 2211840
  s_mov_b32 s47, 0x20000
  s_cselect_b32 s36, s30, s36
  s_cselect_b32 s37, s31, s37
  s_cmp_eq_u32 s54, 3
  s_cselect_b32 s36, s38, s36
  s_cselect_b32 s37, s39, s37
  s_mov_b32 s38, 0
  s_mov_b32 s39, 0x20000
  s_cmp_lg_u32 s53, 0
  s_cbranch_scc1 L_a_q
  s_cmp_eq_u32 s2, 1
  s_cselect_b32 s59, 0, 0x7ff00000
  s_or_b32 s4, s4, 1
  v_mov_b32 v12, s4
  buffer_store_dword v12, v123, s[16:19], s59 offen sc1
  s_mul_i32 s65, s80, 0
  s_mul_i32 s38, s80, 4
  s_sub_u32 s38, s38, s77
  buffer_load_dword v192, v46, s[36:39], s65 offen
  v_lshrrev_b32 v12, 5, v0
  v_bfe_u32 v13, v0, 1, 4
  v_mul_u32_u24 v41, 144, v13
  v_lshl_add_u32 v41, v12, 4, v41
  v_and_b32 v13, 1, v0
  v_lshl_add_u32 v41, v13, 3, v41
  v_add_u32 v41, 152064, v41
  v_lshrrev_b32 v13, 3, v0
  v_mul_u32_u24 v42, 144, v13
  v_and_b32 v14, 7, v0
  v_lshl_add_u32 v42, v14, 4, v42
  v_add_u32 v42, 152064, v42
  v_and_b32 v13, 3, v13
  v_lshlrev_b32 v43, 12, v12
  v_lshl_add_u32 v43, v13, 8, v43
  v_lshl_add_u32 v43, v14, 4, v43
  v_min_u32 v45, 154352, v42
  v_mov_b32 v44, 0
  s_lshr_b32 s3, s2, 3
  s_mul_i32 s58, s3, 81920
  s_bfe_u32 s3, s2, 0x20001
  s_lshl_b32 s3, s3, 10
  s_add_u32 s58, s58, s3
  s_and_b32 s3, s2, 1
  s_lshl_b32 s3, s3, 7
  s_add_u32 s58, s58, s3
  s_add_u32 s59, s58, 32768
  s_add_u32 s60, s58, 65536
  s_cmp_lt_u32 s54, 2
  s_cselect_b32 s60, s60, 0x7ff00000
  s_mov_b32 s3, 0xffff0000
  s_waitcnt vmcnt(6)
  v_lshlrev_b32 v64, 16, v48
  v_and_b32 v65, s3, v48
  v_lshlrev_b32 v66, 16, v49
  v_and_b32 v67, s3, v49
  s_waitcnt vmcnt(5)
  v_lshlrev_b32 v68, 16, v50
  v_and_b32 v69, s3, v50
  v_lshlrev_b32 v70, 16, v51
  v_and_b32 v71, s3, v51
  v_pk_add_f32 v[58:59], v[64:65], v[68:69]
  v_pk_add_f32 v[60:61], v[66:67], v[70:71]
  s_waitcnt vmcnt(4)
  v_lshlrev_b32 v72, 16, v52
  v_and_b32 v73, s3, v52
  v_lshlrev_b32 v74, 16, v53
  v_and_b32 v75, s3, v53
  v_pk_add_f32 v[58:59], v[58:59], v[72:73]
  v_pk_add_f32 v[60:61], v[60:61], v[74:75]
  s_waitcnt vmcnt(3)
  v_lshlrev_b32 v76, 16, v54
  v_and_b32 v77, s3, v54
  v_lshlrev_b32 v78, 16, v55
  v_and_b32 v79, s3, v55
  v_pk_add_f32 v[58:59], v[58:59], v[76:77]
  v_pk_add_f32 v[60:61], v[60:61], v[78:79]
  s_waitcnt vmcnt(2)
  v_lshlrev_b32 v80, 16, v56
  v_and_b32 v81, s3, v56
  v_lshlrev_b32 v82, 16, v57
  v_and_b32 v83, s3, v57
  v_pk_add_f32 v[58:59], v[58:59], v[80:81]
  v_pk_add_f32 v[60:61], v[60:61], v[82:83]
  v_pk_add_f32 v[58:59], v[58:59], v[60:61]
  v_add_f32 v58, v58, v59
  s_nop 1
  v_add_f32_dpp v58, v58, v58 row_ror:8 row_mask:0xf bank_mask:0xf
  s_nop 1
  v_add_f32_dpp v58, v58, v58 row_ror:4 row_mask:0xf bank_mask:0xf
  s_nop 1
  v_add_f32_dpp v58, v58, v58 row_ror:2 row_mask:0xf bank_mask:0xf
  s_nop 1
  v_add_f32_dpp v58, v58, v58 row_ror:1 row_mask:0xf bank_mask:0xf
  v_mov_b32 v59, v58
  s_nop 1
  v_permlane16_swap_b32 v58, v59
  v_add_f32 v58, v58, v59
  v_mul_f32 v62, 0xbacccccd, v58
  v_pk_add_f32 v[64:65], v[64:65], v[62:63] op_sel_hi:[1,0]
  v_pk_add_f32 v[66:67], v[66:67], v[62:63] op_sel_hi:[1,0]
  v_pk_add_f32 v[68:69], v[68:69], v[62:63] op_sel_hi:[1,0]
  v_pk_add_f32 v[70:71], v[70:71], v[62:63] op_sel_hi:[1,0]
  v_pk_add_f32 v[72:73], v[72:73], v[62:63] op_sel_hi:[1,0]
  v_pk_add_f32 v[74:75], v[74:75], v[62:63] op_sel_hi:[1,0]
  v_pk_add_f32 v[76:77], v[76:77], v[62:63] op_sel_hi:[1,0]
  v_pk_add_f32 v[78:79], v[78:79], v[62:63] op_sel_hi:[1,0]
  v_pk_add_f32 v[80:81], v[80:81], v[62:63] op_sel_hi:[1,0]
  v_pk_add_f32 v[82:83], v[82:83], v[62:63] op_sel_hi:[1,0]
  v_pk_mul_f32 v[58:59], v[64:65], v[64:65]
  v_pk_mul_f32 v[60:61], v[66:67], v[66:67]
  v_pk_fma_f32 v[58:59], v[68:69], v[68:69], v[58:59]
  v_pk_fma_f32 v[60:61], v[70:71], v[70:71], v[60:61]
  v_pk_fma_f32 v[58:59], v[72:73], v[72:73], v[58:59]
  v_pk_fma_f32 v[60:61], v[74:75], v[74:75], v[60:61]
  v_pk_fma_f32 v[58:59], v[76:77], v[76:77], v[58:59]
  v_pk_fma_f32 v[60:61], v[78:79], v[78:79], v[60:61]
  v_pk_fma_f32 v[58:59], v[80:81], v[80:81], v[58:59]
  v_pk_fma_f32 v[60:61], v[82:83], v[82:83], v[60:61]
  v_pk_add_f32 v[58:59], v[58:59], v[60:61]
  v_add_f32 v58, v58, v59
  s_nop 1
  v_add_f32_dpp v58, v58, v58 row_ror:8 row_mask:0xf bank_mask:0xf
  s_nop 1
  v_add_f32_dpp v58, v58, v58 row_ror:4 row_mask:0xf bank_mask:0xf
  s_nop 1
  v_add_f32_dpp v58, v58, v58 row_ror:2 row_mask:0xf bank_mask:0xf
  s_nop 1
  v_add_f32_dpp v58, v58, v58 row_ror:1 row_mask:0xf bank_mask:0xf
  v_mov_b32 v59, v58
  s_nop 1
  v_permlane16_swap_b32 v58, v59
  v_add_f32 v58, v58, v59
  v_mov_b32 v62, 0x3727c5ac
  v_fmac_f32 v62, 0x3acccccd, v58
  v_rsq_f32 v62, v62
  s_nop 0
  v_mul_f32 v62, 0x3e0293ee, v62
  v_pk_mul_f32 v[64:65], v[64:65], v[62:63] op_sel_hi:[1,0]
  v_pk_mul_f32 v[66:67], v[66:67], v[62:63] op_sel_hi:[1,0]
  v_cvt_pk_bf16_f32 v48, v64, v65
  v_cvt_pk_bf16_f32 v49, v66, v67
  ds_write_b64 v41, v[48:49] offset:0
  v_pk_mul_f32 v[68:69], v[68:69], v[62:63] op_sel_hi:[1,0]
  v_pk_mul_f32 v[70:71], v[70:71], v[62:63] op_sel_hi:[1,0]
  v_cvt_pk_bf16_f32 v50, v68, v69
  v_cvt_pk_bf16_f32 v51, v70, v71
  ds_write_b64 v41, v[50:51] offset:2304
  v_pk_mul_f32 v[72:73], v[72:73], v[62:63] op_sel_hi:[1,0]
  v_pk_mul_f32 v[74:75], v[74:75], v[62:63] op_sel_hi:[1,0]
  v_cvt_pk_bf16_f32 v52, v72, v73
  v_cvt_pk_bf16_f32 v53, v74, v75
  ds_write_b64 v41, v[52:53] offset:4608
  v_pk_mul_f32 v[76:77], v[76:77], v[62:63] op_sel_hi:[1,0]
  v_pk_mul_f32 v[78:79], v[78:79], v[62:63] op_sel_hi:[1,0]
  v_cvt_pk_bf16_f32 v54, v76, v77
  v_cvt_pk_bf16_f32 v55, v78, v79
  ds_write_b64 v41, v[54:55] offset:6912
  v_pk_mul_f32 v[80:81], v[80:81], v[62:63] op_sel_hi:[1,0]
  v_pk_mul_f32 v[82:83], v[82:83], v[62:63] op_sel_hi:[1,0]
  v_cvt_pk_bf16_f32 v56, v80, v81
  v_cvt_pk_bf16_f32 v57, v82, v83
  ds_write_b64 v41, v[56:57] offset:9216
  buffer_load_dword v125, v44, s[16:19], 0 offen sc1
  s_waitcnt lgkmcnt(0)
  s_barrier
  ds_read_b128 v[84:87], v42 offset:0
  ds_read_b128 v[88:91], v42 offset:4608
  ds_read_b128 v[92:95], v45 offset:9216
  s_waitcnt lgkmcnt(2)
  buffer_store_dwordx4 v[84:87], v43, s[8:11], s58 offen sc1
  s_waitcnt lgkmcnt(1)
  buffer_store_dwordx4 v[88:91], v43, s[8:11], s59 offen sc1
  s_waitcnt lgkmcnt(0)
  buffer_store_dwordx4 v[92:95], v43, s[8:11], s60 offen sc1
  v_lshlrev_b32 v41, 7, v0
  v_cmp_gt_u32 vcc, 8, v0
  s_nop 1
  v_cndmask_b32 v41, v123, v41, vcc
  s_lshr_b32 s58, s2, 3
  s_lshl_b32 s58, s58, 6
  s_and_b32 s3, s2, 7
  s_add_u32 s58, s58, s3
  s_lshl_b32 s58, s58, 4
  s_add_u32 s58, s58, 0x320000
  s_mov_b32 s90, 0x10000
  s_waitcnt vmcnt(0)
L_a_tok:
  v_cmp_eq_u32 vcc, 0, v125
  s_sub_u32 s90, s90, 1
  s_cbranch_scc1 L_a_sig
  s_cbranch_vccz L_a_sig
  buffer_load_dword v125, v44, s[16:19], 0 offen sc1
  s_waitcnt vmcnt(0)
  s_branch L_a_tok
L_a_sig:
  s_barrier
  buffer_store_dword v125, v41, s[8:11], s58 offen sc1
L_a_q:
  s_mov_b32 s67, 0
  s_add_u32 m0, s51, 67584
  s_nop 0
  buffer_load_dwordx4 v36, s[44:47], s67 offen lds
  s_add_u32 m0, s51, 68640
  s_nop 0
  buffer_load_dwordx4 v37, s[44:47], s67 offen lds
  s_add_u32 m0, s51, 69696
  s_nop 0
  buffer_load_dwordx4 v38, s[44:47], s67 offen lds
  s_add_u32 m0, s51, 70752
  s_nop 0
  buffer_load_dwordx4 v39, s[44:47], s67 offen lds
  s_mov_b32 s67, 221184
  s_add_u32 m0, s51, 84480
  s_nop 0
  buffer_load_dwordx4 v36, s[44:47], s67 offen lds
  s_add_u32 m0, s51, 85536
  s_nop 0
  buffer_load_dwordx4 v37, s[44:47], s67 offen lds
  s_add_u32 m0, s51, 86592
  s_nop 0
  buffer_load_dwordx4 v38, s[44:47], s67 offen lds
  s_add_u32 m0, s51, 87648
  s_nop 0
  buffer_load_dwordx4 v39, s[44:47], s67 offen lds
  v_bfe_u32 v12, v0, 2, 4
  v_and_b32 v13, 3, v0
  v_mul_u32_u24 v40, 1056, v12
  v_lshl_add_u32 v40, v13, 4, v40
  v_bfe_u32 v12, v0, 2, 3
  v_mul_u32_u24 v41, 1056, v12
  v_lshl_add_u32 v41, v13, 3, v41
  v_bfe_u32 v12, v0, 5, 1
  v_lshl_add_u32 v41, v12, 9, v41
  v_add_u32 v41, 67584, v41
  s_lshl_b32 s61, s56, 10
  s_add_u32 s61, s61, 0x320000
  v_and_b32 v12, 7, v0
  v_lshlrev_b32 v12, 4, v12
  s_mov_b32 s90, 0x10000
  s_and_b32 s3, s2, 7
  s_lshl_b32 s3, s3, 7
  s_add_u32 s61, s61, s3
L_a_poll:
  buffer_load_dword v126, v12, s[8:11], s61 offen sc1
  s_waitcnt vmcnt(0)
  v_cmp_ne_u32 vcc, v125, v126
  s_sub_u32 s90, s90, 1
  s_cbranch_scc1 L_a_go
  s_cbranch_vccnz L_a_poll
L_a_go:
  s_add_u32 s64, s63, 0
  buffer_load_dwordx4 a[96:99], v1, s[8:11], s64 offen offset:3072 sc1
  buffer_load_dwordx4 a[100:103], v124, s[8:11], s64 offen offset:3072 sc1
  buffer_load_dwordx4 a[104:107], v1, s[8:11], s64 offen offset:2048 sc1
  buffer_load_dwordx4 a[108:111], v124, s[8:11], s64 offen offset:2048 sc1
  buffer_load_dwordx4 a[112:115], v1, s[8:11], s64 offen offset:1024 sc1
  buffer_load_dwordx4 a[116:119], v124, s[8:11], s64 offen offset:1024 sc1
  buffer_load_dwordx4 a[120:123], v1, s[8:11], s64 offen offset:0 sc1
  buffer_load_dwordx4 a[124:127], v124, s[8:11], s64 offen offset:0 sc1
  s_add_u32 s64, s63, 8192
  buffer_load_dwordx4 a[128:131], v1, s[8:11], s64 offen offset:0 sc1
  buffer_load_dwordx4 a[132:135], v1, s[8:11], s64 offen offset:1024 sc1
  buffer_load_dwordx4 a[136:139], v1, s[8:11], s64 offen offset:2048 sc1
  buffer_load_dwordx4 a[140:143], v1, s[8:11], s64 offen offset:3072 sc1
  buffer_load_dwordx4 a[144:147], v124, s[8:11], s64 offen offset:0 sc1
  buffer_load_dwordx4 a[148:151], v124, s[8:11], s64 offen offset:1024 sc1
  buffer_load_dwordx4 a[152:155], v124, s[8:11], s64 offen offset:2048 sc1
  buffer_load_dwordx4 a[156:159], v124, s[8:11], s64 offen offset:3072 sc1
  s_barrier
  ds_read_b64_tr_b16 a[64:65], v41 offset:0
  ds_read_b64_tr_b16 a[66:67], v41 offset:128
  ds_read_b64_tr_b16 a[68:69], v41 offset:256
  ds_read_b64_tr_b16 a[70:71], v41 offset:384
  ds_read_b64_tr_b16 a[72:73], v41 offset:8448
  ds_read_b64_tr_b16 a[74:75], v41 offset:8576
  ds_read_b64_tr_b16 a[76:77], v41 offset:8704
  ds_read_b64_tr_b16 a[78:79], v41 offset:8832
  s_waitcnt vmcnt(15)
  s_waitcnt lgkmcnt(6)
  v_mfma_f32_16x16x32_bf16 v[60:63], a[64:67], a[96:99], 0
  s_waitcnt lgkmcnt(4)
  s_waitcnt vmcnt(14)
  s_lshl_b32 s58, s54, 12
  v_add_u32 v4, s58, v1
  v_mfma_f32_16x16x32_bf16 v[60:63], a[68:71], a[100:103], v[60:63]
  s_waitcnt vmcnt(13)
  ds_read_b64_tr_b16 a[80:81], v41 offset:32
  s_mov_b32 s48, 16384
  v_mfma_f32_16x16x32_bf16 v[56:59], a[64:67], a[104:107], 0
  s_waitcnt vmcnt(12)
  s_lshl_b32 s58, s55, 19
  s_add_u32 s12, s26, s58
  s_addc_u32 s13, s27, 0
  v_mfma_f32_16x16x32_bf16 v[56:59], a[68:71], a[108:111], v[56:59]
  s_waitcnt vmcnt(11)
  ds_read_b64_tr_b16 a[82:83], v41 offset:160
  s_add_u32 s16, s28, s58
  s_addc_u32 s17, s29, 0
  v_mfma_f32_16x16x32_bf16 v[52:55], a[64:67], a[112:115], 0
  s_waitcnt vmcnt(10)
  s_mov_b32 s66, 0
  s_mov_b32 s14, 524288
  s_mov_b32 s15, 0x20000
  v_mfma_f32_16x16x32_bf16 v[52:55], a[68:71], a[116:119], v[52:55]
  s_waitcnt vmcnt(9)
  s_add_u32 m0, s51, 0
  ds_read_b64_tr_b16 a[84:85], v41 offset:288
  s_mov_b32 s18, 524288
  v_mfma_f32_16x16x32_bf16 v[48:51], a[64:67], a[120:123], 0
  s_waitcnt vmcnt(8)
  buffer_load_dwordx4 v32, s[20:23], s66 offen lds
  v_mfma_f32_16x16x32_bf16 v[48:51], a[68:71], a[124:127], v[48:51]
  s_waitcnt lgkmcnt(5)
  s_add_u32 m0, s51, 1056
  ds_read_b64_tr_b16 a[86:87], v41 offset:416
  s_mov_b32 s19, 0x20000
  v_mfma_f32_16x16x32_bf16 a[0:3], a[72:75], a[120:123], 0
  s_waitcnt lgkmcnt(4)
  buffer_load_dwordx4 v33, s[20:23], s66 offen lds
  v_mfma_f32_16x16x32_bf16 a[0:3], a[76:79], a[124:127], a[0:3]
  ds_read_b64_tr_b16 a[88:89], v41 offset:8480
  s_mov_b32 s99, 0x27
  v_mfma_f32_16x16x32_bf16 a[4:7], a[72:75], a[112:115], 0
  v_and_b32 v12, 15, v0
  v_bfe_u32 v13, v0, 4, 2
  v_mfma_f32_16x16x32_bf16 a[4:7], a[76:79], a[116:119], a[4:7]
  s_add_u32 m0, s51, 2112
  ds_read_b64_tr_b16 a[90:91], v41 offset:8608
  v_mul_u32_u24 v2, 1056, v12
  v_mfma_f32_16x16x32_bf16 a[8:11], a[72:75], a[104:107], 0
  buffer_load_dwordx4 v34, s[20:23], s66 offen lds
  v_mfma_f32_16x16x32_bf16 a[8:11], a[76:79], a[108:111], a[8:11]
  ds_read_b64_tr_b16 a[92:93], v41 offset:8736
  v_lshl_add_u32 v2, v13, 4, v2
  v_mfma_f32_16x16x32_bf16 a[12:15], a[72:75], a[96:99], 0
  v_add_u32 v2, 33792, v2
  v_bfe_u32 v12, v0, 2, 4
  v_mfma_f32_16x16x32_bf16 a[12:15], a[76:79], a[100:103], a[12:15]
  s_waitcnt lgkmcnt(5)
  s_add_u32 m0, s51, 3168
  ds_read_b64_tr_b16 a[94:95], v41 offset:8864
  v_and_b32 v13, 3, v0
  v_mfma_f32_16x16x32_bf16 v[76:79], a[80:83], a[96:99], 0
  s_waitcnt lgkmcnt(4)
  buffer_load_dwordx4 v35, s[20:23], s66 offen lds
  v_mfma_f32_16x16x32_bf16 v[76:79], a[84:87], a[100:103], v[76:79]
  ds_read_b64_tr_b16 a[64:65], v41 offset:64
  v_mul_u32_u24 v3, 1056, v12
  v_mfma_f32_16x16x32_bf16 v[72:75], a[80:83], a[104:107], 0
  s_mov_b32 s66, 524288
  v_lshl_add_u32 v3, v13, 3, v3
  v_add_u32 v3, 101376, v3
  v_mfma_f32_16x16x32_bf16 v[72:75], a[84:87], a[108:111], v[72:75]
  s_add_u32 m0, s51, 16896
  ds_read_b64_tr_b16 a[66:67], v41 offset:192
  s_add_u32 s50, s51, 33792
  v_mfma_f32_16x16x32_bf16 v[68:71], a[80:83], a[112:115], 0
  buffer_load_dwordx4 v32, s[20:23], s66 offen lds
  v_mfma_f32_16x16x32_bf16 v[68:71], a[84:87], a[116:119], v[68:71]
  ds_read_b64_tr_b16 a[68:69], v41 offset:320
  s_mov_b32 s57, 0xffff7c00
  v_mfma_f32_16x16x32_bf16 v[64:67], a[80:83], a[120:123], 0
  s_mov_b32 s52, 15
  v_mov_b32 v24, 0xff800000
  v_mfma_f32_16x16x32_bf16 v[64:67], a[84:87], a[124:127], v[64:67]
  s_waitcnt lgkmcnt(5)
  s_add_u32 m0, s51, 17952
  ds_read_b64_tr_b16 a[70:71], v41 offset:448
  v_mov_b32 v25, 0xff800000
  v_mfma_f32_16x16x32_bf16 a[16:19], a[88:91], a[120:123], 0
  s_waitcnt lgkmcnt(4)
  buffer_load_dwordx4 v33, s[20:23], s66 offen lds
  v_mfma_f32_16x16x32_bf16 a[16:19], a[92:95], a[124:127], a[16:19]
  ds_read_b64_tr_b16 a[72:73], v41 offset:8512
  v_mov_b32 v26, 0xff800000
  v_mfma_f32_16x16x32_bf16 a[20:23], a[88:91], a[112:115], 0
  v_mov_b32 v27, 0xff800000
  v_and_b32 v12, 1, v0
  v_mfma_f32_16x16x32_bf16 a[20:23], a[92:95], a[116:119], a[20:23]
  s_add_u32 m0, s51, 19008
  ds_read_b64_tr_b16 a[74:75], v41 offset:8640
  v_mul_u32_u24 v12, 0xaaaa, v12
  v_mfma_f32_16x16x32_bf16 a[24:27], a[88:91], a[104:107], 0
  buffer_load_dwordx4 v34, s[20:23], s66 offen lds
  v_mfma_f32_16x16x32_bf16 a[24:27], a[92:95], a[108:111], a[24:27]
  ds_read_b64_tr_b16 a[76:77], v41 offset:8768
  v_add_u32 v118, 0x4444, v12
  v_mfma_f32_16x16x32_bf16 a[28:31], a[88:91], a[96:99], 0
  v_and_b32 v12, 2, v0
  v_cmp_eq_u32 vcc, 0, v12
  v_mfma_f32_16x16x32_bf16 a[28:31], a[92:95], a[100:103], a[28:31]
  s_waitcnt lgkmcnt(5)
  ds_read_b64_tr_b16 a[78:79], v41 offset:8896
  v_mov_b32 v12, 0x3f803f80
  v_mfma_f32_16x16x32_bf16 v[92:95], a[64:67], a[96:99], 0
  s_waitcnt lgkmcnt(4)
  v_cndmask_b32 v28, 0, v12, vcc
  v_cndmask_b32 v29, 0, v12, vcc
  v_mfma_f32_16x16x32_bf16 v[92:95], a[68:71], a[100:103], v[92:95]
  s_add_u32 m0, s51, 20064
  ds_read_b64_tr_b16 a[80:81], v41 offset:96
  v_cndmask_b32 v30, 0, v12, vcc
  v_mfma_f32_16x16x32_bf16 v[88:91], a[64:67], a[104:107], 0
  buffer_load_dwordx4 v35, s[20:23], s66 offen lds
  v_mfma_f32_16x16x32_bf16 v[88:91], a[68:71], a[108:111], v[88:91]
  ds_read_b64_tr_b16 a[82:83], v41 offset:224
  v_cndmask_b32 v31, 0, v12, vcc
  v_mfma_f32_16x16x32_bf16 v[84:87], a[64:67], a[112:115], 0
  s_mov_b32 s67, 442368
  v_xor_b32 v20, v12, v28
  v_xor_b32 v21, v12, v29
  v_mfma_f32_16x16x32_bf16 v[84:87], a[68:71], a[116:119], v[84:87]
  s_add_u32 m0, s51, 101376
  ds_read_b64_tr_b16 a[84:85], v41 offset:352
  v_xor_b32 v22, v12, v30
  v_mfma_f32_16x16x32_bf16 v[80:83], a[64:67], a[120:123], 0
  buffer_load_dwordx4 v36, s[44:47], s67 offen lds
  v_mfma_f32_16x16x32_bf16 v[80:83], a[68:71], a[124:127], v[80:83]
  s_waitcnt lgkmcnt(5)
  ds_read_b64_tr_b16 a[86:87], v41 offset:480
  v_xor_b32 v23, v12, v31
  v_mfma_f32_16x16x32_bf16 a[32:35], a[72:75], a[120:123], 0
  s_waitcnt lgkmcnt(4)
  s_lshl_b32 s68, s54, 10
  v_add_u32 v5, s68, v1
  v_mfma_f32_16x16x32_bf16 a[32:35], a[76:79], a[124:127], a[32:35]
  s_add_u32 m0, s51, 102432
  ds_read_b64_tr_b16 a[88:89], v41 offset:8544
  v_add_u32 v6, 4096, v5
  v_mfma_f32_16x16x32_bf16 a[36:39], a[72:75], a[112:115], 0
  buffer_load_dwordx4 v37, s[44:47], s67 offen lds
  v_mfma_f32_16x16x32_bf16 a[36:39], a[76:79], a[116:119], a[36:39]
  ds_read_b64_tr_b16 a[90:91], v41 offset:8672
  v_add_u32 v7, 8192, v5
  v_mfma_f32_16x16x32_bf16 a[40:43], a[72:75], a[104:107], 0
  v_add_u32 v8, 12288, v5
  v_add_u32 v9, 16384, v5
  v_mfma_f32_16x16x32_bf16 a[40:43], a[76:79], a[108:111], a[40:43]
  ds_read_b64_tr_b16 a[92:93], v41 offset:8800
  s_sub_u32 s58, s2, 160
  s_cselect_b32 s58, s2, s58
  v_mfma_f32_16x16x32_bf16 a[44:47], a[72:75], a[96:99], 0
  s_mul_i32 s4, s58, 205
  s_lshr_b32 s4, s4, 11
  v_mfma_f32_16x16x32_bf16 a[44:47], a[76:79], a[100:103], a[44:47]
  s_waitcnt lgkmcnt(5)
  ds_read_b64_tr_b16 a[94:95], v41 offset:8928
  s_mul_i32 s59, s4, 10
  v_mfma_f32_16x16x32_bf16 v[108:111], a[80:83], a[96:99], 0
  s_waitcnt lgkmcnt(4)
  s_sub_u32 s5, s58, s59
  s_lshl_b32 s4, s4, 3
  v_mfma_f32_16x16x32_bf16 v[108:111], a[84:87], a[100:103], v[108:111]
  s_add_u32 m0, s51, 103488
  ds_read_b64_tr_b16 a[64:65], v41 offset:16896
  s_mov_b32 s73, 0x2800
  v_mfma_f32_16x16x32_bf16 v[104:107], a[80:83], a[104:107], 0
  buffer_load_dwordx4 v38, s[44:47], s67 offen lds
  v_mfma_f32_16x16x32_bf16 v[104:107], a[84:87], a[108:111], v[104:107]
  ds_read_b64_tr_b16 a[66:67], v41 offset:17024
  s_cmp_ge_u32 s2, 160
  s_cselect_b32 s73, 0x1400, s73
  v_mfma_f32_16x16x32_bf16 v[100:103], a[80:83], a[112:115], 0
  s_mov_b32 s101, 0x500000
  s_cmp_ge_u32 s2, 160
  s_cselect_b32 s101, 0x21c000, s101
  v_mfma_f32_16x16x32_bf16 v[100:103], a[84:87], a[116:119], v[100:103]
  ds_read_b64_tr_b16 a[68:69], v41 offset:17152
  s_mov_b32 s58, 0x67
  v_mfma_f32_16x16x32_bf16 v[96:99], a[80:83], a[120:123], 0
  s_cmp_ge_u32 s2, 160
  s_cselect_b32 s58, 0xcd, s58
  v_mfma_f32_16x16x32_bf16 v[96:99], a[84:87], a[124:127], v[96:99]
  s_waitcnt lgkmcnt(5)
  s_add_u32 m0, s51, 104544
  ds_read_b64_tr_b16 a[70:71], v41 offset:17280
  s_mov_b32 s59, 0xa
  v_mfma_f32_16x16x32_bf16 a[48:51], a[88:91], a[120:123], 0
  s_waitcnt lgkmcnt(4)
  buffer_load_dwordx4 v39, s[44:47], s67 offen lds
  v_mfma_f32_16x16x32_bf16 a[48:51], a[92:95], a[124:127], a[48:51]
  ds_read_b64_tr_b16 a[72:73], v41 offset:25344
  s_cmp_ge_u32 s2, 160
  s_cselect_b32 s59, 0x5, s59
  v_mfma_f32_16x16x32_bf16 a[52:55], a[88:91], a[112:115], 0
  s_mov_b32 s67, 663552
  s_mov_b32 s60, 0x140000
  s_cmp_ge_u32 s2, 160
  s_cselect_b32 s60, 0x43800, s60
  v_mfma_f32_16x16x32_bf16 a[52:55], a[92:95], a[116:119], a[52:55]
  s_add_u32 m0, s51, 118272
  ds_read_b64_tr_b16 a[74:75], v41 offset:25472
  s_mov_b32 s7, 0x2000000
  v_mfma_f32_16x16x32_bf16 a[56:59], a[88:91], a[104:107], 0
  buffer_load_dwordx4 v36, s[44:47], s67 offen lds
  v_mfma_f32_16x16x32_bf16 a[56:59], a[92:95], a[108:111], a[56:59]
  ds_read_b64_tr_b16 a[76:77], v41 offset:25600
  s_cmp_ge_u32 s2, 160
  s_cselect_b32 s7, 0x2500000, s7
  v_mfma_f32_16x16x32_bf16 a[60:63], a[88:91], a[96:99], 0
  s_waitcnt vmcnt(13)
  s_mov_b32 s6, 0x80
  s_cmp_ge_u32 s2, 160
  s_cselect_b32 s6, 0x36, s6
  v_mfma_f32_16x16x32_bf16 a[60:63], a[92:95], a[100:103], a[60:63]
  s_waitcnt lgkmcnt(5)
  s_add_u32 m0, s51, 119328
  ds_read_b64_tr_b16 a[78:79], v41 offset:25728
  s_cmp_ge_u32 s2, 160
  s_cselect_b32 s32, s40, s32
  s_cselect_b32 s33, s41, s33
  v_mfma_f32_16x16x32_bf16 v[60:63], a[64:67], a[140:143], v[60:63]
  s_waitcnt lgkmcnt(4)
  buffer_load_dwordx4 v37, s[44:47], s67 offen lds
  v_mfma_f32_16x16x32_bf16 v[60:63], a[68:71], a[156:159], v[60:63]
  ds_read_b64_tr_b16 a[80:81], v41 offset:16928
  s_sub_u32 s6, s6, s4
  s_cselect_b32 s6, 0, s6
  v_mfma_f32_16x16x32_bf16 v[56:59], a[64:67], a[136:139], v[56:59]
  s_min_u32 s75, s6, 8
  s_lshl_b32 s3, s5, 2
  v_mfma_f32_16x16x32_bf16 v[56:59], a[68:71], a[152:155], v[56:59]
  s_add_u32 m0, s51, 120384
  ds_read_b64_tr_b16 a[82:83], v41 offset:17056
  s_add_u32 s3, s3, s54
  v_mfma_f32_16x16x32_bf16 v[52:55], a[64:67], a[132:135], v[52:55]
  buffer_load_dwordx4 v38, s[44:47], s67 offen lds
  v_mfma_f32_16x16x32_bf16 v[52:55], a[68:71], a[148:151], v[52:55]
  ds_read_b64_tr_b16 a[84:85], v41 offset:17184
  s_mul_i32 s61, s3, 103
  v_mfma_f32_16x16x32_bf16 v[48:51], a[64:67], a[128:131], v[48:51]
  s_lshr_b32 s61, s61, 10
  s_mul_i32 s61, s61, 10
  v_mfma_f32_16x16x32_bf16 v[48:51], a[68:71], a[144:147], v[48:51]
  s_waitcnt lgkmcnt(5)
  s_add_u32 m0, s51, 121440
  ds_read_b64_tr_b16 a[86:87], v41 offset:17312
  s_sub_u32 s61, s3, s61
  v_mfma_f32_16x16x32_bf16 a[0:3], a[72:75], a[128:131], a[0:3]
  s_waitcnt lgkmcnt(4)
  buffer_load_dwordx4 v39, s[44:47], s67 offen lds
  v_mfma_f32_16x16x32_bf16 a[0:3], a[76:79], a[144:147], a[0:3]
  ds_read_b64_tr_b16 a[88:89], v41 offset:25376
  s_cmp_gt_u32 s61, 5
  s_cselect_b32 s6, 0xfffffc00, 0
  v_mfma_f32_16x16x32_bf16 a[4:7], a[72:75], a[132:135], a[4:7]
  s_cmp_eq_u32 s61, 5
  s_cselect_b32 s6, 4096, s6
  v_mfma_f32_16x16x32_bf16 a[4:7], a[76:79], a[148:151], a[4:7]
  s_add_u32 s64, s63, 16384
  ds_read_b64_tr_b16 a[90:91], v41 offset:25504
  s_add_u32 s7, s7, s6
  v_mfma_f32_16x16x32_bf16 a[8:11], a[72:75], a[136:139], a[8:11]
  buffer_load_dwordx4 a[160:163], v1, s[8:11], s64 offen offset:0 sc1
  v_mfma_f32_16x16x32_bf16 a[8:11], a[76:79], a[152:155], a[8:11]
  ds_read_b64_tr_b16 a[92:93], v41 offset:25632
  s_and_b32 s6, s54, 1
  v_mfma_f32_16x16x32_bf16 a[12:15], a[72:75], a[140:143], a[12:15]
  s_mul_i32 s6, s6, 24
  s_lshr_b32 s61, s61, 1
  v_mfma_f32_16x16x32_bf16 a[12:15], a[76:79], a[156:159], a[12:15]
  s_waitcnt lgkmcnt(5)
  ds_read_b64_tr_b16 a[94:95], v41 offset:25760
  s_cmp_eq_u32 s61, 2
  s_cselect_b32 s6, 0, s6
  s_cselect_b32 s78, 3, 4
  v_mfma_f32_16x16x32_bf16 v[76:79], a[80:83], a[140:143], v[76:79]
  s_waitcnt lgkmcnt(4)
  s_lshl_b32 s61, s54, 5
  s_sub_u32 s79, s61, s6
  v_mfma_f32_16x16x32_bf16 v[76:79], a[84:87], a[156:159], v[76:79]
  ds_read_b64_tr_b16 a[64:65], v41 offset:16960
  s_mul_i32 s58, s58, s3
  v_mfma_f32_16x16x32_bf16 v[72:75], a[80:83], a[136:139], v[72:75]
  buffer_load_dwordx4 a[164:167], v1, s[8:11], s64 offen offset:1024 sc1
  v_mfma_f32_16x16x32_bf16 v[72:75], a[84:87], a[152:155], v[72:75]
  ds_read_b64_tr_b16 a[66:67], v41 offset:17088
  s_lshr_b32 s58, s58, 10
  v_mfma_f32_16x16x32_bf16 v[68:71], a[80:83], a[132:135], v[68:71]
  s_mul_i32 s59, s59, s58
  s_sub_u32 s3, s3, s59
  v_mfma_f32_16x16x32_bf16 v[68:71], a[84:87], a[148:151], v[68:71]
  ds_read_b64_tr_b16 a[68:69], v41 offset:17216
  s_mul_i32 s58, s58, s60
  v_mfma_f32_16x16x32_bf16 v[64:67], a[80:83], a[128:131], v[64:67]
  buffer_load_dwordx4 a[168:171], v1, s[8:11], s64 offen offset:2048 sc1
  v_mfma_f32_16x16x32_bf16 v[64:67], a[84:87], a[144:147], v[64:67]
  s_waitcnt lgkmcnt(5)
  ds_read_b64_tr_b16 a[70:71], v41 offset:17344
  s_add_u32 s7, s7, s58
  v_mfma_f32_16x16x32_bf16 a[16:19], a[88:91], a[128:131], a[16:19]
  s_waitcnt lgkmcnt(4)
  s_lshl_b32 s3, s3, 10
  s_add_u32 s7, s7, s3
  v_mfma_f32_16x16x32_bf16 a[16:19], a[92:95], a[144:147], a[16:19]
  ds_read_b64_tr_b16 a[72:73], v41 offset:25408
  s_sub_u32 s58, s4, 0
  v_mfma_f32_16x16x32_bf16 a[20:23], a[88:91], a[132:135], a[20:23]
  buffer_load_dwordx4 a[172:175], v1, s[8:11], s64 offen offset:3072 sc1
  v_mfma_f32_16x16x32_bf16 a[20:23], a[92:95], a[148:151], a[20:23]
  ds_read_b64_tr_b16 a[74:75], v41 offset:25536
  s_mul_i32 s58, s58, s73
  v_mfma_f32_16x16x32_bf16 a[24:27], a[88:91], a[136:139], a[24:27]
  s_add_u32 s72, s7, s58
  s_mul_i32 s69, s4, 40960
  v_mfma_f32_16x16x32_bf16 a[24:27], a[92:95], a[152:155], a[24:27]
  ds_read_b64_tr_b16 a[76:77], v41 offset:25664
  s_lshl_b32 s5, s5, 7
  v_mfma_f32_16x16x32_bf16 a[28:31], a[88:91], a[140:143], a[28:31]
  buffer_load_dwordx4 a[176:179], v124, s[8:11], s64 offen offset:0 sc1
  v_mfma_f32_16x16x32_bf16 a[28:31], a[92:95], a[156:159], a[28:31]
  s_waitcnt lgkmcnt(5)
  ds_read_b64_tr_b16 a[78:79], v41 offset:25792
  s_add_u32 s69, s69, s5
  v_mfma_f32_16x16x32_bf16 v[92:95], a[64:67], a[140:143], v[92:95]
  s_waitcnt lgkmcnt(4)
  s_mov_b32 s74, 0
  s_mov_b32 s89, 135168
  v_mfma_f32_16x16x32_bf16 v[92:95], a[68:71], a[156:159], v[92:95]
  ds_read_b64_tr_b16 a[80:81], v41 offset:16992
  v_lshrrev_b32 v12, 3, v0
  v_mfma_f32_16x16x32_bf16 v[88:91], a[64:67], a[136:139], v[88:91]
  v_mul_u32_u24 v12, 1280, v12
  v_bfe_u32 v14, v0, 4, 2
  v_mfma_f32_16x16x32_bf16 v[88:91], a[68:71], a[152:155], v[88:91]
  ds_read_b64_tr_b16 a[82:83], v41 offset:17120
  v_lshlrev_b32 v14, 1, v14
  v_mfma_f32_16x16x32_bf16 v[84:87], a[64:67], a[132:135], v[84:87]
  buffer_load_dwordx4 a[180:183], v124, s[8:11], s64 offen offset:1024 sc1
  v_mfma_f32_16x16x32_bf16 v[84:87], a[68:71], a[148:151], v[84:87]
  ds_read_b64_tr_b16 a[84:85], v41 offset:17248
  v_and_b32 v15, 7, v0
  v_mfma_f32_16x16x32_bf16 v[80:83], a[64:67], a[128:131], v[80:83]
  v_xor_b32 v14, v14, v15
  v_lshl_add_u32 v117, v14, 4, v12
  v_mfma_f32_16x16x32_bf16 v[80:83], a[68:71], a[144:147], v[80:83]
  s_waitcnt lgkmcnt(5)
  ds_read_b64_tr_b16 a[86:87], v41 offset:17376
  v_and_b32 v13, 3, v0
  v_mfma_f32_16x16x32_bf16 a[32:35], a[72:75], a[128:131], a[32:35]
  s_waitcnt lgkmcnt(4)
  v_lshlrev_b32 v13, s78, v13
  v_add_u32 v13, s79, v13
  v_mfma_f32_16x16x32_bf16 a[32:35], a[76:79], a[144:147], a[32:35]
  ds_read_b64_tr_b16 a[88:89], v41 offset:25440
  v_and_b32 v12, 24, v0
  v_mfma_f32_16x16x32_bf16 a[36:39], a[72:75], a[132:135], a[36:39]
  buffer_load_dwordx4 a[184:187], v124, s[8:11], s64 offen offset:2048 sc1
  v_mfma_f32_16x16x32_bf16 a[36:39], a[76:79], a[148:151], a[36:39]
  ds_read_b64_tr_b16 a[90:91], v41 offset:25568
  v_lshlrev_b32 v12, 2, v12
  v_mfma_f32_16x16x32_bf16 a[40:43], a[72:75], a[136:139], a[40:43]
  v_xor_b32 v13, v12, v13
  v_bfe_u32 v12, v0, 2, 4
  v_mfma_f32_16x16x32_bf16 a[40:43], a[76:79], a[152:155], a[40:43]
  ds_read_b64_tr_b16 a[92:93], v41 offset:25696
  v_lshl_add_u32 v122, v12, 7, v13
  v_mfma_f32_16x16x32_bf16 a[44:47], a[72:75], a[140:143], a[44:47]
  s_waitcnt vmcnt(15)
  buffer_load_dwordx4 a[188:191], v124, s[8:11], s64 offen offset:3072 sc1
  v_mfma_f32_16x16x32_bf16 a[44:47], a[76:79], a[156:159], a[44:47]
  s_waitcnt lgkmcnt(5)
  ds_read_b64_tr_b16 a[94:95], v41 offset:25824
  s_lshl_b32 s59, s54, 3
  v_mfma_f32_16x16x32_bf16 v[108:111], a[80:83], a[140:143], v[108:111]
  s_waitcnt lgkmcnt(4)
  s_barrier
  v_mfma_f32_16x16x32_bf16 v[108:111], a[84:87], a[156:159], v[108:111]
  s_add_u32 s64, s63, 24576
  ds_read_b64_tr_b16 a[64:65], v40 offset:0
  s_or_b32 s59, s59, 0x80000
  v_mfma_f32_16x16x32_bf16 v[104:107], a[80:83], a[136:139], v[104:107]
  buffer_load_dwordx4 a[192:195], v1, s[8:11], s64 offen offset:0 sc1
  v_mfma_f32_16x16x32_bf16 v[104:107], a[84:87], a[152:155], v[104:107]
  ds_read_b64_tr_b16 a[66:67], v40 offset:256
  s_mov_b32 s60, 0x3020100
  v_mfma_f32_16x16x32_bf16 v[100:103], a[80:83], a[132:135], v[100:103]
  s_bitcmp1_b32 s96, 0
  s_cselect_b32 s60, 0x8070605, s60
  v_mfma_f32_16x16x32_bf16 v[100:103], a[84:87], a[148:151], v[100:103]
  ds_read_b64_tr_b16 a[68:69], v40 offset:512
  s_bfe_u32 s60, s60, s59
  v_mfma_f32_16x16x32_bf16 v[96:99], a[80:83], a[128:131], v[96:99]
  buffer_load_dwordx4 a[196:199], v1, s[8:11], s64 offen offset:1024 sc1
  v_mfma_f32_16x16x32_bf16 v[96:99], a[84:87], a[144:147], v[96:99]
  s_waitcnt lgkmcnt(5)
  ds_read_b64_tr_b16 a[70:71], v40 offset:768
  v_lshl_add_u32 v112, s60, 10, v1
  v_mfma_f32_16x16x32_bf16 a[48:51], a[88:91], a[128:131], a[48:51]
  s_waitcnt lgkmcnt(4)
  s_mov_b32 s60, 0xc0b0a04
  s_bitcmp1_b32 s96, 0
  s_cselect_b32 s60, 0x11100f09, s60
  v_mfma_f32_16x16x32_bf16 a[48:51], a[92:95], a[144:147], a[48:51]
  ds_read_b64_tr_b16 a[72:73], v40 offset:16896
  s_bfe_u32 s60, s60, s59
  v_mfma_f32_16x16x32_bf16 a[52:55], a[88:91], a[132:135], a[52:55]
  buffer_load_dwordx4 a[200:203], v1, s[8:11], s64 offen offset:2048 sc1
  v_mfma_f32_16x16x32_bf16 a[52:55], a[92:95], a[148:151], a[52:55]
  ds_read_b64_tr_b16 a[74:75], v40 offset:17152
  v_lshl_add_u32 v113, s60, 10, v1
  v_mfma_f32_16x16x32_bf16 a[56:59], a[88:91], a[136:139], a[56:59]
  s_mov_b32 s60, 0x6050e0d
  s_bitcmp1_b32 s96, 0
  s_cselect_b32 s60, 0x1001312, s60
  v_mfma_f32_16x16x32_bf16 a[56:59], a[92:95], a[152:155], a[56:59]
  ds_read_b64_tr_b16 a[76:77], v40 offset:17408
  s_bfe_u32 s60, s60, s59
  v_mfma_f32_16x16x32_bf16 a[60:63], a[88:91], a[140:143], a[60:63]
  buffer_load_dwordx4 a[204:207], v1, s[8:11], s64 offen offset:3072 sc1
  v_mfma_f32_16x16x32_bf16 a[60:63], a[92:95], a[156:159], a[60:63]
  s_waitcnt lgkmcnt(5)
  ds_read_b64_tr_b16 a[78:79], v40 offset:17664
  v_lshl_add_u32 v114, s60, 10, v1
  v_mfma_f32_16x16x32_bf16 v[152:155], a[64:67], a[96:99], 0
  s_waitcnt lgkmcnt(4)
  s_mov_b32 s60, 0xf090807
  s_bitcmp1_b32 s96, 0
  s_cselect_b32 s60, 0xa040302, s60
  v_mfma_f32_16x16x32_bf16 v[152:155], a[68:71], a[100:103], v[152:155]
  s_waitcnt lgkmcnt(2)
  ds_read_b64_tr_b16 a[80:81], v40 offset:8
  s_bfe_u32 s60, s60, s59
  v_mfma_f32_16x16x32_bf16 v[152:155], a[72:75], a[140:143], v[152:155]
  s_waitcnt lgkmcnt(1)
  ds_read_b64_tr_b16 a[82:83], v40 offset:264
  v_lshl_add_u32 v115, s60, 10, v1
  v_mfma_f32_16x16x32_bf16 v[152:155], a[76:79], a[156:159], v[152:155]
  ds_read_b64_tr_b16 a[84:85], v40 offset:520
  s_mov_b32 s60, 0x13121110
  v_mfma_f32_16x16x32_bf16 v[144:147], a[76:79], a[152:155], 0
  buffer_load_dwordx4 a[208:211], v124, s[8:11], s64 offen offset:0 sc1
  v_mfma_f32_16x16x32_bf16 v[144:147], a[72:75], a[136:139], v[144:147]
  ds_read_b64_tr_b16 a[86:87], v40 offset:776
  s_bitcmp1_b32 s96, 0
  s_cselect_b32 s60, 0xe0d0c0b, s60
  v_mfma_f32_16x16x32_bf16 v[144:147], a[68:71], a[108:111], v[144:147]
  ds_read_b64_tr_b16 a[88:89], v40 offset:16904
  s_bfe_u32 s60, s60, s59
  v_mfma_f32_16x16x32_bf16 v[144:147], a[64:67], a[104:107], v[144:147]
  ds_read_b64_tr_b16 a[90:91], v40 offset:17160
  v_lshl_add_u32 v116, s60, 10, v1
  v_mfma_f32_16x16x32_bf16 v[136:139], a[64:67], a[112:115], 0
  buffer_load_dwordx4 a[212:215], v124, s[8:11], s64 offen offset:1024 sc1
  v_mfma_f32_16x16x32_bf16 v[136:139], a[68:71], a[116:119], v[136:139]
  ds_read_b64_tr_b16 a[92:93], v40 offset:17416
  s_mul_i32 s58, s56, 91
  v_mfma_f32_16x16x32_bf16 v[136:139], a[72:75], a[132:135], v[136:139]
  ds_read_b64_tr_b16 a[94:95], v40 offset:17672
  s_add_u32 s58, s58, s35
  v_mfma_f32_16x16x32_bf16 v[136:139], a[76:79], a[148:151], v[136:139]
  s_lshl_b32 s58, s58, 13
  s_add_u32 s58, s58, 0x400000
  v_mfma_f32_16x16x32_bf16 v[128:131], a[76:79], a[144:147], 0
  buffer_load_dwordx4 a[216:219], v124, s[8:11], s64 offen offset:2048 sc1
  v_mfma_f32_16x16x32_bf16 v[128:131], a[72:75], a[128:131], v[128:131]
  s_cmp_lt_u32 s35, 27
  s_cselect_b32 s86, s58, 0x7ff00000
  v_mfma_f32_16x16x32_bf16 v[128:131], a[68:71], a[124:127], v[128:131]
  s_lshl_b32 s58, s98, 2
  s_add_u32 s58, s58, s96
  v_mfma_f32_16x16x32_bf16 v[128:131], a[64:67], a[120:123], v[128:131]
  s_waitcnt lgkmcnt(6)
  s_mul_i32 s58, s58, 327680
  s_add_u32 s81, s58, 0x2000000
  v_mfma_f32_16x16x32_bf16 v[132:135], a[80:83], a[120:123], 0
  s_waitcnt lgkmcnt(4)
  buffer_load_dwordx4 a[220:223], v124, s[8:11], s64 offen offset:3072 sc1
  v_mfma_f32_16x16x32_bf16 v[132:135], a[84:87], a[124:127], v[132:135]
  s_waitcnt lgkmcnt(2)
  ds_read_b64_tr_b16 a[64:65], v40 offset:64
  s_lshl_b32 s58, s98, 1
  v_mfma_f32_16x16x32_bf16 v[132:135], a[88:91], a[128:131], v[132:135]
  s_waitcnt lgkmcnt(1)
  ds_read_b64_tr_b16 a[66:67], v40 offset:320
  s_and_b32 s59, s96, 1
  v_mfma_f32_16x16x32_bf16 v[132:135], a[92:95], a[144:147], v[132:135]
  ds_read_b64_tr_b16 a[68:69], v40 offset:576
  s_add_u32 s58, s58, s59
  v_mfma_f32_16x16x32_bf16 v[140:143], a[92:95], a[148:151], 0
  s_mul_i32 s65, s80, 4
  s_mul_i32 s100, s58, 160
  s_mul_i32 s58, s58, 276480
  v_mfma_f32_16x16x32_bf16 v[140:143], a[88:91], a[132:135], v[140:143]
  s_mul_i32 s38, s80, 8
  ds_read_b64_tr_b16 a[70:71], v40 offset:832
  s_add_u32 s82, s58, 0x2500000
  v_mfma_f32_16x16x32_bf16 v[140:143], a[84:87], a[116:119], v[140:143]
  s_sub_u32 s65, s65, s77
  ds_read_b64_tr_b16 a[72:73], v40 offset:16960
  s_mul_i32 s59, s97, 1490944
  v_mfma_f32_16x16x32_bf16 v[140:143], a[80:83], a[112:115], v[140:143]
  s_sub_u32 s38, s38, s77
  ds_read_b64_tr_b16 a[74:75], v40 offset:17216
  s_lshl_b32 s60, s96, 17
  v_mfma_f32_16x16x32_bf16 v[148:151], a[80:83], a[104:107], 0
  buffer_load_dword v11, v46, s[36:39], s65 offen
  v_mfma_f32_16x16x32_bf16 v[148:151], a[84:87], a[108:111], v[148:151]
  ds_read_b64_tr_b16 a[76:77], v40 offset:17472
  s_add_u32 s59, s59, s60
  v_mfma_f32_16x16x32_bf16 v[148:151], a[88:91], a[136:139], v[148:151]
  ds_read_b64_tr_b16 a[78:79], v40 offset:17728
  s_add_u32 s59, s59, s68
  v_mfma_f32_16x16x32_bf16 v[148:151], a[92:95], a[152:155], v[148:151]
  s_add_u32 s84, s59, 0x436000
  s_lshr_b32 s59, s96, 1
  v_mfma_f32_16x16x32_bf16 v[156:159], a[92:95], a[156:159], 0
  s_mul_i32 s87, s59, 745472
  s_lshl_b32 s58, s97, 1
  v_mfma_f32_16x16x32_bf16 v[156:159], a[88:91], a[140:143], v[156:159]
  s_add_u32 s58, s58, s59
  s_mul_i32 s59, s58, 745472
  v_mfma_f32_16x16x32_bf16 v[156:159], a[84:87], a[100:103], v[156:159]
  s_add_u32 s83, s59, 0x400000
  s_add_u32 s85, s83, s68
  v_mfma_f32_16x16x32_bf16 v[156:159], a[80:83], a[96:99], v[156:159]
  s_waitcnt lgkmcnt(6)
  s_lshr_b32 s59, s96, 1
  s_mul_i32 s60, s59, 138240
  v_mfma_f32_16x16x32_bf16 v[184:187], a[64:67], a[96:99], 0
  s_waitcnt lgkmcnt(4)
  s_add_u32 s82, s82, s60
  s_mul_i32 s60, s59, 110592
  v_mfma_f32_16x16x32_bf16 v[184:187], a[68:71], a[100:103], v[184:187]
  s_waitcnt lgkmcnt(2)
  ds_read_b64_tr_b16 a[80:81], v40 offset:72
  s_add_u32 s85, s85, s60
  v_mfma_f32_16x16x32_bf16 v[184:187], a[72:75], a[140:143], v[184:187]
  s_waitcnt lgkmcnt(1)
  ds_read_b64_tr_b16 a[82:83], v40 offset:328
  s_lshl_b32 s60, s87, 1
  v_mfma_f32_16x16x32_bf16 v[184:187], a[76:79], a[156:159], v[184:187]
  ds_read_b64_tr_b16 a[84:85], v40 offset:584
  s_sub_u32 s60, s85, s60
  v_mfma_f32_16x16x32_bf16 v[176:179], a[76:79], a[152:155], 0
  s_add_u32 s83, s60, 745472
  s_lshl_b32 s58, s58, 2
  v_mfma_f32_16x16x32_bf16 v[176:179], a[72:75], a[136:139], v[176:179]
  ds_read_b64_tr_b16 a[86:87], v40 offset:840
  s_add_u32 s58, s58, s54
  v_mfma_f32_16x16x32_bf16 v[176:179], a[68:71], a[108:111], v[176:179]
  ds_read_b64_tr_b16 a[88:89], v40 offset:16968
  s_mul_i32 s58, s58, 20480
  v_mfma_f32_16x16x32_bf16 v[176:179], a[64:67], a[104:107], v[176:179]
  ds_read_b64_tr_b16 a[90:91], v40 offset:17224
  s_add_u32 s100, s100, s58
  v_mfma_f32_16x16x32_bf16 v[168:171], a[64:67], a[112:115], 0
  s_lshl_b32 s58, s2, 2
  s_add_u32 s58, s58, s54
  v_mfma_f32_16x16x32_bf16 v[168:171], a[68:71], a[116:119], v[168:171]
  ds_read_b64_tr_b16 a[92:93], v40 offset:17480
  s_lshl_b32 s58, s58, 13
  v_mfma_f32_16x16x32_bf16 v[168:171], a[72:75], a[132:135], v[168:171]
  ds_read_b64_tr_b16 a[94:95], v40 offset:17736
  s_add_u32 s88, s58, 0x2800000
  v_mfma_f32_16x16x32_bf16 v[168:171], a[76:79], a[148:151], v[168:171]
  s_sub_u32 s76, s88, 6144
  v_mfma_f32_16x16x32_bf16 v[160:163], a[76:79], a[144:147], 0
  v_mfma_f32_16x16x32_bf16 v[160:163], a[72:75], a[128:131], v[160:163]
  v_mfma_f32_16x16x32_bf16 v[160:163], a[68:71], a[124:127], v[160:163]
  v_mfma_f32_16x16x32_bf16 v[160:163], a[64:67], a[120:123], v[160:163]
  s_waitcnt lgkmcnt(6)
  v_mfma_f32_16x16x32_bf16 v[164:167], a[80:83], a[120:123], 0
  s_waitcnt lgkmcnt(4)
  v_mfma_f32_16x16x32_bf16 v[164:167], a[84:87], a[124:127], v[164:167]
  s_waitcnt lgkmcnt(2)
  ds_read_b64_tr_b16 a[64:65], v40 offset:128
  v_mfma_f32_16x16x32_bf16 v[164:167], a[88:91], a[128:131], v[164:167]
  s_waitcnt lgkmcnt(1)
  ds_read_b64_tr_b16 a[66:67], v40 offset:384
  v_mfma_f32_16x16x32_bf16 v[164:167], a[92:95], a[144:147], v[164:167]
  ds_read_b64_tr_b16 a[68:69], v40 offset:640
  v_mfma_f32_16x16x32_bf16 v[172:175], a[92:95], a[148:151], 0
  v_mfma_f32_16x16x32_bf16 v[172:175], a[88:91], a[132:135], v[172:175]
  ds_read_b64_tr_b16 a[70:71], v40 offset:896
  v_mfma_f32_16x16x32_bf16 v[172:175], a[84:87], a[116:119], v[172:175]
  ds_read_b64_tr_b16 a[72:73], v40 offset:17024
  v_mfma_f32_16x16x32_bf16 v[172:175], a[80:83], a[112:115], v[172:175]
  ds_read_b64_tr_b16 a[74:75], v40 offset:17280
  v_mfma_f32_16x16x32_bf16 v[180:183], a[80:83], a[104:107], 0
  v_mfma_f32_16x16x32_bf16 v[180:183], a[84:87], a[108:111], v[180:183]
  ds_read_b64_tr_b16 a[76:77], v40 offset:17536
  v_mfma_f32_16x16x32_bf16 v[180:183], a[88:91], a[136:139], v[180:183]
  ds_read_b64_tr_b16 a[78:79], v40 offset:17792
  v_mfma_f32_16x16x32_bf16 v[180:183], a[92:95], a[152:155], v[180:183]
  v_mfma_f32_16x16x32_bf16 v[188:191], a[92:95], a[156:159], 0
  v_mfma_f32_16x16x32_bf16 v[188:191], a[88:91], a[140:143], v[188:191]
  v_mfma_f32_16x16x32_bf16 v[188:191], a[84:87], a[100:103], v[188:191]
  v_mfma_f32_16x16x32_bf16 v[188:191], a[80:83], a[96:99], v[188:191]
  s_waitcnt lgkmcnt(6)
  v_mfma_f32_16x16x32_bf16 v[216:219], a[64:67], a[96:99], 0
  s_waitcnt lgkmcnt(4)
  v_mfma_f32_16x16x32_bf16 v[216:219], a[68:71], a[100:103], v[216:219]
  s_waitcnt lgkmcnt(2)
  ds_read_b64_tr_b16 a[80:81], v40 offset:136
  v_mfma_f32_16x16x32_bf16 v[216:219], a[72:75], a[140:143], v[216:219]
  s_waitcnt lgkmcnt(1)
  ds_read_b64_tr_b16 a[82:83], v40 offset:392
  v_mfma_f32_16x16x32_bf16 v[216:219], a[76:79], a[156:159], v[216:219]
  ds_read_b64_tr_b16 a[84:85], v40 offset:648
  v_mfma_f32_16x16x32_bf16 v[208:211], a[76:79], a[152:155], 0
  v_mfma_f32_16x16x32_bf16 v[208:211], a[72:75], a[136:139], v[208:211]
  ds_read_b64_tr_b16 a[86:87], v40 offset:904
  v_mfma_f32_16x16x32_bf16 v[208:211], a[68:71], a[108:111], v[208:211]
  ds_read_b64_tr_b16 a[88:89], v40 offset:17032
  v_mfma_f32_16x16x32_bf16 v[208:211], a[64:67], a[104:107], v[208:211]
  ds_read_b64_tr_b16 a[90:91], v40 offset:17288
  v_mfma_f32_16x16x32_bf16 v[200:203], a[64:67], a[112:115], 0
  v_mfma_f32_16x16x32_bf16 v[200:203], a[68:71], a[116:119], v[200:203]
  ds_read_b64_tr_b16 a[92:93], v40 offset:17544
  v_mfma_f32_16x16x32_bf16 v[200:203], a[72:75], a[132:135], v[200:203]
  ds_read_b64_tr_b16 a[94:95], v40 offset:17800
  v_mfma_f32_16x16x32_bf16 v[200:203], a[76:79], a[148:151], v[200:203]
  v_mfma_f32_16x16x32_bf16 v[192:195], a[76:79], a[144:147], 0
  v_mfma_f32_16x16x32_bf16 v[192:195], a[72:75], a[128:131], v[192:195]
  v_mfma_f32_16x16x32_bf16 v[192:195], a[68:71], a[124:127], v[192:195]
  v_mfma_f32_16x16x32_bf16 v[192:195], a[64:67], a[120:123], v[192:195]
  s_waitcnt lgkmcnt(6)
  v_mfma_f32_16x16x32_bf16 v[196:199], a[80:83], a[120:123], 0
  s_waitcnt lgkmcnt(4)
  v_mfma_f32_16x16x32_bf16 v[196:199], a[84:87], a[124:127], v[196:199]
  s_waitcnt lgkmcnt(2)
  ds_read_b64_tr_b16 a[64:65], v40 offset:192
  v_mfma_f32_16x16x32_bf16 v[196:199], a[88:91], a[128:131], v[196:199]
  s_waitcnt lgkmcnt(1)
  ds_read_b64_tr_b16 a[66:67], v40 offset:448
  v_mfma_f32_16x16x32_bf16 v[196:199], a[92:95], a[144:147], v[196:199]
  ds_read_b64_tr_b16 a[68:69], v40 offset:704
  v_mfma_f32_16x16x32_bf16 v[204:207], a[92:95], a[148:151], 0
  v_mfma_f32_16x16x32_bf16 v[204:207], a[88:91], a[132:135], v[204:207]
  ds_read_b64_tr_b16 a[70:71], v40 offset:960
  v_mfma_f32_16x16x32_bf16 v[204:207], a[84:87], a[116:119], v[204:207]
  ds_read_b64_tr_b16 a[72:73], v40 offset:17088
  v_mfma_f32_16x16x32_bf16 v[204:207], a[80:83], a[112:115], v[204:207]
  ds_read_b64_tr_b16 a[74:75], v40 offset:17344
  v_mfma_f32_16x16x32_bf16 v[212:215], a[80:83], a[104:107], 0
  v_mfma_f32_16x16x32_bf16 v[212:215], a[84:87], a[108:111], v[212:215]
  ds_read_b64_tr_b16 a[76:77], v40 offset:17600
  v_mfma_f32_16x16x32_bf16 v[212:215], a[88:91], a[136:139], v[212:215]
  ds_read_b64_tr_b16 a[78:79], v40 offset:17856
  v_mfma_f32_16x16x32_bf16 v[212:215], a[92:95], a[152:155], v[212:215]
  v_mfma_f32_16x16x32_bf16 v[220:223], a[92:95], a[156:159], 0
  v_mfma_f32_16x16x32_bf16 v[220:223], a[88:91], a[140:143], v[220:223]
  v_mfma_f32_16x16x32_bf16 v[220:223], a[84:87], a[100:103], v[220:223]
  v_mfma_f32_16x16x32_bf16 v[220:223], a[80:83], a[96:99], v[220:223]
  s_waitcnt lgkmcnt(6)
  v_mfma_f32_16x16x32_bf16 v[248:251], a[64:67], a[96:99], 0
  s_waitcnt lgkmcnt(4)
  v_mfma_f32_16x16x32_bf16 v[248:251], a[68:71], a[100:103], v[248:251]
  s_waitcnt lgkmcnt(2)
  ds_read_b64_tr_b16 a[80:81], v40 offset:200
  v_mfma_f32_16x16x32_bf16 v[248:251], a[72:75], a[140:143], v[248:251]
  s_waitcnt lgkmcnt(1)
  ds_read_b64_tr_b16 a[82:83], v40 offset:456
  v_mfma_f32_16x16x32_bf16 v[248:251], a[76:79], a[156:159], v[248:251]
  ds_read_b64_tr_b16 a[84:85], v40 offset:712
  v_mfma_f32_16x16x32_bf16 v[240:243], a[76:79], a[152:155], 0
  v_mfma_f32_16x16x32_bf16 v[240:243], a[72:75], a[136:139], v[240:243]
  ds_read_b64_tr_b16 a[86:87], v40 offset:968
  v_mfma_f32_16x16x32_bf16 v[240:243], a[68:71], a[108:111], v[240:243]
  ds_read_b64_tr_b16 a[88:89], v40 offset:17096
  v_mfma_f32_16x16x32_bf16 v[240:243], a[64:67], a[104:107], v[240:243]
  ds_read_b64_tr_b16 a[90:91], v40 offset:17352
  v_mfma_f32_16x16x32_bf16 v[232:235], a[64:67], a[112:115], 0
  v_mfma_f32_16x16x32_bf16 v[232:235], a[68:71], a[116:119], v[232:235]
  ds_read_b64_tr_b16 a[92:93], v40 offset:17608
  v_mfma_f32_16x16x32_bf16 v[232:235], a[72:75], a[132:135], v[232:235]
  ds_read_b64_tr_b16 a[94:95], v40 offset:17864
  v_mfma_f32_16x16x32_bf16 v[232:235], a[76:79], a[148:151], v[232:235]
  v_mfma_f32_16x16x32_bf16 v[224:227], a[76:79], a[144:147], 0
  v_mfma_f32_16x16x32_bf16 v[224:227], a[72:75], a[128:131], v[224:227]
  v_mfma_f32_16x16x32_bf16 v[224:227], a[68:71], a[124:127], v[224:227]
  s_waitcnt vmcnt(17)
  v_mfma_f32_16x16x32_bf16 v[224:227], a[64:67], a[120:123], v[224:227]
  s_waitcnt lgkmcnt(6)
  s_waitcnt lgkmcnt(0)
  v_mfma_f32_16x16x32_bf16 v[228:231], a[80:83], a[120:123], 0
  s_barrier
  v_mfma_f32_16x16x32_bf16 v[228:231], a[84:87], a[124:127], v[228:231]
  ds_read_b64_tr_b16 a[64:65], v41 offset:33792
  v_mfma_f32_16x16x32_bf16 v[228:231], a[88:91], a[128:131], v[228:231]
  ds_read_b64_tr_b16 a[66:67], v41 offset:33920
  v_mfma_f32_16x16x32_bf16 v[228:231], a[92:95], a[144:147], v[228:231]
  ds_read_b64_tr_b16 a[68:69], v41 offset:34048
  v_mfma_f32_16x16x32_bf16 v[236:239], a[92:95], a[148:151], 0
  v_mfma_f32_16x16x32_bf16 v[236:239], a[88:91], a[132:135], v[236:239]
  ds_read_b64_tr_b16 a[70:71], v41 offset:34176
  v_mfma_f32_16x16x32_bf16 v[236:239], a[84:87], a[116:119], v[236:239]
  ds_read_b64_tr_b16 a[72:73], v41 offset:50688
  v_mfma_f32_16x16x32_bf16 v[236:239], a[80:83], a[112:115], v[236:239]
  ds_read_b64_tr_b16 a[74:75], v41 offset:50816
  v_mfma_f32_16x16x32_bf16 v[244:247], a[80:83], a[104:107], 0
  v_mfma_f32_16x16x32_bf16 v[244:247], a[84:87], a[108:111], v[244:247]
  ds_read_b64_tr_b16 a[76:77], v41 offset:50944
  v_mfma_f32_16x16x32_bf16 v[244:247], a[88:91], a[136:139], v[244:247]
  ds_read_b64_tr_b16 a[78:79], v41 offset:51072
  v_mfma_f32_16x16x32_bf16 v[244:247], a[92:95], a[152:155], v[244:247]
  v_mfma_f32_16x16x32_bf16 v[252:255], a[92:95], a[156:159], 0
  v_mfma_f32_16x16x32_bf16 v[252:255], a[88:91], a[140:143], v[252:255]
  v_mfma_f32_16x16x32_bf16 v[252:255], a[84:87], a[100:103], v[252:255]
  s_waitcnt vmcnt(1)
  v_mfma_f32_16x16x32_bf16 v[252:255], a[80:83], a[96:99], v[252:255]
  s_waitcnt lgkmcnt(6)
  v_mfma_f32_16x16x32_bf16 v[60:63], a[64:67], a[172:175], v[60:63]
  s_waitcnt lgkmcnt(4)
  v_mfma_f32_16x16x32_bf16 v[60:63], a[68:71], a[188:191], v[60:63]
  s_waitcnt lgkmcnt(2)
  ds_read_b64_tr_b16 a[80:81], v41 offset:42240
  v_mfma_f32_16x16x32_bf16 v[60:63], a[72:75], a[204:207], v[60:63]
  s_waitcnt lgkmcnt(1)
  ds_read_b64_tr_b16 a[82:83], v41 offset:42368
  v_mfma_f32_16x16x32_bf16 v[60:63], a[76:79], a[220:223], v[60:63]
  ds_read_b64_tr_b16 a[84:85], v41 offset:42496
  v_mfma_f32_16x16x32_bf16 v[56:59], a[76:79], a[216:219], v[56:59]
  v_mfma_f32_16x16x32_bf16 v[56:59], a[72:75], a[200:203], v[56:59]
  ds_read_b64_tr_b16 a[86:87], v41 offset:42624
  v_mfma_f32_16x16x32_bf16 v[56:59], a[68:71], a[184:187], v[56:59]
  ds_read_b64_tr_b16 a[88:89], v41 offset:59136
  v_mfma_f32_16x16x32_bf16 v[56:59], a[64:67], a[168:171], v[56:59]
  ds_read_b64_tr_b16 a[90:91], v41 offset:59264
  v_mfma_f32_16x16x32_bf16 v[52:55], a[64:67], a[164:167], v[52:55]
  v_mfma_f32_16x16x32_bf16 v[52:55], a[68:71], a[180:183], v[52:55]
  ds_read_b64_tr_b16 a[92:93], v41 offset:59392
  v_mfma_f32_16x16x32_bf16 v[52:55], a[72:75], a[196:199], v[52:55]
  ds_read_b64_tr_b16 a[94:95], v41 offset:59520
  v_mfma_f32_16x16x32_bf16 v[52:55], a[76:79], a[212:215], v[52:55]
  v_mfma_f32_16x16x32_bf16 v[48:51], a[76:79], a[208:211], v[48:51]
  v_mfma_f32_16x16x32_bf16 v[48:51], a[72:75], a[192:195], v[48:51]
  v_mfma_f32_16x16x32_bf16 v[48:51], a[68:71], a[176:179], v[48:51]
  v_mfma_f32_16x16x32_bf16 v[48:51], a[64:67], a[160:163], v[48:51]
  s_waitcnt lgkmcnt(6)
  v_mfma_f32_16x16x32_bf16 a[0:3], a[80:83], a[160:163], a[0:3]
  s_waitcnt lgkmcnt(4)
  v_mfma_f32_16x16x32_bf16 a[0:3], a[84:87], a[176:179], a[0:3]
  s_waitcnt lgkmcnt(2)
  ds_read_b64_tr_b16 a[64:65], v41 offset:33824
  v_mfma_f32_16x16x32_bf16 a[0:3], a[88:91], a[192:195], a[0:3]
  s_waitcnt lgkmcnt(1)
  ds_read_b64_tr_b16 a[66:67], v41 offset:33952
  v_mfma_f32_16x16x32_bf16 a[0:3], a[92:95], a[208:211], a[0:3]
  ds_read_b64_tr_b16 a[68:69], v41 offset:34080
  v_mfma_f32_16x16x32_bf16 a[4:7], a[92:95], a[212:215], a[4:7]
  v_mfma_f32_16x16x32_bf16 a[4:7], a[88:91], a[196:199], a[4:7]
  ds_read_b64_tr_b16 a[70:71], v41 offset:34208
  v_mfma_f32_16x16x32_bf16 a[4:7], a[84:87], a[180:183], a[4:7]
  ds_read_b64_tr_b16 a[72:73], v41 offset:50720
  v_mfma_f32_16x16x32_bf16 a[4:7], a[80:83], a[164:167], a[4:7]
  ds_read_b64_tr_b16 a[74:75], v41 offset:50848
  v_mfma_f32_16x16x32_bf16 a[8:11], a[80:83], a[168:171], a[8:11]
  v_mfma_f32_16x16x32_bf16 a[8:11], a[84:87], a[184:187], a[8:11]
  ds_read_b64_tr_b16 a[76:77], v41 offset:50976
  v_mfma_f32_16x16x32_bf16 a[8:11], a[88:91], a[200:203], a[8:11]
  ds_read_b64_tr_b16 a[78:79], v41 offset:51104
  v_mfma_f32_16x16x32_bf16 a[8:11], a[92:95], a[216:219], a[8:11]
  v_mfma_f32_16x16x32_bf16 a[12:15], a[92:95], a[220:223], a[12:15]
  v_mfma_f32_16x16x32_bf16 a[12:15], a[88:91], a[204:207], a[12:15]
  v_mfma_f32_16x16x32_bf16 a[12:15], a[84:87], a[188:191], a[12:15]
  v_mfma_f32_16x16x32_bf16 a[12:15], a[80:83], a[172:175], a[12:15]
  s_waitcnt lgkmcnt(6)
  v_mfma_f32_16x16x32_bf16 v[76:79], a[64:67], a[172:175], v[76:79]
  s_waitcnt lgkmcnt(4)
  v_mfma_f32_16x16x32_bf16 v[76:79], a[68:71], a[188:191], v[76:79]
  s_waitcnt lgkmcnt(2)
  ds_read_b64_tr_b16 a[80:81], v41 offset:42272
  v_mfma_f32_16x16x32_bf16 v[76:79], a[72:75], a[204:207], v[76:79]
  s_waitcnt lgkmcnt(1)
  ds_read_b64_tr_b16 a[82:83], v41 offset:42400
  v_mfma_f32_16x16x32_bf16 v[76:79], a[76:79], a[220:223], v[76:79]
  ds_read_b64_tr_b16 a[84:85], v41 offset:42528
  v_mfma_f32_16x16x32_bf16 v[72:75], a[76:79], a[216:219], v[72:75]
  v_mfma_f32_16x16x32_bf16 v[72:75], a[72:75], a[200:203], v[72:75]
  ds_read_b64_tr_b16 a[86:87], v41 offset:42656
  v_mfma_f32_16x16x32_bf16 v[72:75], a[68:71], a[184:187], v[72:75]
  ds_read_b64_tr_b16 a[88:89], v41 offset:59168
  v_mfma_f32_16x16x32_bf16 v[72:75], a[64:67], a[168:171], v[72:75]
  ds_read_b64_tr_b16 a[90:91], v41 offset:59296
  v_mfma_f32_16x16x32_bf16 v[68:71], a[64:67], a[164:167], v[68:71]
  v_mfma_f32_16x16x32_bf16 v[68:71], a[68:71], a[180:183], v[68:71]
  s_mov_b32 s66, 1048576
  ds_read_b64_tr_b16 a[92:93], v41 offset:59424
  v_mfma_f32_16x16x32_bf16 v[68:71], a[72:75], a[196:199], v[68:71]
  s_add_u32 m0, s51, 33792
  ds_read_b64_tr_b16 a[94:95], v41 offset:59552
  v_mfma_f32_16x16x32_bf16 v[68:71], a[76:79], a[212:215], v[68:71]
  buffer_load_dwordx4 v32, s[20:23], s66 offen lds
  v_mfma_f32_16x16x32_bf16 v[64:67], a[76:79], a[208:211], v[64:67]
  s_add_u32 m0, s51, 34848
  v_mfma_f32_16x16x32_bf16 v[64:67], a[72:75], a[192:195], v[64:67]
  buffer_load_dwordx4 v33, s[20:23], s66 offen lds
  v_mfma_f32_16x16x32_bf16 v[64:67], a[68:71], a[176:179], v[64:67]
  s_add_u32 m0, s51, 35904
  v_mfma_f32_16x16x32_bf16 v[64:67], a[64:67], a[160:163], v[64:67]
  s_waitcnt lgkmcnt(6)
  buffer_load_dwordx4 v34, s[20:23], s66 offen lds
  v_mfma_f32_16x16x32_bf16 a[16:19], a[80:83], a[160:163], a[16:19]
  s_waitcnt lgkmcnt(4)
  v_mfma_f32_16x16x32_bf16 a[16:19], a[84:87], a[176:179], a[16:19]
  s_waitcnt lgkmcnt(2)
  ds_read_b64_tr_b16 a[64:65], v41 offset:33856
  v_mfma_f32_16x16x32_bf16 a[16:19], a[88:91], a[192:195], a[16:19]
  s_waitcnt lgkmcnt(1)
  ds_read_b64_tr_b16 a[66:67], v41 offset:33984
  v_mfma_f32_16x16x32_bf16 a[16:19], a[92:95], a[208:211], a[16:19]
  s_add_u32 m0, s51, 36960
  ds_read_b64_tr_b16 a[68:69], v41 offset:34112
  v_mfma_f32_16x16x32_bf16 a[20:23], a[92:95], a[212:215], a[20:23]
  buffer_load_dwordx4 v35, s[20:23], s66 offen lds
  v_mfma_f32_16x16x32_bf16 a[20:23], a[88:91], a[196:199], a[20:23]
  ds_read_b64_tr_b16 a[70:71], v41 offset:34240
  v_mfma_f32_16x16x32_bf16 a[20:23], a[84:87], a[180:183], a[20:23]
  s_mov_b32 s66, 1572864
  ds_read_b64_tr_b16 a[72:73], v41 offset:50752
  v_mfma_f32_16x16x32_bf16 a[20:23], a[80:83], a[164:167], a[20:23]
  s_add_u32 m0, s51, 50688
  ds_read_b64_tr_b16 a[74:75], v41 offset:50880
  v_mfma_f32_16x16x32_bf16 a[24:27], a[80:83], a[168:171], a[24:27]
  buffer_load_dwordx4 v32, s[20:23], s66 offen lds
  v_mfma_f32_16x16x32_bf16 a[24:27], a[84:87], a[184:187], a[24:27]
  ds_read_b64_tr_b16 a[76:77], v41 offset:51008
  v_mfma_f32_16x16x32_bf16 a[24:27], a[88:91], a[200:203], a[24:27]
  s_add_u32 m0, s51, 51744
  ds_read_b64_tr_b16 a[78:79], v41 offset:51136
  v_mfma_f32_16x16x32_bf16 a[24:27], a[92:95], a[216:219], a[24:27]
  buffer_load_dwordx4 v33, s[20:23], s66 offen lds
  v_mfma_f32_16x16x32_bf16 a[28:31], a[92:95], a[220:223], a[28:31]
  s_add_u32 m0, s51, 52800
  v_mfma_f32_16x16x32_bf16 a[28:31], a[88:91], a[204:207], a[28:31]
  buffer_load_dwordx4 v34, s[20:23], s66 offen lds
  v_mfma_f32_16x16x32_bf16 a[28:31], a[84:87], a[188:191], a[28:31]
  s_add_u32 m0, s51, 53856
  v_mfma_f32_16x16x32_bf16 a[28:31], a[80:83], a[172:175], a[28:31]
  s_waitcnt lgkmcnt(6)
  buffer_load_dwordx4 v35, s[20:23], s66 offen lds
  v_mfma_f32_16x16x32_bf16 v[92:95], a[64:67], a[172:175], v[92:95]
  s_waitcnt lgkmcnt(4)
  v_mfma_f32_16x16x32_bf16 v[92:95], a[68:71], a[188:191], v[92:95]
  s_waitcnt lgkmcnt(2)
  ds_read_b64_tr_b16 a[80:81], v41 offset:42304
  v_mfma_f32_16x16x32_bf16 v[92:95], a[72:75], a[204:207], v[92:95]
  s_waitcnt lgkmcnt(1)
  s_mov_b32 s67, 884736
  ds_read_b64_tr_b16 a[82:83], v41 offset:42432
  v_mfma_f32_16x16x32_bf16 v[92:95], a[76:79], a[220:223], v[92:95]
  s_add_u32 m0, s51, 67584
  ds_read_b64_tr_b16 a[84:85], v41 offset:42560
  v_mfma_f32_16x16x32_bf16 v[88:91], a[76:79], a[216:219], v[88:91]
  buffer_load_dwordx4 v36, s[44:47], s67 offen lds
  v_mfma_f32_16x16x32_bf16 v[88:91], a[72:75], a[200:203], v[88:91]
  ds_read_b64_tr_b16 a[86:87], v41 offset:42688
  v_mfma_f32_16x16x32_bf16 v[88:91], a[68:71], a[184:187], v[88:91]
  ds_read_b64_tr_b16 a[88:89], v41 offset:59200
  v_mfma_f32_16x16x32_bf16 v[88:91], a[64:67], a[168:171], v[88:91]
  s_add_u32 m0, s51, 68640
  ds_read_b64_tr_b16 a[90:91], v41 offset:59328
  v_mfma_f32_16x16x32_bf16 v[84:87], a[64:67], a[164:167], v[84:87]
  buffer_load_dwordx4 v37, s[44:47], s67 offen lds
  v_mfma_f32_16x16x32_bf16 v[84:87], a[68:71], a[180:183], v[84:87]
  ds_read_b64_tr_b16 a[92:93], v41 offset:59456
  v_mfma_f32_16x16x32_bf16 v[84:87], a[72:75], a[196:199], v[84:87]
  ds_read_b64_tr_b16 a[94:95], v41 offset:59584
  v_mfma_f32_16x16x32_bf16 v[84:87], a[76:79], a[212:215], v[84:87]
  v_mfma_f32_16x16x32_bf16 v[80:83], a[76:79], a[208:211], v[80:83]
  v_mfma_f32_16x16x32_bf16 v[80:83], a[72:75], a[192:195], v[80:83]
  v_mfma_f32_16x16x32_bf16 v[80:83], a[68:71], a[176:179], v[80:83]
  v_mfma_f32_16x16x32_bf16 v[80:83], a[64:67], a[160:163], v[80:83]
  s_waitcnt lgkmcnt(6)
  v_mfma_f32_16x16x32_bf16 a[32:35], a[80:83], a[160:163], a[32:35]
  s_waitcnt lgkmcnt(4)
  v_mfma_f32_16x16x32_bf16 a[32:35], a[84:87], a[176:179], a[32:35]
  s_waitcnt lgkmcnt(2)
  ds_read_b64_tr_b16 a[64:65], v41 offset:33888
  v_mfma_f32_16x16x32_bf16 a[32:35], a[88:91], a[192:195], a[32:35]
  s_waitcnt lgkmcnt(1)
  ds_read_b64_tr_b16 a[66:67], v41 offset:34016
  v_mfma_f32_16x16x32_bf16 a[32:35], a[92:95], a[208:211], a[32:35]
  ds_read_b64_tr_b16 a[68:69], v41 offset:34144
  v_mfma_f32_16x16x32_bf16 a[36:39], a[92:95], a[212:215], a[36:39]
  v_mfma_f32_16x16x32_bf16 a[36:39], a[88:91], a[196:199], a[36:39]
  ds_read_b64_tr_b16 a[70:71], v41 offset:34272
  v_mfma_f32_16x16x32_bf16 a[36:39], a[84:87], a[180:183], a[36:39]
  ds_read_b64_tr_b16 a[72:73], v41 offset:50784
  v_mfma_f32_16x16x32_bf16 a[36:39], a[80:83], a[164:167], a[36:39]
  s_add_u32 m0, s51, 69696
  ds_read_b64_tr_b16 a[74:75], v41 offset:50912
  v_mfma_f32_16x16x32_bf16 a[40:43], a[80:83], a[168:171], a[40:43]
  buffer_load_dwordx4 v38, s[44:47], s67 offen lds
  v_mfma_f32_16x16x32_bf16 a[40:43], a[84:87], a[184:187], a[40:43]
  ds_read_b64_tr_b16 a[76:77], v41 offset:51040
  v_mfma_f32_16x16x32_bf16 a[40:43], a[88:91], a[200:203], a[40:43]
  ds_read_b64_tr_b16 a[78:79], v41 offset:51168
  v_mfma_f32_16x16x32_bf16 a[40:43], a[92:95], a[216:219], a[40:43]
  s_add_u32 m0, s51, 70752
  v_mfma_f32_16x16x32_bf16 a[44:47], a[92:95], a[220:223], a[44:47]
  buffer_load_dwordx4 v39, s[44:47], s67 offen lds
  v_mfma_f32_16x16x32_bf16 a[44:47], a[88:91], a[204:207], a[44:47]
  v_mfma_f32_16x16x32_bf16 a[44:47], a[84:87], a[188:191], a[44:47]
  s_mov_b32 s67, 1105920
  v_mfma_f32_16x16x32_bf16 a[44:47], a[80:83], a[172:175], a[44:47]
  s_waitcnt lgkmcnt(6)
  s_add_u32 m0, s51, 84480
  v_mfma_f32_16x16x32_bf16 v[108:111], a[64:67], a[172:175], v[108:111]
  s_waitcnt lgkmcnt(4)
  buffer_load_dwordx4 v36, s[44:47], s67 offen lds
  v_mfma_f32_16x16x32_bf16 v[108:111], a[68:71], a[188:191], v[108:111]
  s_waitcnt lgkmcnt(2)
  ds_read_b64_tr_b16 a[80:81], v41 offset:42336
  v_mfma_f32_16x16x32_bf16 v[108:111], a[72:75], a[204:207], v[108:111]
  s_waitcnt lgkmcnt(1)
  ds_read_b64_tr_b16 a[82:83], v41 offset:42464
  v_mfma_f32_16x16x32_bf16 v[108:111], a[76:79], a[220:223], v[108:111]
  s_add_u32 m0, s51, 85536
  ds_read_b64_tr_b16 a[84:85], v41 offset:42592
  v_mfma_f32_16x16x32_bf16 v[104:107], a[76:79], a[216:219], v[104:107]
  buffer_load_dwordx4 v37, s[44:47], s67 offen lds
  v_mfma_f32_16x16x32_bf16 v[104:107], a[72:75], a[200:203], v[104:107]
  ds_read_b64_tr_b16 a[86:87], v41 offset:42720
  v_mfma_f32_16x16x32_bf16 v[104:107], a[68:71], a[184:187], v[104:107]
  ds_read_b64_tr_b16 a[88:89], v41 offset:59232
  v_mfma_f32_16x16x32_bf16 v[104:107], a[64:67], a[168:171], v[104:107]
  ds_read_b64_tr_b16 a[90:91], v41 offset:59360
  v_mfma_f32_16x16x32_bf16 v[100:103], a[64:67], a[164:167], v[100:103]
  v_mfma_f32_16x16x32_bf16 v[100:103], a[68:71], a[180:183], v[100:103]
  ds_read_b64_tr_b16 a[92:93], v41 offset:59488
  v_mfma_f32_16x16x32_bf16 v[100:103], a[72:75], a[196:199], v[100:103]
  s_add_u32 m0, s51, 86592
  ds_read_b64_tr_b16 a[94:95], v41 offset:59616
  v_mfma_f32_16x16x32_bf16 v[100:103], a[76:79], a[212:215], v[100:103]
  buffer_load_dwordx4 v38, s[44:47], s67 offen lds
  v_mfma_f32_16x16x32_bf16 v[96:99], a[76:79], a[208:211], v[96:99]
  s_add_u32 m0, s51, 87648
  v_mfma_f32_16x16x32_bf16 v[96:99], a[72:75], a[192:195], v[96:99]
  buffer_load_dwordx4 v39, s[44:47], s67 offen lds
  v_mfma_f32_16x16x32_bf16 v[96:99], a[68:71], a[176:179], v[96:99]
  s_waitcnt vmcnt(8)
  s_add_u32 s64, s63, 32768
  v_mfma_f32_16x16x32_bf16 v[96:99], a[64:67], a[160:163], v[96:99]
  s_waitcnt lgkmcnt(6)
  s_waitcnt lgkmcnt(0)
  buffer_load_dwordx4 a[224:227], v1, s[8:11], s64 offen offset:0 sc1
  v_mfma_f32_16x16x32_bf16 a[48:51], a[80:83], a[160:163], a[48:51]
  s_barrier
  v_mfma_f32_16x16x32_bf16 a[48:51], a[84:87], a[176:179], a[48:51]
  ds_read_b64_tr_b16 a[64:65], v40 offset:33792
  v_mfma_f32_16x16x32_bf16 a[48:51], a[88:91], a[192:195], a[48:51]
  ds_read_b64_tr_b16 a[66:67], v40 offset:34048
  v_mfma_f32_16x16x32_bf16 a[48:51], a[92:95], a[208:211], a[48:51]
  ds_read_b64_tr_b16 a[68:69], v40 offset:34304
  v_mfma_f32_16x16x32_bf16 a[52:55], a[92:95], a[212:215], a[52:55]
  buffer_load_dwordx4 a[228:231], v1, s[8:11], s64 offen offset:1024 sc1
  v_mfma_f32_16x16x32_bf16 a[52:55], a[88:91], a[196:199], a[52:55]
  ds_read_b64_tr_b16 a[70:71], v40 offset:34560
  v_mfma_f32_16x16x32_bf16 a[52:55], a[84:87], a[180:183], a[52:55]
  ds_read_b64_tr_b16 a[72:73], v40 offset:50688
  v_mfma_f32_16x16x32_bf16 a[52:55], a[80:83], a[164:167], a[52:55]
  ds_read_b64_tr_b16 a[74:75], v40 offset:50944
  v_mfma_f32_16x16x32_bf16 a[56:59], a[80:83], a[168:171], a[56:59]
  buffer_load_dwordx4 a[232:235], v1, s[8:11], s64 offen offset:2048 sc1
  v_mfma_f32_16x16x32_bf16 a[56:59], a[84:87], a[184:187], a[56:59]
  ds_read_b64_tr_b16 a[76:77], v40 offset:51200
  v_mfma_f32_16x16x32_bf16 a[56:59], a[88:91], a[200:203], a[56:59]
  ds_read_b64_tr_b16 a[78:79], v40 offset:51456
  v_mfma_f32_16x16x32_bf16 a[56:59], a[92:95], a[216:219], a[56:59]
  buffer_load_dwordx4 a[236:239], v1, s[8:11], s64 offen offset:3072 sc1
  v_mfma_f32_16x16x32_bf16 a[60:63], a[92:95], a[220:223], a[60:63]
  v_mfma_f32_16x16x32_bf16 a[60:63], a[88:91], a[204:207], a[60:63]
  buffer_load_dwordx4 a[240:243], v124, s[8:11], s64 offen offset:0 sc1
  v_mfma_f32_16x16x32_bf16 a[60:63], a[84:87], a[188:191], a[60:63]
  v_mfma_f32_16x16x32_bf16 a[60:63], a[80:83], a[172:175], a[60:63]
  s_waitcnt lgkmcnt(6)
  v_mfma_f32_16x16x32_bf16 v[152:155], a[64:67], a[172:175], v[152:155]
  s_waitcnt lgkmcnt(4)
  v_mfma_f32_16x16x32_bf16 v[152:155], a[68:71], a[188:191], v[152:155]
  s_waitcnt lgkmcnt(2)
  ds_read_b64_tr_b16 a[80:81], v40 offset:33800
  v_mfma_f32_16x16x32_bf16 v[152:155], a[72:75], a[204:207], v[152:155]
  s_waitcnt lgkmcnt(1)
  ds_read_b64_tr_b16 a[82:83], v40 offset:34056
  v_mfma_f32_16x16x32_bf16 v[152:155], a[76:79], a[220:223], v[152:155]
  ds_read_b64_tr_b16 a[84:85], v40 offset:34312
  v_mfma_f32_16x16x32_bf16 v[144:147], a[76:79], a[216:219], v[144:147]
  buffer_load_dwordx4 a[244:247], v124, s[8:11], s64 offen offset:1024 sc1
  v_mfma_f32_16x16x32_bf16 v[144:147], a[72:75], a[200:203], v[144:147]
  ds_read_b64_tr_b16 a[86:87], v40 offset:34568
  v_mfma_f32_16x16x32_bf16 v[144:147], a[68:71], a[184:187], v[144:147]
  ds_read_b64_tr_b16 a[88:89], v40 offset:50696
  v_mfma_f32_16x16x32_bf16 v[144:147], a[64:67], a[168:171], v[144:147]
  ds_read_b64_tr_b16 a[90:91], v40 offset:50952
  v_mfma_f32_16x16x32_bf16 v[136:139], a[64:67], a[164:167], v[136:139]
  buffer_load_dwordx4 a[248:251], v124, s[8:11], s64 offen offset:2048 sc1
  v_mfma_f32_16x16x32_bf16 v[136:139], a[68:71], a[180:183], v[136:139]
  ds_read_b64_tr_b16 a[92:93], v40 offset:51208
  v_mfma_f32_16x16x32_bf16 v[136:139], a[72:75], a[196:199], v[136:139]
  ds_read_b64_tr_b16 a[94:95], v40 offset:51464
  v_mfma_f32_16x16x32_bf16 v[136:139], a[76:79], a[212:215], v[136:139]
  buffer_load_dwordx4 a[252:255], v124, s[8:11], s64 offen offset:3072 sc1
  v_mfma_f32_16x16x32_bf16 v[128:131], a[76:79], a[208:211], v[128:131]
  v_mfma_f32_16x16x32_bf16 v[128:131], a[72:75], a[192:195], v[128:131]
  v_mfma_f32_16x16x32_bf16 v[128:131], a[68:71], a[176:179], v[128:131]
  v_mfma_f32_16x16x32_bf16 v[128:131], a[64:67], a[160:163], v[128:131]
  s_waitcnt lgkmcnt(6)
  s_add_u32 s64, s63, 40960
  v_mfma_f32_16x16x32_bf16 v[132:135], a[80:83], a[160:163], v[132:135]
  s_waitcnt lgkmcnt(4)
  buffer_load_dwordx4 a[96:99], v1, s[8:11], s64 offen offset:0 sc1
  v_mfma_f32_16x16x32_bf16 v[132:135], a[84:87], a[176:179], v[132:135]
  s_waitcnt lgkmcnt(2)
  ds_read_b64_tr_b16 a[64:65], v40 offset:33856
  v_mfma_f32_16x16x32_bf16 v[132:135], a[88:91], a[192:195], v[132:135]
  s_waitcnt lgkmcnt(1)
  ds_read_b64_tr_b16 a[66:67], v40 offset:34112
  v_mfma_f32_16x16x32_bf16 v[132:135], a[92:95], a[208:211], v[132:135]
  ds_read_b64_tr_b16 a[68:69], v40 offset:34368
  v_mfma_f32_16x16x32_bf16 v[140:143], a[92:95], a[212:215], v[140:143]
  buffer_load_dwordx4 a[100:103], v1, s[8:11], s64 offen offset:1024 sc1
  v_mfma_f32_16x16x32_bf16 v[140:143], a[88:91], a[196:199], v[140:143]
  ds_read_b64_tr_b16 a[70:71], v40 offset:34624
  v_mfma_f32_16x16x32_bf16 v[140:143], a[84:87], a[180:183], v[140:143]
  ds_read_b64_tr_b16 a[72:73], v40 offset:50752
  v_mfma_f32_16x16x32_bf16 v[140:143], a[80:83], a[164:167], v[140:143]
  ds_read_b64_tr_b16 a[74:75], v40 offset:51008
  v_mfma_f32_16x16x32_bf16 v[148:151], a[80:83], a[168:171], v[148:151]
  v_mfma_f32_16x16x32_bf16 v[148:151], a[84:87], a[184:187], v[148:151]
  ds_read_b64_tr_b16 a[76:77], v40 offset:51264
  v_mfma_f32_16x16x32_bf16 v[148:151], a[88:91], a[200:203], v[148:151]
  ds_read_b64_tr_b16 a[78:79], v40 offset:51520
  v_mfma_f32_16x16x32_bf16 v[148:151], a[92:95], a[216:219], v[148:151]
  buffer_load_dwordx4 a[104:107], v1, s[8:11], s64 offen offset:2048 sc1
  v_mfma_f32_16x16x32_bf16 v[156:159], a[92:95], a[220:223], v[156:159]
  v_mfma_f32_16x16x32_bf16 v[156:159], a[88:91], a[204:207], v[156:159]
  v_mfma_f32_16x16x32_bf16 v[156:159], a[84:87], a[188:191], v[156:159]
  v_mfma_f32_16x16x32_bf16 v[156:159], a[80:83], a[172:175], v[156:159]
  s_waitcnt lgkmcnt(6)
  v_mfma_f32_16x16x32_bf16 v[184:187], a[64:67], a[172:175], v[184:187]
  s_waitcnt lgkmcnt(4)
  buffer_load_dwordx4 a[108:111], v1, s[8:11], s64 offen offset:3072 sc1
  v_mfma_f32_16x16x32_bf16 v[184:187], a[68:71], a[188:191], v[184:187]
  s_waitcnt lgkmcnt(2)
  ds_read_b64_tr_b16 a[80:81], v40 offset:33864
  v_mfma_f32_16x16x32_bf16 v[184:187], a[72:75], a[204:207], v[184:187]
  s_waitcnt lgkmcnt(1)
  ds_read_b64_tr_b16 a[82:83], v40 offset:34120
  v_mfma_f32_16x16x32_bf16 v[184:187], a[76:79], a[220:223], v[184:187]
  ds_read_b64_tr_b16 a[84:85], v40 offset:34376
  v_mfma_f32_16x16x32_bf16 v[176:179], a[76:79], a[216:219], v[176:179]
  v_mfma_f32_16x16x32_bf16 v[176:179], a[72:75], a[200:203], v[176:179]
  ds_read_b64_tr_b16 a[86:87], v40 offset:34632
  v_mfma_f32_16x16x32_bf16 v[176:179], a[68:71], a[184:187], v[176:179]
  ds_read_b64_tr_b16 a[88:89], v40 offset:50760
  v_mfma_f32_16x16x32_bf16 v[176:179], a[64:67], a[168:171], v[176:179]
  ds_read_b64_tr_b16 a[90:91], v40 offset:51016
  v_mfma_f32_16x16x32_bf16 v[168:171], a[64:67], a[164:167], v[168:171]
  buffer_load_dwordx4 a[112:115], v124, s[8:11], s64 offen offset:0 sc1
  v_mfma_f32_16x16x32_bf16 v[168:171], a[68:71], a[180:183], v[168:171]
  ds_read_b64_tr_b16 a[92:93], v40 offset:51272
  v_mfma_f32_16x16x32_bf16 v[168:171], a[72:75], a[196:199], v[168:171]
  ds_read_b64_tr_b16 a[94:95], v40 offset:51528
  v_mfma_f32_16x16x32_bf16 v[168:171], a[76:79], a[212:215], v[168:171]
  buffer_load_dwordx4 a[116:119], v124, s[8:11], s64 offen offset:1024 sc1
  v_mfma_f32_16x16x32_bf16 v[160:163], a[76:79], a[208:211], v[160:163]
  v_mfma_f32_16x16x32_bf16 v[160:163], a[72:75], a[192:195], v[160:163]
  buffer_load_dwordx4 a[120:123], v124, s[8:11], s64 offen offset:2048 sc1
  v_mfma_f32_16x16x32_bf16 v[160:163], a[68:71], a[176:179], v[160:163]
  v_mfma_f32_16x16x32_bf16 v[160:163], a[64:67], a[160:163], v[160:163]
  s_waitcnt lgkmcnt(6)
  v_mfma_f32_16x16x32_bf16 v[164:167], a[80:83], a[160:163], v[164:167]
  s_waitcnt lgkmcnt(4)
  v_mfma_f32_16x16x32_bf16 v[164:167], a[84:87], a[176:179], v[164:167]
  s_waitcnt lgkmcnt(2)
  ds_read_b64_tr_b16 a[64:65], v40 offset:33920
  v_mfma_f32_16x16x32_bf16 v[164:167], a[88:91], a[192:195], v[164:167]
  s_waitcnt lgkmcnt(1)
  ds_read_b64_tr_b16 a[66:67], v40 offset:34176
  v_mfma_f32_16x16x32_bf16 v[164:167], a[92:95], a[208:211], v[164:167]
  ds_read_b64_tr_b16 a[68:69], v40 offset:34432
  v_mfma_f32_16x16x32_bf16 v[172:175], a[92:95], a[212:215], v[172:175]
  buffer_load_dwordx4 a[124:127], v124, s[8:11], s64 offen offset:3072 sc1
  v_mfma_f32_16x16x32_bf16 v[172:175], a[88:91], a[196:199], v[172:175]
  ds_read_b64_tr_b16 a[70:71], v40 offset:34688
  v_mfma_f32_16x16x32_bf16 v[172:175], a[84:87], a[180:183], v[172:175]
  s_mov_b32 s66, 2097152
  ds_read_b64_tr_b16 a[72:73], v40 offset:50816
  v_mfma_f32_16x16x32_bf16 v[172:175], a[80:83], a[164:167], v[172:175]
  s_add_u32 m0, s51, 0
  ds_read_b64_tr_b16 a[74:75], v40 offset:51072
  v_mfma_f32_16x16x32_bf16 v[180:183], a[80:83], a[168:171], v[180:183]
  buffer_load_dwordx4 v32, s[20:23], s66 offen lds
  v_mfma_f32_16x16x32_bf16 v[180:183], a[84:87], a[184:187], v[180:183]
  ds_read_b64_tr_b16 a[76:77], v40 offset:51328
  v_mfma_f32_16x16x32_bf16 v[180:183], a[88:91], a[200:203], v[180:183]
  s_add_u32 m0, s51, 1056
  ds_read_b64_tr_b16 a[78:79], v40 offset:51584
  v_mfma_f32_16x16x32_bf16 v[180:183], a[92:95], a[216:219], v[180:183]
  buffer_load_dwordx4 v33, s[20:23], s66 offen lds
  v_mfma_f32_16x16x32_bf16 v[188:191], a[92:95], a[220:223], v[188:191]
  v_mfma_f32_16x16x32_bf16 v[188:191], a[88:91], a[204:207], v[188:191]
  v_mfma_f32_16x16x32_bf16 v[188:191], a[84:87], a[188:191], v[188:191]
  s_add_u32 m0, s51, 2112
  v_mfma_f32_16x16x32_bf16 v[188:191], a[80:83], a[172:175], v[188:191]
  s_waitcnt lgkmcnt(6)
  buffer_load_dwordx4 v34, s[20:23], s66 offen lds
  v_mfma_f32_16x16x32_bf16 v[216:219], a[64:67], a[172:175], v[216:219]
  s_waitcnt lgkmcnt(4)
  v_mfma_f32_16x16x32_bf16 v[216:219], a[68:71], a[188:191], v[216:219]
  s_waitcnt lgkmcnt(2)
  ds_read_b64_tr_b16 a[80:81], v40 offset:33928
  v_mfma_f32_16x16x32_bf16 v[216:219], a[72:75], a[204:207], v[216:219]
  s_waitcnt lgkmcnt(1)
  ds_read_b64_tr_b16 a[82:83], v40 offset:34184
  v_mfma_f32_16x16x32_bf16 v[216:219], a[76:79], a[220:223], v[216:219]
  s_add_u32 m0, s51, 3168
  ds_read_b64_tr_b16 a[84:85], v40 offset:34440
  v_mfma_f32_16x16x32_bf16 v[208:211], a[76:79], a[216:219], v[208:211]
  buffer_load_dwordx4 v35, s[20:23], s66 offen lds
  v_mfma_f32_16x16x32_bf16 v[208:211], a[72:75], a[200:203], v[208:211]
  ds_read_b64_tr_b16 a[86:87], v40 offset:34696
  v_mfma_f32_16x16x32_bf16 v[208:211], a[68:71], a[184:187], v[208:211]
  s_mov_b32 s66, 2621440
  ds_read_b64_tr_b16 a[88:89], v40 offset:50824
  v_mfma_f32_16x16x32_bf16 v[208:211], a[64:67], a[168:171], v[208:211]
  s_add_u32 m0, s51, 16896
  ds_read_b64_tr_b16 a[90:91], v40 offset:51080
  v_mfma_f32_16x16x32_bf16 v[200:203], a[64:67], a[164:167], v[200:203]
  buffer_load_dwordx4 v32, s[20:23], s66 offen lds
  v_mfma_f32_16x16x32_bf16 v[200:203], a[68:71], a[180:183], v[200:203]
  ds_read_b64_tr_b16 a[92:93], v40 offset:51336
  v_mfma_f32_16x16x32_bf16 v[200:203], a[72:75], a[196:199], v[200:203]
  ds_read_b64_tr_b16 a[94:95], v40 offset:51592
  v_mfma_f32_16x16x32_bf16 v[200:203], a[76:79], a[212:215], v[200:203]
  s_add_u32 m0, s51, 17952
  v_mfma_f32_16x16x32_bf16 v[192:195], a[76:79], a[208:211], v[192:195]
  buffer_load_dwordx4 v33, s[20:23], s66 offen lds
  v_mfma_f32_16x16x32_bf16 v[192:195], a[72:75], a[192:195], v[192:195]
  v_mfma_f32_16x16x32_bf16 v[192:195], a[68:71], a[176:179], v[192:195]
  v_mfma_f32_16x16x32_bf16 v[192:195], a[64:67], a[160:163], v[192:195]
  s_waitcnt lgkmcnt(6)
  v_mfma_f32_16x16x32_bf16 v[196:199], a[80:83], a[160:163], v[196:199]
  s_waitcnt lgkmcnt(4)
  v_mfma_f32_16x16x32_bf16 v[196:199], a[84:87], a[176:179], v[196:199]
  s_waitcnt lgkmcnt(2)
  ds_read_b64_tr_b16 a[64:65], v40 offset:33984
  v_mfma_f32_16x16x32_bf16 v[196:199], a[88:91], a[192:195], v[196:199]
  s_waitcnt lgkmcnt(1)
  ds_read_b64_tr_b16 a[66:67], v40 offset:34240
  v_mfma_f32_16x16x32_bf16 v[196:199], a[92:95], a[208:211], v[196:199]
  s_add_u32 m0, s51, 19008
  ds_read_b64_tr_b16 a[68:69], v40 offset:34496
  v_mfma_f32_16x16x32_bf16 v[204:207], a[92:95], a[212:215], v[204:207]
  buffer_load_dwordx4 v34, s[20:23], s66 offen lds
  v_mfma_f32_16x16x32_bf16 v[204:207], a[88:91], a[196:199], v[204:207]
  ds_read_b64_tr_b16 a[70:71], v40 offset:34752
  v_mfma_f32_16x16x32_bf16 v[204:207], a[84:87], a[180:183], v[204:207]
  ds_read_b64_tr_b16 a[72:73], v40 offset:50880
  v_mfma_f32_16x16x32_bf16 v[204:207], a[80:83], a[164:167], v[204:207]
  ds_read_b64_tr_b16 a[74:75], v40 offset:51136
  v_mfma_f32_16x16x32_bf16 v[212:215], a[80:83], a[168:171], v[212:215]
  v_mfma_f32_16x16x32_bf16 v[212:215], a[84:87], a[184:187], v[212:215]
  ds_read_b64_tr_b16 a[76:77], v40 offset:51392
  v_mfma_f32_16x16x32_bf16 v[212:215], a[88:91], a[200:203], v[212:215]
  s_add_u32 m0, s51, 20064
  ds_read_b64_tr_b16 a[78:79], v40 offset:51648
  v_mfma_f32_16x16x32_bf16 v[212:215], a[92:95], a[216:219], v[212:215]
  buffer_load_dwordx4 v35, s[20:23], s66 offen lds
  v_mfma_f32_16x16x32_bf16 v[220:223], a[92:95], a[220:223], v[220:223]
  s_mov_b32 s67, 1327104
  s_add_u32 m0, s51, 101376
  v_mfma_f32_16x16x32_bf16 v[220:223], a[88:91], a[204:207], v[220:223]
  buffer_load_dwordx4 v36, s[44:47], s67 offen lds
  v_mfma_f32_16x16x32_bf16 v[220:223], a[84:87], a[188:191], v[220:223]
  v_mfma_f32_16x16x32_bf16 v[220:223], a[80:83], a[172:175], v[220:223]
  s_waitcnt lgkmcnt(6)
  v_mfma_f32_16x16x32_bf16 v[248:251], a[64:67], a[172:175], v[248:251]
  s_waitcnt lgkmcnt(4)
  v_mfma_f32_16x16x32_bf16 v[248:251], a[68:71], a[188:191], v[248:251]
  s_waitcnt lgkmcnt(2)
  ds_read_b64_tr_b16 a[80:81], v40 offset:33992
  v_mfma_f32_16x16x32_bf16 v[248:251], a[72:75], a[204:207], v[248:251]
  s_waitcnt lgkmcnt(1)
  ds_read_b64_tr_b16 a[82:83], v40 offset:34248
  v_mfma_f32_16x16x32_bf16 v[248:251], a[76:79], a[220:223], v[248:251]
  s_add_u32 m0, s51, 102432
  ds_read_b64_tr_b16 a[84:85], v40 offset:34504
  v_mfma_f32_16x16x32_bf16 v[240:243], a[76:79], a[216:219], v[240:243]
  buffer_load_dwordx4 v37, s[44:47], s67 offen lds
  v_mfma_f32_16x16x32_bf16 v[240:243], a[72:75], a[200:203], v[240:243]
  ds_read_b64_tr_b16 a[86:87], v40 offset:34760
  v_mfma_f32_16x16x32_bf16 v[240:243], a[68:71], a[184:187], v[240:243]
  ds_read_b64_tr_b16 a[88:89], v40 offset:50888
  v_mfma_f32_16x16x32_bf16 v[240:243], a[64:67], a[168:171], v[240:243]
  s_add_u32 m0, s51, 103488
  ds_read_b64_tr_b16 a[90:91], v40 offset:51144
  v_mfma_f32_16x16x32_bf16 v[232:235], a[64:67], a[164:167], v[232:235]
  buffer_load_dwordx4 v38, s[44:47], s67 offen lds
  v_mfma_f32_16x16x32_bf16 v[232:235], a[68:71], a[180:183], v[232:235]
  ds_read_b64_tr_b16 a[92:93], v40 offset:51400
  v_mfma_f32_16x16x32_bf16 v[232:235], a[72:75], a[196:199], v[232:235]
  s_add_u32 m0, s51, 104544
  ds_read_b64_tr_b16 a[94:95], v40 offset:51656
  v_mfma_f32_16x16x32_bf16 v[232:235], a[76:79], a[212:215], v[232:235]
  buffer_load_dwordx4 v39, s[44:47], s67 offen lds
  v_mfma_f32_16x16x32_bf16 v[224:227], a[76:79], a[208:211], v[224:227]
  s_mov_b32 s67, 1548288
  v_mfma_f32_16x16x32_bf16 v[224:227], a[72:75], a[192:195], v[224:227]
  s_add_u32 m0, s51, 118272
  v_mfma_f32_16x16x32_bf16 v[224:227], a[68:71], a[176:179], v[224:227]
  s_waitcnt vmcnt(28)
  buffer_load_dwordx4 v36, s[44:47], s67 offen lds
  v_mfma_f32_16x16x32_bf16 v[224:227], a[64:67], a[160:163], v[224:227]
  s_waitcnt lgkmcnt(6)
  s_waitcnt lgkmcnt(0)
  v_mfma_f32_16x16x32_bf16 v[228:231], a[80:83], a[160:163], v[228:231]
  s_barrier
  v_mfma_f32_16x16x32_bf16 v[228:231], a[84:87], a[176:179], v[228:231]
  ds_read_b64_tr_b16 a[64:65], v41 offset:0
  v_mfma_f32_16x16x32_bf16 v[228:231], a[88:91], a[192:195], v[228:231]
  ds_read_b64_tr_b16 a[66:67], v41 offset:128
  v_mfma_f32_16x16x32_bf16 v[228:231], a[92:95], a[208:211], v[228:231]
  s_add_u32 m0, s51, 119328
  ds_read_b64_tr_b16 a[68:69], v41 offset:256
  v_mfma_f32_16x16x32_bf16 v[236:239], a[92:95], a[212:215], v[236:239]
  buffer_load_dwordx4 v37, s[44:47], s67 offen lds
  v_mfma_f32_16x16x32_bf16 v[236:239], a[88:91], a[196:199], v[236:239]
  ds_read_b64_tr_b16 a[70:71], v41 offset:384
  v_mfma_f32_16x16x32_bf16 v[236:239], a[84:87], a[180:183], v[236:239]
  ds_read_b64_tr_b16 a[72:73], v41 offset:16896
  v_mfma_f32_16x16x32_bf16 v[236:239], a[80:83], a[164:167], v[236:239]
  s_add_u32 m0, s51, 120384
  ds_read_b64_tr_b16 a[74:75], v41 offset:17024
  v_mfma_f32_16x16x32_bf16 v[244:247], a[80:83], a[168:171], v[244:247]
  buffer_load_dwordx4 v38, s[44:47], s67 offen lds
  v_mfma_f32_16x16x32_bf16 v[244:247], a[84:87], a[184:187], v[244:247]
  ds_read_b64_tr_b16 a[76:77], v41 offset:17152
  v_mfma_f32_16x16x32_bf16 v[244:247], a[88:91], a[200:203], v[244:247]
  ds_read_b64_tr_b16 a[78:79], v41 offset:17280
  v_mfma_f32_16x16x32_bf16 v[244:247], a[92:95], a[216:219], v[244:247]
  s_add_u32 m0, s51, 121440
  v_mfma_f32_16x16x32_bf16 v[252:255], a[92:95], a[220:223], v[252:255]
  buffer_load_dwordx4 v39, s[44:47], s67 offen lds
  v_mfma_f32_16x16x32_bf16 v[252:255], a[88:91], a[204:207], v[252:255]
  v_mfma_f32_16x16x32_bf16 v[252:255], a[84:87], a[188:191], v[252:255]
  s_waitcnt vmcnt(16)
  v_mfma_f32_16x16x32_bf16 v[252:255], a[80:83], a[172:175], v[252:255]
  s_waitcnt lgkmcnt(6)
  s_add_u32 s64, s63, 49152
  v_mfma_f32_16x16x32_bf16 v[60:63], a[64:67], a[236:239], v[60:63]
  s_waitcnt lgkmcnt(4)
  buffer_load_dwordx4 a[128:131], v1, s[8:11], s64 offen offset:0 sc1
  v_mfma_f32_16x16x32_bf16 v[60:63], a[68:71], a[252:255], v[60:63]
  s_waitcnt lgkmcnt(2)
  ds_read_b64_tr_b16 a[80:81], v41 offset:8448
  v_mfma_f32_16x16x32_bf16 v[60:63], a[72:75], a[108:111], v[60:63]
  s_waitcnt lgkmcnt(1)
  ds_read_b64_tr_b16 a[82:83], v41 offset:8576
  v_mfma_f32_16x16x32_bf16 v[60:63], a[76:79], a[124:127], v[60:63]
  ds_read_b64_tr_b16 a[84:85], v41 offset:8704
  v_mfma_f32_16x16x32_bf16 v[56:59], a[76:79], a[120:123], v[56:59]
  v_mfma_f32_16x16x32_bf16 v[56:59], a[72:75], a[104:107], v[56:59]
  ds_read_b64_tr_b16 a[86:87], v41 offset:8832
  v_mfma_f32_16x16x32_bf16 v[56:59], a[68:71], a[248:251], v[56:59]
  ds_read_b64_tr_b16 a[88:89], v41 offset:25344
  v_mfma_f32_16x16x32_bf16 v[56:59], a[64:67], a[232:235], v[56:59]
  ds_read_b64_tr_b16 a[90:91], v41 offset:25472
  v_mfma_f32_16x16x32_bf16 v[52:55], a[64:67], a[228:231], v[52:55]
  buffer_load_dwordx4 a[132:135], v1, s[8:11], s64 offen offset:1024 sc1
  v_mfma_f32_16x16x32_bf16 v[52:55], a[68:71], a[244:247], v[52:55]
  ds_read_b64_tr_b16 a[92:93], v41 offset:25600
  v_mfma_f32_16x16x32_bf16 v[52:55], a[72:75], a[100:103], v[52:55]
  ds_read_b64_tr_b16 a[94:95], v41 offset:25728
  v_mfma_f32_16x16x32_bf16 v[52:55], a[76:79], a[116:119], v[52:55]
  v_mfma_f32_16x16x32_bf16 v[48:51], a[76:79], a[112:115], v[48:51]
  buffer_load_dwordx4 a[136:139], v1, s[8:11], s64 offen offset:2048 sc1
  v_mfma_f32_16x16x32_bf16 v[48:51], a[72:75], a[96:99], v[48:51]
  v_mfma_f32_16x16x32_bf16 v[48:51], a[68:71], a[240:243], v[48:51]
  v_mfma_f32_16x16x32_bf16 v[48:51], a[64:67], a[224:227], v[48:51]
  s_waitcnt lgkmcnt(6)
  v_mfma_f32_16x16x32_bf16 a[0:3], a[80:83], a[224:227], a[0:3]
  s_waitcnt lgkmcnt(4)
  buffer_load_dwordx4 a[140:143], v1, s[8:11], s64 offen offset:3072 sc1
  v_mfma_f32_16x16x32_bf16 a[0:3], a[84:87], a[240:243], a[0:3]
  s_waitcnt lgkmcnt(2)
  ds_read_b64_tr_b16 a[64:65], v41 offset:32
  v_mfma_f32_16x16x32_bf16 a[0:3], a[88:91], a[96:99], a[0:3]
  s_waitcnt lgkmcnt(1)
  ds_read_b64_tr_b16 a[66:67], v41 offset:160
  v_mfma_f32_16x16x32_bf16 a[0:3], a[92:95], a[112:115], a[0:3]
  ds_read_b64_tr_b16 a[68:69], v41 offset:288
  v_mfma_f32_16x16x32_bf16 a[4:7], a[92:95], a[116:119], a[4:7]
  v_mfma_f32_16x16x32_bf16 a[4:7], a[88:91], a[100:103], a[4:7]
  ds_read_b64_tr_b16 a[70:71], v41 offset:416
  v_mfma_f32_16x16x32_bf16 a[4:7], a[84:87], a[244:247], a[4:7]
  ds_read_b64_tr_b16 a[72:73], v41 offset:16928
  v_mfma_f32_16x16x32_bf16 a[4:7], a[80:83], a[228:231], a[4:7]
  ds_read_b64_tr_b16 a[74:75], v41 offset:17056
  v_mfma_f32_16x16x32_bf16 a[8:11], a[80:83], a[232:235], a[8:11]
  buffer_load_dwordx4 a[144:147], v124, s[8:11], s64 offen offset:0 sc1
  v_mfma_f32_16x16x32_bf16 a[8:11], a[84:87], a[248:251], a[8:11]
  ds_read_b64_tr_b16 a[76:77], v41 offset:17184
  v_mfma_f32_16x16x32_bf16 a[8:11], a[88:91], a[104:107], a[8:11]
  ds_read_b64_tr_b16 a[78:79], v41 offset:17312
  v_mfma_f32_16x16x32_bf16 a[8:11], a[92:95], a[120:123], a[8:11]
  buffer_load_dwordx4 a[148:151], v124, s[8:11], s64 offen offset:1024 sc1
  v_mfma_f32_16x16x32_bf16 a[12:15], a[92:95], a[124:127], a[12:15]
  v_mfma_f32_16x16x32_bf16 a[12:15], a[88:91], a[108:111], a[12:15]
  buffer_load_dwordx4 a[152:155], v124, s[8:11], s64 offen offset:2048 sc1
  v_mfma_f32_16x16x32_bf16 a[12:15], a[84:87], a[252:255], a[12:15]
  v_mfma_f32_16x16x32_bf16 a[12:15], a[80:83], a[236:239], a[12:15]
  s_waitcnt lgkmcnt(6)
  v_mfma_f32_16x16x32_bf16 v[76:79], a[64:67], a[236:239], v[76:79]
  s_waitcnt lgkmcnt(4)
  v_mfma_f32_16x16x32_bf16 v[76:79], a[68:71], a[252:255], v[76:79]
  s_waitcnt lgkmcnt(2)
  ds_read_b64_tr_b16 a[80:81], v41 offset:8480
  v_mfma_f32_16x16x32_bf16 v[76:79], a[72:75], a[108:111], v[76:79]
  s_waitcnt lgkmcnt(1)
  ds_read_b64_tr_b16 a[82:83], v41 offset:8608
  v_mfma_f32_16x16x32_bf16 v[76:79], a[76:79], a[124:127], v[76:79]
  ds_read_b64_tr_b16 a[84:85], v41 offset:8736
  v_mfma_f32_16x16x32_bf16 v[72:75], a[76:79], a[120:123], v[72:75]
  buffer_load_dwordx4 a[156:159], v124, s[8:11], s64 offen offset:3072 sc1
  v_mfma_f32_16x16x32_bf16 v[72:75], a[72:75], a[104:107], v[72:75]
  ds_read_b64_tr_b16 a[86:87], v41 offset:8864
  v_mfma_f32_16x16x32_bf16 v[72:75], a[68:71], a[248:251], v[72:75]
  ds_read_b64_tr_b16 a[88:89], v41 offset:25376
  v_mfma_f32_16x16x32_bf16 v[72:75], a[64:67], a[232:235], v[72:75]
  s_add_u32 s64, s63, 57344
  ds_read_b64_tr_b16 a[90:91], v41 offset:25504
  v_mfma_f32_16x16x32_bf16 v[68:71], a[64:67], a[228:231], v[68:71]
  buffer_load_dwordx4 a[160:163], v1, s[8:11], s64 offen offset:0 sc1
  v_mfma_f32_16x16x32_bf16 v[68:71], a[68:71], a[244:247], v[68:71]
  ds_read_b64_tr_b16 a[92:93], v41 offset:25632
  v_mfma_f32_16x16x32_bf16 v[68:71], a[72:75], a[100:103], v[68:71]
  ds_read_b64_tr_b16 a[94:95], v41 offset:25760
  v_mfma_f32_16x16x32_bf16 v[68:71], a[76:79], a[116:119], v[68:71]
  buffer_load_dwordx4 a[164:167], v1, s[8:11], s64 offen offset:1024 sc1
  v_mfma_f32_16x16x32_bf16 v[64:67], a[76:79], a[112:115], v[64:67]
  v_mfma_f32_16x16x32_bf16 v[64:67], a[72:75], a[96:99], v[64:67]
  v_mfma_f32_16x16x32_bf16 v[64:67], a[68:71], a[240:243], v[64:67]
  v_mfma_f32_16x16x32_bf16 v[64:67], a[64:67], a[224:227], v[64:67]
  s_waitcnt lgkmcnt(6)
  buffer_load_dwordx4 a[168:171], v1, s[8:11], s64 offen offset:2048 sc1
  v_mfma_f32_16x16x32_bf16 a[16:19], a[80:83], a[224:227], a[16:19]
  s_waitcnt lgkmcnt(4)
  v_mfma_f32_16x16x32_bf16 a[16:19], a[84:87], a[240:243], a[16:19]
  s_waitcnt lgkmcnt(2)
  ds_read_b64_tr_b16 a[64:65], v41 offset:64
  v_mfma_f32_16x16x32_bf16 a[16:19], a[88:91], a[96:99], a[16:19]
  s_waitcnt lgkmcnt(1)
  ds_read_b64_tr_b16 a[66:67], v41 offset:192
  v_mfma_f32_16x16x32_bf16 a[16:19], a[92:95], a[112:115], a[16:19]
  ds_read_b64_tr_b16 a[68:69], v41 offset:320
  v_mfma_f32_16x16x32_bf16 a[20:23], a[92:95], a[116:119], a[20:23]
  buffer_load_dwordx4 a[172:175], v1, s[8:11], s64 offen offset:3072 sc1
  v_mfma_f32_16x16x32_bf16 a[20:23], a[88:91], a[100:103], a[20:23]
  ds_read_b64_tr_b16 a[70:71], v41 offset:448
  v_mfma_f32_16x16x32_bf16 a[20:23], a[84:87], a[244:247], a[20:23]
  ds_read_b64_tr_b16 a[72:73], v41 offset:16960
  v_mfma_f32_16x16x32_bf16 a[20:23], a[80:83], a[228:231], a[20:23]
  ds_read_b64_tr_b16 a[74:75], v41 offset:17088
  v_mfma_f32_16x16x32_bf16 a[24:27], a[80:83], a[232:235], a[24:27]
  v_mfma_f32_16x16x32_bf16 a[24:27], a[84:87], a[248:251], a[24:27]
  ds_read_b64_tr_b16 a[76:77], v41 offset:17216
  v_mfma_f32_16x16x32_bf16 a[24:27], a[88:91], a[104:107], a[24:27]
  ds_read_b64_tr_b16 a[78:79], v41 offset:17344
  v_mfma_f32_16x16x32_bf16 a[24:27], a[92:95], a[120:123], a[24:27]
  buffer_load_dwordx4 a[176:179], v124, s[8:11], s64 offen offset:0 sc1
  v_mfma_f32_16x16x32_bf16 a[28:31], a[92:95], a[124:127], a[28:31]
  v_mfma_f32_16x16x32_bf16 a[28:31], a[88:91], a[108:111], a[28:31]
  buffer_load_dwordx4 a[180:183], v124, s[8:11], s64 offen offset:1024 sc1
  v_mfma_f32_16x16x32_bf16 a[28:31], a[84:87], a[252:255], a[28:31]
  v_mfma_f32_16x16x32_bf16 a[28:31], a[80:83], a[236:239], a[28:31]
  s_waitcnt lgkmcnt(6)
  v_mfma_f32_16x16x32_bf16 v[92:95], a[64:67], a[236:239], v[92:95]
  s_waitcnt lgkmcnt(4)
  v_mfma_f32_16x16x32_bf16 v[92:95], a[68:71], a[252:255], v[92:95]
  s_waitcnt lgkmcnt(2)
  ds_read_b64_tr_b16 a[80:81], v41 offset:8512
  v_mfma_f32_16x16x32_bf16 v[92:95], a[72:75], a[108:111], v[92:95]
  s_waitcnt lgkmcnt(1)
  ds_read_b64_tr_b16 a[82:83], v41 offset:8640
  v_mfma_f32_16x16x32_bf16 v[92:95], a[76:79], a[124:127], v[92:95]
  ds_read_b64_tr_b16 a[84:85], v41 offset:8768
  v_mfma_f32_16x16x32_bf16 v[88:91], a[76:79], a[120:123], v[88:91]
  buffer_load_dwordx4 a[184:187], v124, s[8:11], s64 offen offset:2048 sc1
  v_mfma_f32_16x16x32_bf16 v[88:91], a[72:75], a[104:107], v[88:91]
  ds_read_b64_tr_b16 a[86:87], v41 offset:8896
  v_mfma_f32_16x16x32_bf16 v[88:91], a[68:71], a[248:251], v[88:91]
  ds_read_b64_tr_b16 a[88:89], v41 offset:25408
  v_mfma_f32_16x16x32_bf16 v[88:91], a[64:67], a[232:235], v[88:91]
  ds_read_b64_tr_b16 a[90:91], v41 offset:25536
  v_mfma_f32_16x16x32_bf16 v[84:87], a[64:67], a[228:231], v[84:87]
  v_mfma_f32_16x16x32_bf16 v[84:87], a[68:71], a[244:247], v[84:87]
  ds_read_b64_tr_b16 a[92:93], v41 offset:25664
  v_mfma_f32_16x16x32_bf16 v[84:87], a[72:75], a[100:103], v[84:87]
  ds_read_b64_tr_b16 a[94:95], v41 offset:25792
  v_mfma_f32_16x16x32_bf16 v[84:87], a[76:79], a[116:119], v[84:87]
  buffer_load_dwordx4 a[188:191], v124, s[8:11], s64 offen offset:3072 sc1
  v_mfma_f32_16x16x32_bf16 v[80:83], a[76:79], a[112:115], v[80:83]
  s_add_u32 s64, s63, 65536
  v_mfma_f32_16x16x32_bf16 v[80:83], a[72:75], a[96:99], v[80:83]
  buffer_load_dwordx4 a[192:195], v1, s[8:11], s64 offen offset:0 sc1
  v_mfma_f32_16x16x32_bf16 v[80:83], a[68:71], a[240:243], v[80:83]
  v_mfma_f32_16x16x32_bf16 v[80:83], a[64:67], a[224:227], v[80:83]
  s_waitcnt lgkmcnt(6)
  v_mfma_f32_16x16x32_bf16 a[32:35], a[80:83], a[224:227], a[32:35]
  s_waitcnt lgkmcnt(4)
  v_mfma_f32_16x16x32_bf16 a[32:35], a[84:87], a[240:243], a[32:35]
  s_waitcnt lgkmcnt(2)
  ds_read_b64_tr_b16 a[64:65], v41 offset:96
  v_mfma_f32_16x16x32_bf16 a[32:35], a[88:91], a[96:99], a[32:35]
  s_waitcnt lgkmcnt(1)
  ds_read_b64_tr_b16 a[66:67], v41 offset:224
  v_mfma_f32_16x16x32_bf16 a[32:35], a[92:95], a[112:115], a[32:35]
  ds_read_b64_tr_b16 a[68:69], v41 offset:352
  v_mfma_f32_16x16x32_bf16 a[36:39], a[92:95], a[116:119], a[36:39]
  buffer_load_dwordx4 a[196:199], v1, s[8:11], s64 offen offset:1024 sc1
  v_mfma_f32_16x16x32_bf16 a[36:39], a[88:91], a[100:103], a[36:39]
  ds_read_b64_tr_b16 a[70:71], v41 offset:480
  v_mfma_f32_16x16x32_bf16 a[36:39], a[84:87], a[244:247], a[36:39]
  ds_read_b64_tr_b16 a[72:73], v41 offset:16992
  v_mfma_f32_16x16x32_bf16 a[36:39], a[80:83], a[228:231], a[36:39]
  ds_read_b64_tr_b16 a[74:75], v41 offset:17120
  v_mfma_f32_16x16x32_bf16 a[40:43], a[80:83], a[232:235], a[40:43]
  buffer_load_dwordx4 a[200:203], v1, s[8:11], s64 offen offset:2048 sc1
  v_mfma_f32_16x16x32_bf16 a[40:43], a[84:87], a[248:251], a[40:43]
  ds_read_b64_tr_b16 a[76:77], v41 offset:17248
  v_mfma_f32_16x16x32_bf16 a[40:43], a[88:91], a[104:107], a[40:43]
  ds_read_b64_tr_b16 a[78:79], v41 offset:17376
  v_mfma_f32_16x16x32_bf16 a[40:43], a[92:95], a[120:123], a[40:43]
  buffer_load_dwordx4 a[204:207], v1, s[8:11], s64 offen offset:3072 sc1
  v_mfma_f32_16x16x32_bf16 a[44:47], a[92:95], a[124:127], a[44:47]
  v_mfma_f32_16x16x32_bf16 a[44:47], a[88:91], a[108:111], a[44:47]
  v_mfma_f32_16x16x32_bf16 a[44:47], a[84:87], a[252:255], a[44:47]
  buffer_load_dwordx4 a[208:211], v124, s[8:11], s64 offen offset:0 sc1
  v_mfma_f32_16x16x32_bf16 a[44:47], a[80:83], a[236:239], a[44:47]
  s_waitcnt lgkmcnt(6)
  s_mul_i32 s65, s80, 8
  s_mul_i32 s38, s80, 10
  s_sub_u32 s65, s65, s77
  v_mfma_f32_16x16x32_bf16 v[108:111], a[64:67], a[236:239], v[108:111]
  s_waitcnt lgkmcnt(4)
  buffer_load_dword v10, v46, s[36:39], s65 offen
  v_mfma_f32_16x16x32_bf16 v[108:111], a[68:71], a[252:255], v[108:111]
  s_waitcnt lgkmcnt(2)
  ds_read_b64_tr_b16 a[80:81], v41 offset:8544
  v_mfma_f32_16x16x32_bf16 v[108:111], a[72:75], a[108:111], v[108:111]
  s_waitcnt lgkmcnt(1)
  ds_read_b64_tr_b16 a[82:83], v41 offset:8672
  v_mfma_f32_16x16x32_bf16 v[108:111], a[76:79], a[124:127], v[108:111]
  ds_read_b64_tr_b16 a[84:85], v41 offset:8800
  v_mfma_f32_16x16x32_bf16 v[104:107], a[76:79], a[120:123], v[104:107]
  v_mfma_f32_16x16x32_bf16 v[104:107], a[72:75], a[104:107], v[104:107]
  ds_read_b64_tr_b16 a[86:87], v41 offset:8928
  v_mfma_f32_16x16x32_bf16 v[104:107], a[68:71], a[248:251], v[104:107]
  ds_read_b64_tr_b16 a[88:89], v41 offset:25440
  v_mfma_f32_16x16x32_bf16 v[104:107], a[64:67], a[232:235], v[104:107]
  ds_read_b64_tr_b16 a[90:91], v41 offset:25568
  v_mfma_f32_16x16x32_bf16 v[100:103], a[64:67], a[228:231], v[100:103]
  v_mfma_f32_16x16x32_bf16 v[100:103], a[68:71], a[244:247], v[100:103]
  ds_read_b64_tr_b16 a[92:93], v41 offset:25696
  v_mfma_f32_16x16x32_bf16 v[100:103], a[72:75], a[100:103], v[100:103]
  ds_read_b64_tr_b16 a[94:95], v41 offset:25824
  v_mfma_f32_16x16x32_bf16 v[100:103], a[76:79], a[116:119], v[100:103]
  v_mfma_f32_16x16x32_bf16 v[96:99], a[76:79], a[112:115], v[96:99]
  v_mfma_f32_16x16x32_bf16 v[96:99], a[72:75], a[96:99], v[96:99]
  v_mfma_f32_16x16x32_bf16 v[96:99], a[68:71], a[240:243], v[96:99]
  s_waitcnt vmcnt(30)
  v_mfma_f32_16x16x32_bf16 v[96:99], a[64:67], a[224:227], v[96:99]
  s_waitcnt lgkmcnt(6)
  s_waitcnt lgkmcnt(0)
  v_mfma_f32_16x16x32_bf16 a[48:51], a[80:83], a[224:227], a[48:51]
  s_barrier
  v_mfma_f32_16x16x32_bf16 a[48:51], a[84:87], a[240:243], a[48:51]
  ds_read_b64_tr_b16 a[64:65], v40 offset:0
  v_mfma_f32_16x16x32_bf16 a[48:51], a[88:91], a[96:99], a[48:51]
  ds_read_b64_tr_b16 a[66:67], v40 offset:256
  v_mfma_f32_16x16x32_bf16 a[48:51], a[92:95], a[112:115], a[48:51]
  ds_read_b64_tr_b16 a[68:69], v40 offset:512
  v_mfma_f32_16x16x32_bf16 a[52:55], a[92:95], a[116:119], a[52:55]
  v_mfma_f32_16x16x32_bf16 a[52:55], a[88:91], a[100:103], a[52:55]
  ds_read_b64_tr_b16 a[70:71], v40 offset:768
  v_mfma_f32_16x16x32_bf16 a[52:55], a[84:87], a[244:247], a[52:55]
  ds_read_b64_tr_b16 a[72:73], v40 offset:16896
  v_mfma_f32_16x16x32_bf16 a[52:55], a[80:83], a[228:231], a[52:55]
  ds_read_b64_tr_b16 a[74:75], v40 offset:17152
  v_mfma_f32_16x16x32_bf16 a[56:59], a[80:83], a[232:235], a[56:59]
  v_mfma_f32_16x16x32_bf16 a[56:59], a[84:87], a[248:251], a[56:59]
  ds_read_b64_tr_b16 a[76:77], v40 offset:17408
  v_mfma_f32_16x16x32_bf16 a[56:59], a[88:91], a[104:107], a[56:59]
  ds_read_b64_tr_b16 a[78:79], v40 offset:17664
  v_mfma_f32_16x16x32_bf16 a[56:59], a[92:95], a[120:123], a[56:59]
  v_mfma_f32_16x16x32_bf16 a[60:63], a[92:95], a[124:127], a[60:63]
  v_mfma_f32_16x16x32_bf16 a[60:63], a[88:91], a[108:111], a[60:63]
  v_mfma_f32_16x16x32_bf16 a[60:63], a[84:87], a[252:255], a[60:63]
  v_mfma_f32_16x16x32_bf16 a[60:63], a[80:83], a[236:239], a[60:63]
  s_waitcnt lgkmcnt(6)
  v_mfma_f32_16x16x32_bf16 v[152:155], a[64:67], a[236:239], v[152:155]
  s_waitcnt lgkmcnt(4)
  v_mfma_f32_16x16x32_bf16 v[152:155], a[68:71], a[252:255], v[152:155]
  s_waitcnt lgkmcnt(2)
  ds_read_b64_tr_b16 a[80:81], v40 offset:8
  v_mfma_f32_16x16x32_bf16 v[152:155], a[72:75], a[108:111], v[152:155]
  s_waitcnt lgkmcnt(1)
  ds_read_b64_tr_b16 a[82:83], v40 offset:264
  v_mfma_f32_16x16x32_bf16 v[152:155], a[76:79], a[124:127], v[152:155]
  ds_read_b64_tr_b16 a[84:85], v40 offset:520
  v_mfma_f32_16x16x32_bf16 v[144:147], a[76:79], a[120:123], v[144:147]
  v_mfma_f32_16x16x32_bf16 v[144:147], a[72:75], a[104:107], v[144:147]
  ds_read_b64_tr_b16 a[86:87], v40 offset:776
  v_mfma_f32_16x16x32_bf16 v[144:147], a[68:71], a[248:251], v[144:147]
  ds_read_b64_tr_b16 a[88:89], v40 offset:16904
  v_mfma_f32_16x16x32_bf16 v[144:147], a[64:67], a[232:235], v[144:147]
  ds_read_b64_tr_b16 a[90:91], v40 offset:17160
  v_mfma_f32_16x16x32_bf16 v[136:139], a[64:67], a[228:231], v[136:139]
  v_mfma_f32_16x16x32_bf16 v[136:139], a[68:71], a[244:247], v[136:139]
  ds_read_b64_tr_b16 a[92:93], v40 offset:17416
  v_mfma_f32_16x16x32_bf16 v[136:139], a[72:75], a[100:103], v[136:139]
  ds_read_b64_tr_b16 a[94:95], v40 offset:17672
  v_mfma_f32_16x16x32_bf16 v[136:139], a[76:79], a[116:119], v[136:139]
  v_mfma_f32_16x16x32_bf16 v[128:131], a[76:79], a[112:115], v[128:131]
  v_mfma_f32_16x16x32_bf16 v[128:131], a[72:75], a[96:99], v[128:131]
  v_mfma_f32_16x16x32_bf16 v[128:131], a[68:71], a[240:243], v[128:131]
  v_mfma_f32_16x16x32_bf16 v[128:131], a[64:67], a[224:227], v[128:131]
  s_waitcnt lgkmcnt(6)
  v_mfma_f32_16x16x32_bf16 v[132:135], a[80:83], a[224:227], v[132:135]
  s_waitcnt lgkmcnt(4)
  v_mfma_f32_16x16x32_bf16 v[132:135], a[84:87], a[240:243], v[132:135]
  s_waitcnt lgkmcnt(2)
  ds_read_b64_tr_b16 a[64:65], v40 offset:64
  v_mfma_f32_16x16x32_bf16 v[132:135], a[88:91], a[96:99], v[132:135]
  s_waitcnt lgkmcnt(1)
  ds_read_b64_tr_b16 a[66:67], v40 offset:320
  v_mfma_f32_16x16x32_bf16 v[132:135], a[92:95], a[112:115], v[132:135]
  ds_read_b64_tr_b16 a[68:69], v40 offset:576
  v_mfma_f32_16x16x32_bf16 v[140:143], a[92:95], a[116:119], v[140:143]
  v_mfma_f32_16x16x32_bf16 v[140:143], a[88:91], a[100:103], v[140:143]
  ds_read_b64_tr_b16 a[70:71], v40 offset:832
  v_mfma_f32_16x16x32_bf16 v[140:143], a[84:87], a[244:247], v[140:143]
  ds_read_b64_tr_b16 a[72:73], v40 offset:16960
  v_mfma_f32_16x16x32_bf16 v[140:143], a[80:83], a[228:231], v[140:143]
  ds_read_b64_tr_b16 a[74:75], v40 offset:17216
  v_mfma_f32_16x16x32_bf16 v[148:151], a[80:83], a[232:235], v[148:151]
  v_mfma_f32_16x16x32_bf16 v[148:151], a[84:87], a[248:251], v[148:151]
  ds_read_b64_tr_b16 a[76:77], v40 offset:17472
  v_mfma_f32_16x16x32_bf16 v[148:151], a[88:91], a[104:107], v[148:151]
  ds_read_b64_tr_b16 a[78:79], v40 offset:17728
  v_mfma_f32_16x16x32_bf16 v[148:151], a[92:95], a[120:123], v[148:151]
  v_mfma_f32_16x16x32_bf16 v[156:159], a[92:95], a[124:127], v[156:159]
  v_mfma_f32_16x16x32_bf16 v[156:159], a[88:91], a[108:111], v[156:159]
  v_mfma_f32_16x16x32_bf16 v[156:159], a[84:87], a[252:255], v[156:159]
  v_mfma_f32_16x16x32_bf16 v[156:159], a[80:83], a[236:239], v[156:159]
  s_waitcnt lgkmcnt(6)
  v_mfma_f32_16x16x32_bf16 v[184:187], a[64:67], a[236:239], v[184:187]
  s_waitcnt lgkmcnt(4)
  v_mfma_f32_16x16x32_bf16 v[184:187], a[68:71], a[252:255], v[184:187]
  s_waitcnt lgkmcnt(2)
  ds_read_b64_tr_b16 a[80:81], v40 offset:72
  v_mfma_f32_16x16x32_bf16 v[184:187], a[72:75], a[108:111], v[184:187]
  s_waitcnt lgkmcnt(1)
  ds_read_b64_tr_b16 a[82:83], v40 offset:328
  v_mfma_f32_16x16x32_bf16 v[184:187], a[76:79], a[124:127], v[184:187]
  ds_read_b64_tr_b16 a[84:85], v40 offset:584
  v_mfma_f32_16x16x32_bf16 v[176:179], a[76:79], a[120:123], v[176:179]
  v_mfma_f32_16x16x32_bf16 v[176:179], a[72:75], a[104:107], v[176:179]
  ds_read_b64_tr_b16 a[86:87], v40 offset:840
  v_mfma_f32_16x16x32_bf16 v[176:179], a[68:71], a[248:251], v[176:179]
  ds_read_b64_tr_b16 a[88:89], v40 offset:16968
  v_mfma_f32_16x16x32_bf16 v[176:179], a[64:67], a[232:235], v[176:179]
  ds_read_b64_tr_b16 a[90:91], v40 offset:17224
  v_mfma_f32_16x16x32_bf16 v[168:171], a[64:67], a[228:231], v[168:171]
  v_mfma_f32_16x16x32_bf16 v[168:171], a[68:71], a[244:247], v[168:171]
  ds_read_b64_tr_b16 a[92:93], v40 offset:17480
  v_mfma_f32_16x16x32_bf16 v[168:171], a[72:75], a[100:103], v[168:171]
  ds_read_b64_tr_b16 a[94:95], v40 offset:17736
  v_mfma_f32_16x16x32_bf16 v[168:171], a[76:79], a[116:119], v[168:171]
  v_mfma_f32_16x16x32_bf16 v[160:163], a[76:79], a[112:115], v[160:163]
  v_mfma_f32_16x16x32_bf16 v[160:163], a[72:75], a[96:99], v[160:163]
  v_mfma_f32_16x16x32_bf16 v[160:163], a[68:71], a[240:243], v[160:163]
  v_mfma_f32_16x16x32_bf16 v[160:163], a[64:67], a[224:227], v[160:163]
  s_waitcnt lgkmcnt(6)
  v_mfma_f32_16x16x32_bf16 v[164:167], a[80:83], a[224:227], v[164:167]
  s_waitcnt lgkmcnt(4)
  v_mfma_f32_16x16x32_bf16 v[164:167], a[84:87], a[240:243], v[164:167]
  s_waitcnt lgkmcnt(2)
  ds_read_b64_tr_b16 a[64:65], v40 offset:128
  v_mfma_f32_16x16x32_bf16 v[164:167], a[88:91], a[96:99], v[164:167]
  s_waitcnt lgkmcnt(1)
  ds_read_b64_tr_b16 a[66:67], v40 offset:384
  v_mfma_f32_16x16x32_bf16 v[164:167], a[92:95], a[112:115], v[164:167]
  ds_read_b64_tr_b16 a[68:69], v40 offset:640
  v_mfma_f32_16x16x32_bf16 v[172:175], a[92:95], a[116:119], v[172:175]
  v_mfma_f32_16x16x32_bf16 v[172:175], a[88:91], a[100:103], v[172:175]
  ds_read_b64_tr_b16 a[70:71], v40 offset:896
  v_mfma_f32_16x16x32_bf16 v[172:175], a[84:87], a[244:247], v[172:175]
  ds_read_b64_tr_b16 a[72:73], v40 offset:17024
  v_mfma_f32_16x16x32_bf16 v[172:175], a[80:83], a[228:231], v[172:175]
  ds_read_b64_tr_b16 a[74:75], v40 offset:17280
  v_mfma_f32_16x16x32_bf16 v[180:183], a[80:83], a[232:235], v[180:183]
  v_mfma_f32_16x16x32_bf16 v[180:183], a[84:87], a[248:251], v[180:183]
  ds_read_b64_tr_b16 a[76:77], v40 offset:17536
  v_mfma_f32_16x16x32_bf16 v[180:183], a[88:91], a[104:107], v[180:183]
  ds_read_b64_tr_b16 a[78:79], v40 offset:17792
  v_mfma_f32_16x16x32_bf16 v[180:183], a[92:95], a[120:123], v[180:183]
  v_mfma_f32_16x16x32_bf16 v[188:191], a[92:95], a[124:127], v[188:191]
  v_mfma_f32_16x16x32_bf16 v[188:191], a[88:91], a[108:111], v[188:191]
  v_mfma_f32_16x16x32_bf16 v[188:191], a[84:87], a[252:255], v[188:191]
  v_mfma_f32_16x16x32_bf16 v[188:191], a[80:83], a[236:239], v[188:191]
  s_waitcnt lgkmcnt(6)
  v_mfma_f32_16x16x32_bf16 v[216:219], a[64:67], a[236:239], v[216:219]
  s_waitcnt lgkmcnt(4)
  v_mfma_f32_16x16x32_bf16 v[216:219], a[68:71], a[252:255], v[216:219]
  s_waitcnt lgkmcnt(2)
  ds_read_b64_tr_b16 a[80:81], v40 offset:136
  v_mfma_f32_16x16x32_bf16 v[216:219], a[72:75], a[108:111], v[216:219]
  s_waitcnt lgkmcnt(1)
  ds_read_b64_tr_b16 a[82:83], v40 offset:392
  v_mfma_f32_16x16x32_bf16 v[216:219], a[76:79], a[124:127], v[216:219]
  ds_read_b64_tr_b16 a[84:85], v40 offset:648
  v_mfma_f32_16x16x32_bf16 v[208:211], a[76:79], a[120:123], v[208:211]
  v_mfma_f32_16x16x32_bf16 v[208:211], a[72:75], a[104:107], v[208:211]
  ds_read_b64_tr_b16 a[86:87], v40 offset:904
  v_mfma_f32_16x16x32_bf16 v[208:211], a[68:71], a[248:251], v[208:211]
  ds_read_b64_tr_b16 a[88:89], v40 offset:17032
  v_mfma_f32_16x16x32_bf16 v[208:211], a[64:67], a[232:235], v[208:211]
  ds_read_b64_tr_b16 a[90:91], v40 offset:17288
  v_mfma_f32_16x16x32_bf16 v[200:203], a[64:67], a[228:231], v[200:203]
  v_mfma_f32_16x16x32_bf16 v[200:203], a[68:71], a[244:247], v[200:203]
  ds_read_b64_tr_b16 a[92:93], v40 offset:17544
  v_mfma_f32_16x16x32_bf16 v[200:203], a[72:75], a[100:103], v[200:203]
  ds_read_b64_tr_b16 a[94:95], v40 offset:17800
  v_mfma_f32_16x16x32_bf16 v[200:203], a[76:79], a[116:119], v[200:203]
  v_mfma_f32_16x16x32_bf16 v[192:195], a[76:79], a[112:115], v[192:195]
  v_mfma_f32_16x16x32_bf16 v[192:195], a[72:75], a[96:99], v[192:195]
  v_mfma_f32_16x16x32_bf16 v[192:195], a[68:71], a[240:243], v[192:195]
  v_mfma_f32_16x16x32_bf16 v[192:195], a[64:67], a[224:227], v[192:195]
  s_waitcnt lgkmcnt(6)
  v_mfma_f32_16x16x32_bf16 v[196:199], a[80:83], a[224:227], v[196:199]
  s_waitcnt lgkmcnt(4)
  v_mfma_f32_16x16x32_bf16 v[196:199], a[84:87], a[240:243], v[196:199]
  s_waitcnt lgkmcnt(2)
  ds_read_b64_tr_b16 a[64:65], v40 offset:192
  v_mfma_f32_16x16x32_bf16 v[196:199], a[88:91], a[96:99], v[196:199]
  s_waitcnt lgkmcnt(1)
  ds_read_b64_tr_b16 a[66:67], v40 offset:448
  v_mfma_f32_16x16x32_bf16 v[196:199], a[92:95], a[112:115], v[196:199]
  ds_read_b64_tr_b16 a[68:69], v40 offset:704
  v_mfma_f32_16x16x32_bf16 v[204:207], a[92:95], a[116:119], v[204:207]
  v_mfma_f32_16x16x32_bf16 v[204:207], a[88:91], a[100:103], v[204:207]
  ds_read_b64_tr_b16 a[70:71], v40 offset:960
  v_mfma_f32_16x16x32_bf16 v[204:207], a[84:87], a[244:247], v[204:207]
  ds_read_b64_tr_b16 a[72:73], v40 offset:17088
  v_mfma_f32_16x16x32_bf16 v[204:207], a[80:83], a[228:231], v[204:207]
  ds_read_b64_tr_b16 a[74:75], v40 offset:17344
  v_mfma_f32_16x16x32_bf16 v[212:215], a[80:83], a[232:235], v[212:215]
  v_mfma_f32_16x16x32_bf16 v[212:215], a[84:87], a[248:251], v[212:215]
  ds_read_b64_tr_b16 a[76:77], v40 offset:17600
  v_mfma_f32_16x16x32_bf16 v[212:215], a[88:91], a[104:107], v[212:215]
  ds_read_b64_tr_b16 a[78:79], v40 offset:17856
  v_mfma_f32_16x16x32_bf16 v[212:215], a[92:95], a[120:123], v[212:215]
  v_mfma_f32_16x16x32_bf16 v[220:223], a[92:95], a[124:127], v[220:223]
  v_mfma_f32_16x16x32_bf16 v[220:223], a[88:91], a[108:111], v[220:223]
  v_mfma_f32_16x16x32_bf16 v[220:223], a[84:87], a[252:255], v[220:223]
  v_mfma_f32_16x16x32_bf16 v[220:223], a[80:83], a[236:239], v[220:223]
  s_waitcnt lgkmcnt(6)
  v_mfma_f32_16x16x32_bf16 v[248:251], a[64:67], a[236:239], v[248:251]
  s_waitcnt lgkmcnt(4)
  v_mfma_f32_16x16x32_bf16 v[248:251], a[68:71], a[252:255], v[248:251]
  s_waitcnt lgkmcnt(2)
  ds_read_b64_tr_b16 a[80:81], v40 offset:200
  v_mfma_f32_16x16x32_bf16 v[248:251], a[72:75], a[108:111], v[248:251]
  s_waitcnt lgkmcnt(1)
  ds_read_b64_tr_b16 a[82:83], v40 offset:456
  v_mfma_f32_16x16x32_bf16 v[248:251], a[76:79], a[124:127], v[248:251]
  ds_read_b64_tr_b16 a[84:85], v40 offset:712
  v_mfma_f32_16x16x32_bf16 v[240:243], a[76:79], a[120:123], v[240:243]
  v_mfma_f32_16x16x32_bf16 v[240:243], a[72:75], a[104:107], v[240:243]
  ds_read_b64_tr_b16 a[86:87], v40 offset:968
  v_mfma_f32_16x16x32_bf16 v[240:243], a[68:71], a[248:251], v[240:243]
  ds_read_b64_tr_b16 a[88:89], v40 offset:17096
  v_mfma_f32_16x16x32_bf16 v[240:243], a[64:67], a[232:235], v[240:243]
  ds_read_b64_tr_b16 a[90:91], v40 offset:17352
  v_mfma_f32_16x16x32_bf16 v[232:235], a[64:67], a[228:231], v[232:235]
  v_mfma_f32_16x16x32_bf16 v[232:235], a[68:71], a[244:247], v[232:235]
  ds_read_b64_tr_b16 a[92:93], v40 offset:17608
  v_mfma_f32_16x16x32_bf16 v[232:235], a[72:75], a[100:103], v[232:235]
  ds_read_b64_tr_b16 a[94:95], v40 offset:17864
  v_mfma_f32_16x16x32_bf16 v[232:235], a[76:79], a[116:119], v[232:235]
  v_mfma_f32_16x16x32_bf16 v[224:227], a[76:79], a[112:115], v[224:227]
  v_mfma_f32_16x16x32_bf16 v[224:227], a[72:75], a[96:99], v[224:227]
  v_mfma_f32_16x16x32_bf16 v[224:227], a[68:71], a[240:243], v[224:227]
  s_waitcnt vmcnt(22)
  v_mfma_f32_16x16x32_bf16 v[224:227], a[64:67], a[224:227], v[224:227]
  s_waitcnt lgkmcnt(6)
  s_waitcnt lgkmcnt(0)
  v_mfma_f32_16x16x32_bf16 v[228:231], a[80:83], a[224:227], v[228:231]
  s_barrier
  v_mfma_f32_16x16x32_bf16 v[228:231], a[84:87], a[240:243], v[228:231]
  ds_read_b64_tr_b16 a[64:65], v41 offset:33792
  v_mfma_f32_16x16x32_bf16 v[228:231], a[88:91], a[96:99], v[228:231]
  s_mov_b32 s66, 3145728
  ds_read_b64_tr_b16 a[66:67], v41 offset:33920
  v_mfma_f32_16x16x32_bf16 v[228:231], a[92:95], a[112:115], v[228:231]
  s_add_u32 m0, s51, 33792
  ds_read_b64_tr_b16 a[68:69], v41 offset:34048
  v_mfma_f32_16x16x32_bf16 v[236:239], a[92:95], a[116:119], v[236:239]
  buffer_load_dwordx4 v32, s[20:23], s66 offen lds
  v_mfma_f32_16x16x32_bf16 v[236:239], a[88:91], a[100:103], v[236:239]
  ds_read_b64_tr_b16 a[70:71], v41 offset:34176
  v_mfma_f32_16x16x32_bf16 v[236:239], a[84:87], a[244:247], v[236:239]
  ds_read_b64_tr_b16 a[72:73], v41 offset:50688
  v_mfma_f32_16x16x32_bf16 v[236:239], a[80:83], a[228:231], v[236:239]
  s_add_u32 m0, s51, 34848
  ds_read_b64_tr_b16 a[74:75], v41 offset:50816
  v_mfma_f32_16x16x32_bf16 v[244:247], a[80:83], a[232:235], v[244:247]
  buffer_load_dwordx4 v33, s[20:23], s66 offen lds
  v_mfma_f32_16x16x32_bf16 v[244:247], a[84:87], a[248:251], v[244:247]
  ds_read_b64_tr_b16 a[76:77], v41 offset:50944
  v_mfma_f32_16x16x32_bf16 v[244:247], a[88:91], a[104:107], v[244:247]
  s_add_u32 m0, s51, 35904
  ds_read_b64_tr_b16 a[78:79], v41 offset:51072
  v_mfma_f32_16x16x32_bf16 v[244:247], a[92:95], a[120:123], v[244:247]
  buffer_load_dwordx4 v34, s[20:23], s66 offen lds
  v_mfma_f32_16x16x32_bf16 v[252:255], a[92:95], a[124:127], v[252:255]
  s_add_u32 m0, s51, 36960
  v_mfma_f32_16x16x32_bf16 v[252:255], a[88:91], a[108:111], v[252:255]
  buffer_load_dwordx4 v35, s[20:23], s66 offen lds
  v_mfma_f32_16x16x32_bf16 v[252:255], a[84:87], a[252:255], v[252:255]
  s_waitcnt vmcnt(10)
  s_mov_b32 s66, 3670016
  s_add_u32 m0, s51, 50688
  v_mfma_f32_16x16x32_bf16 v[252:255], a[80:83], a[236:239], v[252:255]
  s_waitcnt lgkmcnt(6)
  buffer_load_dwordx4 v32, s[20:23], s66 offen lds
  v_mfma_f32_16x16x32_bf16 v[60:63], a[64:67], a[140:143], v[60:63]
  s_waitcnt lgkmcnt(4)
  v_mfma_f32_16x16x32_bf16 v[60:63], a[68:71], a[156:159], v[60:63]
  s_waitcnt lgkmcnt(2)
  ds_read_b64_tr_b16 a[80:81], v41 offset:42240
  v_mfma_f32_16x16x32_bf16 v[60:63], a[72:75], a[172:175], v[60:63]
  s_waitcnt lgkmcnt(1)
  ds_read_b64_tr_b16 a[82:83], v41 offset:42368
  v_mfma_f32_16x16x32_bf16 v[60:63], a[76:79], a[188:191], v[60:63]
  s_add_u32 m0, s51, 51744
  ds_read_b64_tr_b16 a[84:85], v41 offset:42496
  v_mfma_f32_16x16x32_bf16 v[56:59], a[76:79], a[184:187], v[56:59]
  buffer_load_dwordx4 v33, s[20:23], s66 offen lds
  v_mfma_f32_16x16x32_bf16 v[56:59], a[72:75], a[168:171], v[56:59]
  ds_read_b64_tr_b16 a[86:87], v41 offset:42624
  v_mfma_f32_16x16x32_bf16 v[56:59], a[68:71], a[152:155], v[56:59]
  ds_read_b64_tr_b16 a[88:89], v41 offset:59136
  v_mfma_f32_16x16x32_bf16 v[56:59], a[64:67], a[136:139], v[56:59]
  s_add_u32 m0, s51, 52800
  ds_read_b64_tr_b16 a[90:91], v41 offset:59264
  v_mfma_f32_16x16x32_bf16 v[52:55], a[64:67], a[132:135], v[52:55]
  buffer_load_dwordx4 v34, s[20:23], s66 offen lds
  v_mfma_f32_16x16x32_bf16 v[52:55], a[68:71], a[148:151], v[52:55]
  ds_read_b64_tr_b16 a[92:93], v41 offset:59392
  v_mfma_f32_16x16x32_bf16 v[52:55], a[72:75], a[164:167], v[52:55]
  s_add_u32 m0, s51, 53856
  ds_read_b64_tr_b16 a[94:95], v41 offset:59520
  v_mfma_f32_16x16x32_bf16 v[52:55], a[76:79], a[180:183], v[52:55]
  buffer_load_dwordx4 v35, s[20:23], s66 offen lds
  v_mfma_f32_16x16x32_bf16 v[48:51], a[76:79], a[176:179], v[48:51]
  s_mov_b32 s67, 1769472
  s_add_u32 m0, s51, 67584
  v_mfma_f32_16x16x32_bf16 v[48:51], a[72:75], a[160:163], v[48:51]
  buffer_load_dwordx4 v36, s[44:47], s67 offen lds
  v_mfma_f32_16x16x32_bf16 v[48:51], a[68:71], a[144:147], v[48:51]
  s_add_u32 m0, s51, 68640
  v_mfma_f32_16x16x32_bf16 v[48:51], a[64:67], a[128:131], v[48:51]
  s_waitcnt lgkmcnt(6)
  buffer_load_dwordx4 v37, s[44:47], s67 offen lds
  v_mfma_f32_16x16x32_bf16 a[0:3], a[80:83], a[128:131], a[0:3]
  s_waitcnt lgkmcnt(4)
  v_mfma_f32_16x16x32_bf16 a[0:3], a[84:87], a[144:147], a[0:3]
  s_waitcnt lgkmcnt(2)
  ds_read_b64_tr_b16 a[64:65], v41 offset:33824
  v_mfma_f32_16x16x32_bf16 a[0:3], a[88:91], a[160:163], a[0:3]
  s_waitcnt lgkmcnt(1)
  ds_read_b64_tr_b16 a[66:67], v41 offset:33952
  v_mfma_f32_16x16x32_bf16 a[0:3], a[92:95], a[176:179], a[0:3]
  ds_read_b64_tr_b16 a[68:69], v41 offset:34080
  v_mfma_f32_16x16x32_bf16 a[4:7], a[92:95], a[180:183], a[4:7]
  v_mfma_f32_16x16x32_bf16 a[4:7], a[88:91], a[164:167], a[4:7]
  ds_read_b64_tr_b16 a[70:71], v41 offset:34208
  v_mfma_f32_16x16x32_bf16 a[4:7], a[84:87], a[148:151], a[4:7]
  ds_read_b64_tr_b16 a[72:73], v41 offset:50720
  v_mfma_f32_16x16x32_bf16 a[4:7], a[80:83], a[132:135], a[4:7]
  ds_read_b64_tr_b16 a[74:75], v41 offset:50848
  v_mfma_f32_16x16x32_bf16 a[8:11], a[80:83], a[136:139], a[8:11]
  v_mfma_f32_16x16x32_bf16 a[8:11], a[84:87], a[152:155], a[8:11]
  ds_read_b64_tr_b16 a[76:77], v41 offset:50976
  v_mfma_f32_16x16x32_bf16 a[8:11], a[88:91], a[168:171], a[8:11]
  ds_read_b64_tr_b16 a[78:79], v41 offset:51104
  v_mfma_f32_16x16x32_bf16 a[8:11], a[92:95], a[184:187], a[8:11]
  v_mfma_f32_16x16x32_bf16 a[12:15], a[92:95], a[188:191], a[12:15]
  v_mfma_f32_16x16x32_bf16 a[12:15], a[88:91], a[172:175], a[12:15]
  v_mfma_f32_16x16x32_bf16 a[12:15], a[84:87], a[156:159], a[12:15]
  v_mfma_f32_16x16x32_bf16 a[12:15], a[80:83], a[140:143], a[12:15]
  s_waitcnt lgkmcnt(6)
  s_add_u32 m0, s51, 69696
  v_mfma_f32_16x16x32_bf16 v[76:79], a[64:67], a[140:143], v[76:79]
  s_waitcnt lgkmcnt(4)
  buffer_load_dwordx4 v38, s[44:47], s67 offen lds
  v_mfma_f32_16x16x32_bf16 v[76:79], a[68:71], a[156:159], v[76:79]
  s_waitcnt lgkmcnt(2)
  ds_read_b64_tr_b16 a[80:81], v41 offset:42272
  v_mfma_f32_16x16x32_bf16 v[76:79], a[72:75], a[172:175], v[76:79]
  s_waitcnt lgkmcnt(1)
  ds_read_b64_tr_b16 a[82:83], v41 offset:42400
  v_mfma_f32_16x16x32_bf16 v[76:79], a[76:79], a[188:191], v[76:79]
  ds_read_b64_tr_b16 a[84:85], v41 offset:42528
  v_mfma_f32_16x16x32_bf16 v[72:75], a[76:79], a[184:187], v[72:75]
  v_mfma_f32_16x16x32_bf16 v[72:75], a[72:75], a[168:171], v[72:75]
  ds_read_b64_tr_b16 a[86:87], v41 offset:42656
  v_mfma_f32_16x16x32_bf16 v[72:75], a[68:71], a[152:155], v[72:75]
  ds_read_b64_tr_b16 a[88:89], v41 offset:59168
  v_mfma_f32_16x16x32_bf16 v[72:75], a[64:67], a[136:139], v[72:75]
  s_add_u32 m0, s51, 70752
  ds_read_b64_tr_b16 a[90:91], v41 offset:59296
  v_mfma_f32_16x16x32_bf16 v[68:71], a[64:67], a[132:135], v[68:71]
  buffer_load_dwordx4 v39, s[44:47], s67 offen lds
  v_mfma_f32_16x16x32_bf16 v[68:71], a[68:71], a[148:151], v[68:71]
  s_mov_b32 s67, 1990656
  ds_read_b64_tr_b16 a[92:93], v41 offset:59424
  v_mfma_f32_16x16x32_bf16 v[68:71], a[72:75], a[164:167], v[68:71]
  s_add_u32 m0, s51, 84480
  ds_read_b64_tr_b16 a[94:95], v41 offset:59552
  v_mfma_f32_16x16x32_bf16 v[68:71], a[76:79], a[180:183], v[68:71]
  buffer_load_dwordx4 v36, s[44:47], s67 offen lds
  v_mfma_f32_16x16x32_bf16 v[64:67], a[76:79], a[176:179], v[64:67]
  s_add_u32 m0, s51, 85536
  v_mfma_f32_16x16x32_bf16 v[64:67], a[72:75], a[160:163], v[64:67]
  buffer_load_dwordx4 v37, s[44:47], s67 offen lds
  v_mfma_f32_16x16x32_bf16 v[64:67], a[68:71], a[144:147], v[64:67]
  v_mfma_f32_16x16x32_bf16 v[64:67], a[64:67], a[128:131], v[64:67]
  s_waitcnt lgkmcnt(6)
  v_mfma_f32_16x16x32_bf16 a[16:19], a[80:83], a[128:131], a[16:19]
  s_waitcnt lgkmcnt(4)
  v_mfma_f32_16x16x32_bf16 a[16:19], a[84:87], a[144:147], a[16:19]
  s_waitcnt lgkmcnt(2)
  ds_read_b64_tr_b16 a[64:65], v41 offset:33856
  v_mfma_f32_16x16x32_bf16 a[16:19], a[88:91], a[160:163], a[16:19]
  s_waitcnt lgkmcnt(1)
  ds_read_b64_tr_b16 a[66:67], v41 offset:33984
  v_mfma_f32_16x16x32_bf16 a[16:19], a[92:95], a[176:179], a[16:19]
  s_add_u32 m0, s51, 86592
  ds_read_b64_tr_b16 a[68:69], v41 offset:34112
  v_mfma_f32_16x16x32_bf16 a[20:23], a[92:95], a[180:183], a[20:23]
  buffer_load_dwordx4 v38, s[44:47], s67 offen lds
  v_mfma_f32_16x16x32_bf16 a[20:23], a[88:91], a[164:167], a[20:23]
  ds_read_b64_tr_b16 a[70:71], v41 offset:34240
  v_mfma_f32_16x16x32_bf16 a[20:23], a[84:87], a[148:151], a[20:23]
  ds_read_b64_tr_b16 a[72:73], v41 offset:50752
  v_mfma_f32_16x16x32_bf16 a[20:23], a[80:83], a[132:135], a[20:23]
  s_add_u32 m0, s51, 87648
  ds_read_b64_tr_b16 a[74:75], v41 offset:50880
  v_mfma_f32_16x16x32_bf16 a[24:27], a[80:83], a[136:139], a[24:27]
  buffer_load_dwordx4 v39, s[44:47], s67 offen lds
  v_mfma_f32_16x16x32_bf16 a[24:27], a[84:87], a[152:155], a[24:27]
  ds_read_b64_tr_b16 a[76:77], v41 offset:51008
  v_mfma_f32_16x16x32_bf16 a[24:27], a[88:91], a[168:171], a[24:27]
  ds_read_b64_tr_b16 a[78:79], v41 offset:51136
  v_mfma_f32_16x16x32_bf16 a[24:27], a[92:95], a[184:187], a[24:27]
  buffer_load_dwordx4 a[212:215], v124, s[8:11], s64 offen offset:1024 sc1
  v_mfma_f32_16x16x32_bf16 a[28:31], a[92:95], a[188:191], a[28:31]
  v_mfma_f32_16x16x32_bf16 a[28:31], a[88:91], a[172:175], a[28:31]
  v_mfma_f32_16x16x32_bf16 a[28:31], a[84:87], a[156:159], a[28:31]
  v_mfma_f32_16x16x32_bf16 a[28:31], a[80:83], a[140:143], a[28:31]
  s_waitcnt lgkmcnt(6)
  buffer_load_dwordx4 a[216:219], v124, s[8:11], s64 offen offset:2048 sc1
  v_mfma_f32_16x16x32_bf16 v[92:95], a[64:67], a[140:143], v[92:95]
  s_waitcnt lgkmcnt(4)
  v_mfma_f32_16x16x32_bf16 v[92:95], a[68:71], a[156:159], v[92:95]
  s_waitcnt lgkmcnt(2)
  ds_read_b64_tr_b16 a[80:81], v41 offset:42304
  v_mfma_f32_16x16x32_bf16 v[92:95], a[72:75], a[172:175], v[92:95]
  s_waitcnt lgkmcnt(1)
  ds_read_b64_tr_b16 a[82:83], v41 offset:42432
  v_mfma_f32_16x16x32_bf16 v[92:95], a[76:79], a[188:191], v[92:95]
  ds_read_b64_tr_b16 a[84:85], v41 offset:42560
  v_mfma_f32_16x16x32_bf16 v[88:91], a[76:79], a[184:187], v[88:91]
  buffer_load_dwordx4 a[220:223], v124, s[8:11], s64 offen offset:3072 sc1
  v_mfma_f32_16x16x32_bf16 v[88:91], a[72:75], a[168:171], v[88:91]
  ds_read_b64_tr_b16 a[86:87], v41 offset:42688
  v_mfma_f32_16x16x32_bf16 v[88:91], a[68:71], a[152:155], v[88:91]
  ds_read_b64_tr_b16 a[88:89], v41 offset:59200
  v_mfma_f32_16x16x32_bf16 v[88:91], a[64:67], a[136:139], v[88:91]
  s_add_u32 s64, s63, 73728
  ds_read_b64_tr_b16 a[90:91], v41 offset:59328
  v_mfma_f32_16x16x32_bf16 v[84:87], a[64:67], a[132:135], v[84:87]
  buffer_load_dwordx4 a[96:99], v1, s[8:11], s64 offen offset:0 sc1
  v_mfma_f32_16x16x32_bf16 v[84:87], a[68:71], a[148:151], v[84:87]
  ds_read_b64_tr_b16 a[92:93], v41 offset:59456
  v_mfma_f32_16x16x32_bf16 v[84:87], a[72:75], a[164:167], v[84:87]
  ds_read_b64_tr_b16 a[94:95], v41 offset:59584
  v_mfma_f32_16x16x32_bf16 v[84:87], a[76:79], a[180:183], v[84:87]
  v_mfma_f32_16x16x32_bf16 v[80:83], a[76:79], a[176:179], v[80:83]
  buffer_load_dwordx4 a[100:103], v1, s[8:11], s64 offen offset:1024 sc1
  v_mfma_f32_16x16x32_bf16 v[80:83], a[72:75], a[160:163], v[80:83]
  v_mfma_f32_16x16x32_bf16 v[80:83], a[68:71], a[144:147], v[80:83]
  v_mfma_f32_16x16x32_bf16 v[80:83], a[64:67], a[128:131], v[80:83]
  s_waitcnt lgkmcnt(6)
  v_mfma_f32_16x16x32_bf16 a[32:35], a[80:83], a[128:131], a[32:35]
  s_waitcnt lgkmcnt(4)
  v_mfma_f32_16x16x32_bf16 a[32:35], a[84:87], a[144:147], a[32:35]
  s_waitcnt lgkmcnt(2)
  ds_read_b64_tr_b16 a[64:65], v41 offset:33888
  v_mfma_f32_16x16x32_bf16 a[32:35], a[88:91], a[160:163], a[32:35]
  s_waitcnt lgkmcnt(1)
  ds_read_b64_tr_b16 a[66:67], v41 offset:34016
  v_mfma_f32_16x16x32_bf16 a[32:35], a[92:95], a[176:179], a[32:35]
  ds_read_b64_tr_b16 a[68:69], v41 offset:34144
  v_mfma_f32_16x16x32_bf16 a[36:39], a[92:95], a[180:183], a[36:39]
  buffer_load_dwordx4 a[104:107], v1, s[8:11], s64 offen offset:2048 sc1
  v_mfma_f32_16x16x32_bf16 a[36:39], a[88:91], a[164:167], a[36:39]
  ds_read_b64_tr_b16 a[70:71], v41 offset:34272
  v_mfma_f32_16x16x32_bf16 a[36:39], a[84:87], a[148:151], a[36:39]
  ds_read_b64_tr_b16 a[72:73], v41 offset:50784
  v_mfma_f32_16x16x32_bf16 a[36:39], a[80:83], a[132:135], a[36:39]
  ds_read_b64_tr_b16 a[74:75], v41 offset:50912
  v_mfma_f32_16x16x32_bf16 a[40:43], a[80:83], a[136:139], a[40:43]
  v_mfma_f32_16x16x32_bf16 a[40:43], a[84:87], a[152:155], a[40:43]
  ds_read_b64_tr_b16 a[76:77], v41 offset:51040
  v_mfma_f32_16x16x32_bf16 a[40:43], a[88:91], a[168:171], a[40:43]
  ds_read_b64_tr_b16 a[78:79], v41 offset:51168
  v_mfma_f32_16x16x32_bf16 a[40:43], a[92:95], a[184:187], a[40:43]
  buffer_load_dwordx4 a[108:111], v1, s[8:11], s64 offen offset:3072 sc1
  v_mfma_f32_16x16x32_bf16 a[44:47], a[92:95], a[188:191], a[44:47]
  v_mfma_f32_16x16x32_bf16 a[44:47], a[88:91], a[172:175], a[44:47]
  buffer_load_dwordx4 a[112:115], v124, s[8:11], s64 offen offset:0 sc1
  v_mfma_f32_16x16x32_bf16 a[44:47], a[84:87], a[156:159], a[44:47]
  v_mfma_f32_16x16x32_bf16 a[44:47], a[80:83], a[140:143], a[44:47]
  s_waitcnt lgkmcnt(6)
  v_mfma_f32_16x16x32_bf16 v[108:111], a[64:67], a[140:143], v[108:111]
  s_waitcnt lgkmcnt(4)
  v_mfma_f32_16x16x32_bf16 v[108:111], a[68:71], a[156:159], v[108:111]
  s_waitcnt lgkmcnt(2)
  ds_read_b64_tr_b16 a[80:81], v41 offset:42336
  v_mfma_f32_16x16x32_bf16 v[108:111], a[72:75], a[172:175], v[108:111]
  s_waitcnt lgkmcnt(1)
  ds_read_b64_tr_b16 a[82:83], v41 offset:42464
  v_mfma_f32_16x16x32_bf16 v[108:111], a[76:79], a[188:191], v[108:111]
  ds_read_b64_tr_b16 a[84:85], v41 offset:42592
  v_mfma_f32_16x16x32_bf16 v[104:107], a[76:79], a[184:187], v[104:107]
  buffer_load_dwordx4 a[116:119], v124, s[8:11], s64 offen offset:1024 sc1
  v_mfma_f32_16x16x32_bf16 v[104:107], a[72:75], a[168:171], v[104:107]
  ds_read_b64_tr_b16 a[86:87], v41 offset:42720
  v_mfma_f32_16x16x32_bf16 v[104:107], a[68:71], a[152:155], v[104:107]
  ds_read_b64_tr_b16 a[88:89], v41 offset:59232
  v_mfma_f32_16x16x32_bf16 v[104:107], a[64:67], a[136:139], v[104:107]
  ds_read_b64_tr_b16 a[90:91], v41 offset:59360
  v_mfma_f32_16x16x32_bf16 v[100:103], a[64:67], a[132:135], v[100:103]
  buffer_load_dwordx4 a[120:123], v124, s[8:11], s64 offen offset:2048 sc1
  v_mfma_f32_16x16x32_bf16 v[100:103], a[68:71], a[148:151], v[100:103]
  ds_read_b64_tr_b16 a[92:93], v41 offset:59488
  v_mfma_f32_16x16x32_bf16 v[100:103], a[72:75], a[164:167], v[100:103]
  ds_read_b64_tr_b16 a[94:95], v41 offset:59616
  v_mfma_f32_16x16x32_bf16 v[100:103], a[76:79], a[180:183], v[100:103]
  buffer_load_dwordx4 a[124:127], v124, s[8:11], s64 offen offset:3072 sc1
  v_mfma_f32_16x16x32_bf16 v[96:99], a[76:79], a[176:179], v[96:99]
  s_mov_b32 s66, 4194304
  v_mfma_f32_16x16x32_bf16 v[96:99], a[72:75], a[160:163], v[96:99]
  s_add_u32 m0, s51, 0
  v_mfma_f32_16x16x32_bf16 v[96:99], a[68:71], a[144:147], v[96:99]
  s_waitcnt vmcnt(19)
  buffer_load_dwordx4 v32, s[20:23], s66 offen lds
  v_mfma_f32_16x16x32_bf16 v[96:99], a[64:67], a[128:131], v[96:99]
  s_waitcnt lgkmcnt(6)
  s_waitcnt lgkmcnt(0)
  v_mfma_f32_16x16x32_bf16 a[48:51], a[80:83], a[128:131], a[48:51]
  s_barrier
  v_mfma_f32_16x16x32_bf16 a[48:51], a[84:87], a[144:147], a[48:51]
  ds_read_b64_tr_b16 a[64:65], v40 offset:33792
  v_mfma_f32_16x16x32_bf16 a[48:51], a[88:91], a[160:163], a[48:51]
  ds_read_b64_tr_b16 a[66:67], v40 offset:34048
  v_mfma_f32_16x16x32_bf16 a[48:51], a[92:95], a[176:179], a[48:51]
  s_add_u32 m0, s51, 1056
  ds_read_b64_tr_b16 a[68:69], v40 offset:34304
  v_mfma_f32_16x16x32_bf16 a[52:55], a[92:95], a[180:183], a[52:55]
  buffer_load_dwordx4 v33, s[20:23], s66 offen lds
  v_mfma_f32_16x16x32_bf16 a[52:55], a[88:91], a[164:167], a[52:55]
  ds_read_b64_tr_b16 a[70:71], v40 offset:34560
  v_mfma_f32_16x16x32_bf16 a[52:55], a[84:87], a[148:151], a[52:55]
  ds_read_b64_tr_b16 a[72:73], v40 offset:50688
  v_mfma_f32_16x16x32_bf16 a[52:55], a[80:83], a[132:135], a[52:55]
  s_add_u32 m0, s51, 2112
  ds_read_b64_tr_b16 a[74:75], v40 offset:50944
  v_mfma_f32_16x16x32_bf16 a[56:59], a[80:83], a[136:139], a[56:59]
  buffer_load_dwordx4 v34, s[20:23], s66 offen lds
  v_mfma_f32_16x16x32_bf16 a[56:59], a[84:87], a[152:155], a[56:59]
  ds_read_b64_tr_b16 a[76:77], v40 offset:51200
  v_mfma_f32_16x16x32_bf16 a[56:59], a[88:91], a[168:171], a[56:59]
  ds_read_b64_tr_b16 a[78:79], v40 offset:51456
  v_mfma_f32_16x16x32_bf16 a[56:59], a[92:95], a[184:187], a[56:59]
  s_add_u32 m0, s51, 3168
  v_mfma_f32_16x16x32_bf16 a[60:63], a[92:95], a[188:191], a[60:63]
  buffer_load_dwordx4 v35, s[20:23], s66 offen lds
  v_mfma_f32_16x16x32_bf16 a[60:63], a[88:91], a[172:175], a[60:63]
  v_mfma_f32_16x16x32_bf16 a[60:63], a[84:87], a[156:159], a[60:63]
  s_mov_b32 s66, 4718592
  v_mfma_f32_16x16x32_bf16 a[60:63], a[80:83], a[140:143], a[60:63]
  s_waitcnt lgkmcnt(6)
  s_add_u32 m0, s51, 16896
  v_mfma_f32_16x16x32_bf16 v[152:155], a[64:67], a[140:143], v[152:155]
  s_waitcnt lgkmcnt(4)
  buffer_load_dwordx4 v32, s[20:23], s66 offen lds
  v_mfma_f32_16x16x32_bf16 v[152:155], a[68:71], a[156:159], v[152:155]
  s_waitcnt lgkmcnt(2)
  ds_read_b64_tr_b16 a[80:81], v40 offset:33800
  v_mfma_f32_16x16x32_bf16 v[152:155], a[72:75], a[172:175], v[152:155]
  s_waitcnt lgkmcnt(1)
  ds_read_b64_tr_b16 a[82:83], v40 offset:34056
  v_mfma_f32_16x16x32_bf16 v[152:155], a[76:79], a[188:191], v[152:155]
  ds_read_b64_tr_b16 a[84:85], v40 offset:34312
  v_mfma_f32_16x16x32_bf16 v[144:147], a[76:79], a[184:187], v[144:147]
  v_mfma_f32_16x16x32_bf16 v[144:147], a[72:75], a[168:171], v[144:147]
  ds_read_b64_tr_b16 a[86:87], v40 offset:34568
  v_mfma_f32_16x16x32_bf16 v[144:147], a[68:71], a[152:155], v[144:147]
  ds_read_b64_tr_b16 a[88:89], v40 offset:50696
  v_mfma_f32_16x16x32_bf16 v[144:147], a[64:67], a[136:139], v[144:147]
  s_add_u32 m0, s51, 17952
  ds_read_b64_tr_b16 a[90:91], v40 offset:50952
  v_mfma_f32_16x16x32_bf16 v[136:139], a[64:67], a[132:135], v[136:139]
  buffer_load_dwordx4 v33, s[20:23], s66 offen lds
  v_mfma_f32_16x16x32_bf16 v[136:139], a[68:71], a[148:151], v[136:139]
  ds_read_b64_tr_b16 a[92:93], v40 offset:51208
  v_mfma_f32_16x16x32_bf16 v[136:139], a[72:75], a[164:167], v[136:139]
  ds_read_b64_tr_b16 a[94:95], v40 offset:51464
  v_mfma_f32_16x16x32_bf16 v[136:139], a[76:79], a[180:183], v[136:139]
  s_add_u32 m0, s51, 19008
  v_mfma_f32_16x16x32_bf16 v[128:131], a[76:79], a[176:179], v[128:131]
  buffer_load_dwordx4 v34, s[20:23], s66 offen lds
  v_mfma_f32_16x16x32_bf16 v[128:131], a[72:75], a[160:163], v[128:131]
  v_mfma_f32_16x16x32_bf16 v[128:131], a[68:71], a[144:147], v[128:131]
  v_mfma_f32_16x16x32_bf16 v[128:131], a[64:67], a[128:131], v[128:131]
  s_waitcnt lgkmcnt(6)
  s_add_u32 m0, s51, 20064
  v_mfma_f32_16x16x32_bf16 v[132:135], a[80:83], a[128:131], v[132:135]
  s_waitcnt lgkmcnt(4)
  buffer_load_dwordx4 v35, s[20:23], s66 offen lds
  v_mfma_f32_16x16x32_bf16 v[132:135], a[84:87], a[144:147], v[132:135]
  s_waitcnt lgkmcnt(2)
  ds_read_b64_tr_b16 a[64:65], v40 offset:33856
  v_mfma_f32_16x16x32_bf16 v[132:135], a[88:91], a[160:163], v[132:135]
  s_waitcnt lgkmcnt(1)
  ds_read_b64_tr_b16 a[66:67], v40 offset:34112
  v_mfma_f32_16x16x32_bf16 v[132:135], a[92:95], a[176:179], v[132:135]
  ds_read_b64_tr_b16 a[68:69], v40 offset:34368
  v_mfma_f32_16x16x32_bf16 v[140:143], a[92:95], a[180:183], v[140:143]
  v_mfma_f32_16x16x32_bf16 v[140:143], a[88:91], a[164:167], v[140:143]
  ds_read_b64_tr_b16 a[70:71], v40 offset:34624
  v_mfma_f32_16x16x32_bf16 v[140:143], a[84:87], a[148:151], v[140:143]
  ds_read_b64_tr_b16 a[72:73], v40 offset:50752
  v_mfma_f32_16x16x32_bf16 v[140:143], a[80:83], a[132:135], v[140:143]
  s_add_u32 m0, s51, 101376
  ds_read_b64_tr_b16 a[74:75], v40 offset:51008
  v_mfma_f32_16x16x32_bf16 v[148:151], a[80:83], a[136:139], v[148:151]
  buffer_load_dwordx4 v4, s[16:19], 0 offen offset:0 lds
  v_mfma_f32_16x16x32_bf16 v[148:151], a[84:87], a[152:155], v[148:151]
  ds_read_b64_tr_b16 a[76:77], v40 offset:51264
  v_mfma_f32_16x16x32_bf16 v[148:151], a[88:91], a[168:171], v[148:151]
  s_add_u32 m0, s51, 101408
  ds_read_b64_tr_b16 a[78:79], v40 offset:51520
  v_mfma_f32_16x16x32_bf16 v[148:151], a[92:95], a[184:187], v[148:151]
  buffer_load_dwordx4 v4, s[16:19], 0 offen offset:1024 lds
  v_mfma_f32_16x16x32_bf16 v[156:159], a[92:95], a[188:191], v[156:159]
  s_add_u32 m0, s51, 101440
  v_mfma_f32_16x16x32_bf16 v[156:159], a[88:91], a[172:175], v[156:159]
  buffer_load_dwordx4 v4, s[16:19], 0 offen offset:2048 lds
  v_mfma_f32_16x16x32_bf16 v[156:159], a[84:87], a[156:159], v[156:159]
  v_mfma_f32_16x16x32_bf16 v[156:159], a[80:83], a[140:143], v[156:159]
  s_waitcnt lgkmcnt(6)
  v_mfma_f32_16x16x32_bf16 v[184:187], a[64:67], a[140:143], v[184:187]
  s_waitcnt lgkmcnt(4)
  v_mfma_f32_16x16x32_bf16 v[184:187], a[68:71], a[156:159], v[184:187]
  s_waitcnt lgkmcnt(2)
  ds_read_b64_tr_b16 a[80:81], v40 offset:33864
  v_mfma_f32_16x16x32_bf16 v[184:187], a[72:75], a[172:175], v[184:187]
  s_waitcnt lgkmcnt(1)
  ds_read_b64_tr_b16 a[82:83], v40 offset:34120
  v_mfma_f32_16x16x32_bf16 v[184:187], a[76:79], a[188:191], v[184:187]
  s_add_u32 m0, s51, 101472
  ds_read_b64_tr_b16 a[84:85], v40 offset:34376
  v_mfma_f32_16x16x32_bf16 v[176:179], a[76:79], a[184:187], v[176:179]
  buffer_load_dwordx4 v4, s[16:19], 0 offen offset:3072 lds
  v_mfma_f32_16x16x32_bf16 v[176:179], a[72:75], a[168:171], v[176:179]
  ds_read_b64_tr_b16 a[86:87], v40 offset:34632
  v_mfma_f32_16x16x32_bf16 v[176:179], a[68:71], a[152:155], v[176:179]
  ds_read_b64_tr_b16 a[88:89], v40 offset:50760
  v_mfma_f32_16x16x32_bf16 v[176:179], a[64:67], a[136:139], v[176:179]
  s_add_u32 m0, s51, 118272
  ds_read_b64_tr_b16 a[90:91], v40 offset:51016
  v_mfma_f32_16x16x32_bf16 v[168:171], a[64:67], a[132:135], v[168:171]
  buffer_load_dwordx4 v4, s[16:19], s48 offen offset:0 lds
  v_mfma_f32_16x16x32_bf16 v[168:171], a[68:71], a[148:151], v[168:171]
  ds_read_b64_tr_b16 a[92:93], v40 offset:51272
  v_mfma_f32_16x16x32_bf16 v[168:171], a[72:75], a[164:167], v[168:171]
  s_add_u32 m0, s51, 118304
  ds_read_b64_tr_b16 a[94:95], v40 offset:51528
  v_mfma_f32_16x16x32_bf16 v[168:171], a[76:79], a[180:183], v[168:171]
  buffer_load_dwordx4 v4, s[16:19], s48 offen offset:1024 lds
  v_mfma_f32_16x16x32_bf16 v[160:163], a[76:79], a[176:179], v[160:163]
  v_mfma_f32_16x16x32_bf16 v[160:163], a[72:75], a[160:163], v[160:163]
  v_mfma_f32_16x16x32_bf16 v[160:163], a[68:71], a[144:147], v[160:163]
  s_add_u32 m0, s51, 118336
  v_mfma_f32_16x16x32_bf16 v[160:163], a[64:67], a[128:131], v[160:163]
  s_waitcnt lgkmcnt(6)
  buffer_load_dwordx4 v4, s[16:19], s48 offen offset:2048 lds
  v_mfma_f32_16x16x32_bf16 v[164:167], a[80:83], a[128:131], v[164:167]
  s_waitcnt lgkmcnt(4)
  s_getpc_b64 s[4:5]
L_pc_q:
  s_add_u32 s4, s4, L_a_attn-L_pc_q
  s_addc_u32 s5, s5, 0
  v_mfma_f32_16x16x32_bf16 v[164:167], a[84:87], a[144:147], v[164:167]
  s_waitcnt lgkmcnt(2)
  ds_read_b64_tr_b16 a[64:65], v40 offset:33920
  s_lshr_b32 s3, s2, 3
  v_mfma_f32_16x16x32_bf16 v[164:167], a[88:91], a[160:163], v[164:167]
  s_waitcnt lgkmcnt(1)
  ds_read_b64_tr_b16 a[66:67], v40 offset:34176
  s_lshl_b32 s3, s3, 10
  v_mfma_f32_16x16x32_bf16 v[164:167], a[92:95], a[176:179], v[164:167]
  s_add_u32 m0, s51, 118368
  ds_read_b64_tr_b16 a[68:69], v40 offset:34432
  v_lshl_add_u32 v120, v0, 2, s3
  v_mfma_f32_16x16x32_bf16 v[172:175], a[92:95], a[180:183], v[172:175]
  buffer_load_dwordx4 v4, s[16:19], s48 offen offset:3072 lds
  v_mfma_f32_16x16x32_bf16 v[172:175], a[88:91], a[164:167], v[172:175]
  ds_read_b64_tr_b16 a[70:71], v40 offset:34688
  v_min_u32 v120, L_a_post-L_a_attn, v120
  v_mfma_f32_16x16x32_bf16 v[172:175], a[84:87], a[148:151], v[172:175]
  ds_read_b64_tr_b16 a[72:73], v40 offset:50816
  v_mov_b32 v121, s5
  v_mfma_f32_16x16x32_bf16 v[172:175], a[80:83], a[132:135], v[172:175]
  ds_read_b64_tr_b16 a[74:75], v40 offset:51072
  v_add_co_u32 v120, vcc, s4, v120
  v_mfma_f32_16x16x32_bf16 v[180:183], a[80:83], a[136:139], v[180:183]
  s_nop 0
  v_addc_co_u32 v121, vcc, 0, v121, vcc
  v_mfma_f32_16x16x32_bf16 v[180:183], a[84:87], a[152:155], v[180:183]
  ds_read_b64_tr_b16 a[76:77], v40 offset:51328
  v_mfma_f32_16x16x32_bf16 v[180:183], a[88:91], a[168:171], v[180:183]
  ds_read_b64_tr_b16 a[78:79], v40 offset:51584
  v_mfma_f32_16x16x32_bf16 v[180:183], a[92:95], a[184:187], v[180:183]
  v_mfma_f32_16x16x32_bf16 v[188:191], a[92:95], a[188:191], v[188:191]
  v_mfma_f32_16x16x32_bf16 v[188:191], a[88:91], a[172:175], v[188:191]
  v_mfma_f32_16x16x32_bf16 v[188:191], a[84:87], a[156:159], v[188:191]
  v_mfma_f32_16x16x32_bf16 v[188:191], a[80:83], a[140:143], v[188:191]
  s_waitcnt lgkmcnt(6)
  v_mfma_f32_16x16x32_bf16 v[216:219], a[64:67], a[140:143], v[216:219]
  s_waitcnt lgkmcnt(4)
  global_load_dword v119, v[120:121], off
  v_mfma_f32_16x16x32_bf16 v[216:219], a[68:71], a[156:159], v[216:219]
  s_waitcnt lgkmcnt(2)
  ds_read_b64_tr_b16 a[80:81], v40 offset:33928
  v_mfma_f32_16x16x32_bf16 v[216:219], a[72:75], a[172:175], v[216:219]
  s_waitcnt lgkmcnt(1)
  ds_read_b64_tr_b16 a[82:83], v40 offset:34184
  v_mfma_f32_16x16x32_bf16 v[216:219], a[76:79], a[188:191], v[216:219]
  ds_read_b64_tr_b16 a[84:85], v40 offset:34440
  v_mfma_f32_16x16x32_bf16 v[208:211], a[76:79], a[184:187], v[208:211]
  v_mfma_f32_16x16x32_bf16 v[208:211], a[72:75], a[168:171], v[208:211]
  ds_read_b64_tr_b16 a[86:87], v40 offset:34696
  v_mfma_f32_16x16x32_bf16 v[208:211], a[68:71], a[152:155], v[208:211]
  ds_read_b64_tr_b16 a[88:89], v40 offset:50824
  v_mfma_f32_16x16x32_bf16 v[208:211], a[64:67], a[136:139], v[208:211]
  ds_read_b64_tr_b16 a[90:91], v40 offset:51080
  v_mfma_f32_16x16x32_bf16 v[200:203], a[64:67], a[132:135], v[200:203]
  v_mfma_f32_16x16x32_bf16 v[200:203], a[68:71], a[148:151], v[200:203]
  ds_read_b64_tr_b16 a[92:93], v40 offset:51336
  v_mfma_f32_16x16x32_bf16 v[200:203], a[72:75], a[164:167], v[200:203]
  ds_read_b64_tr_b16 a[94:95], v40 offset:51592
  v_mfma_f32_16x16x32_bf16 v[200:203], a[76:79], a[180:183], v[200:203]
  v_mfma_f32_16x16x32_bf16 v[192:195], a[76:79], a[176:179], v[192:195]
  v_mfma_f32_16x16x32_bf16 v[192:195], a[72:75], a[160:163], v[192:195]
  v_mfma_f32_16x16x32_bf16 v[192:195], a[68:71], a[144:147], v[192:195]
  v_mfma_f32_16x16x32_bf16 v[192:195], a[64:67], a[128:131], v[192:195]
  s_waitcnt lgkmcnt(6)
  v_mfma_f32_16x16x32_bf16 v[196:199], a[80:83], a[128:131], v[196:199]
  s_waitcnt lgkmcnt(4)
  v_mfma_f32_16x16x32_bf16 v[196:199], a[84:87], a[144:147], v[196:199]
  s_waitcnt lgkmcnt(2)
  ds_read_b64_tr_b16 a[64:65], v40 offset:33984
  v_mfma_f32_16x16x32_bf16 v[196:199], a[88:91], a[160:163], v[196:199]
  s_waitcnt lgkmcnt(1)
  ds_read_b64_tr_b16 a[66:67], v40 offset:34240
  v_mfma_f32_16x16x32_bf16 v[196:199], a[92:95], a[176:179], v[196:199]
  ds_read_b64_tr_b16 a[68:69], v40 offset:34496
  v_mfma_f32_16x16x32_bf16 v[204:207], a[92:95], a[180:183], v[204:207]
  v_mfma_f32_16x16x32_bf16 v[204:207], a[88:91], a[164:167], v[204:207]
  ds_read_b64_tr_b16 a[70:71], v40 offset:34752
  v_mfma_f32_16x16x32_bf16 v[204:207], a[84:87], a[148:151], v[204:207]
  ds_read_b64_tr_b16 a[72:73], v40 offset:50880
  v_mfma_f32_16x16x32_bf16 v[204:207], a[80:83], a[132:135], v[204:207]
  ds_read_b64_tr_b16 a[74:75], v40 offset:51136
  v_mfma_f32_16x16x32_bf16 v[212:215], a[80:83], a[136:139], v[212:215]
  v_mfma_f32_16x16x32_bf16 v[212:215], a[84:87], a[152:155], v[212:215]
  ds_read_b64_tr_b16 a[76:77], v40 offset:51392
  v_mfma_f32_16x16x32_bf16 v[212:215], a[88:91], a[168:171], v[212:215]
  ds_read_b64_tr_b16 a[78:79], v40 offset:51648
  v_mfma_f32_16x16x32_bf16 v[212:215], a[92:95], a[184:187], v[212:215]
  v_mfma_f32_16x16x32_bf16 v[220:223], a[92:95], a[188:191], v[220:223]
  v_mfma_f32_16x16x32_bf16 v[220:223], a[88:91], a[172:175], v[220:223]
  v_mfma_f32_16x16x32_bf16 v[220:223], a[84:87], a[156:159], v[220:223]
  v_mfma_f32_16x16x32_bf16 v[220:223], a[80:83], a[140:143], v[220:223]
  s_waitcnt lgkmcnt(6)
  v_mfma_f32_16x16x32_bf16 v[248:251], a[64:67], a[140:143], v[248:251]
  s_waitcnt lgkmcnt(4)
  v_mfma_f32_16x16x32_bf16 v[248:251], a[68:71], a[156:159], v[248:251]
  s_waitcnt lgkmcnt(2)
  ds_read_b64_tr_b16 a[80:81], v40 offset:33992
  v_mfma_f32_16x16x32_bf16 v[248:251], a[72:75], a[172:175], v[248:251]
  s_waitcnt lgkmcnt(1)
  ds_read_b64_tr_b16 a[82:83], v40 offset:34248
  v_mfma_f32_16x16x32_bf16 v[248:251], a[76:79], a[188:191], v[248:251]
  ds_read_b64_tr_b16 a[84:85], v40 offset:34504
  v_mfma_f32_16x16x32_bf16 v[240:243], a[76:79], a[184:187], v[240:243]
  v_mfma_f32_16x16x32_bf16 v[240:243], a[72:75], a[168:171], v[240:243]
  ds_read_b64_tr_b16 a[86:87], v40 offset:34760
  v_mfma_f32_16x16x32_bf16 v[240:243], a[68:71], a[152:155], v[240:243]
  ds_read_b64_tr_b16 a[88:89], v40 offset:50888
  v_mfma_f32_16x16x32_bf16 v[240:243], a[64:67], a[136:139], v[240:243]
  ds_read_b64_tr_b16 a[90:91], v40 offset:51144
  v_mfma_f32_16x16x32_bf16 v[232:235], a[64:67], a[132:135], v[232:235]
  v_mfma_f32_16x16x32_bf16 v[232:235], a[68:71], a[148:151], v[232:235]
  ds_read_b64_tr_b16 a[92:93], v40 offset:51400
  v_mfma_f32_16x16x32_bf16 v[232:235], a[72:75], a[164:167], v[232:235]
  ds_read_b64_tr_b16 a[94:95], v40 offset:51656
  v_mfma_f32_16x16x32_bf16 v[232:235], a[76:79], a[180:183], v[232:235]
  v_mfma_f32_16x16x32_bf16 v[224:227], a[76:79], a[176:179], v[224:227]
  v_mfma_f32_16x16x32_bf16 v[224:227], a[72:75], a[160:163], v[224:227]
  v_mfma_f32_16x16x32_bf16 v[224:227], a[68:71], a[144:147], v[224:227]
  s_waitcnt vmcnt(28)
  v_mfma_f32_16x16x32_bf16 v[224:227], a[64:67], a[128:131], v[224:227]
  s_waitcnt lgkmcnt(6)
  s_waitcnt lgkmcnt(0)
  v_mfma_f32_16x16x32_bf16 v[228:231], a[80:83], a[128:131], v[228:231]
  s_barrier
  v_mfma_f32_16x16x32_bf16 v[228:231], a[84:87], a[144:147], v[228:231]
  ds_read_b64_tr_b16 a[64:65], v41 offset:0
  v_mfma_f32_16x16x32_bf16 v[228:231], a[88:91], a[160:163], v[228:231]
  ds_read_b64_tr_b16 a[66:67], v41 offset:128
  v_mfma_f32_16x16x32_bf16 v[228:231], a[92:95], a[176:179], v[228:231]
  ds_read_b64_tr_b16 a[68:69], v41 offset:256
  v_mfma_f32_16x16x32_bf16 v[236:239], a[92:95], a[180:183], v[236:239]
  v_mfma_f32_16x16x32_bf16 v[236:239], a[88:91], a[164:167], v[236:239]
  ds_read_b64_tr_b16 a[70:71], v41 offset:384
  v_mfma_f32_16x16x32_bf16 v[236:239], a[84:87], a[148:151], v[236:239]
  ds_read_b64_tr_b16 a[72:73], v41 offset:16896
  v_mfma_f32_16x16x32_bf16 v[236:239], a[80:83], a[132:135], v[236:239]
  s_add_u32 m0, s51, 33792
  ds_read_b64_tr_b16 a[74:75], v41 offset:17024
  v_mfma_f32_16x16x32_bf16 v[244:247], a[80:83], a[136:139], v[244:247]
  buffer_load_dwordx4 v4, s[12:15], 0 offen offset:0 lds
  v_mfma_f32_16x16x32_bf16 v[244:247], a[84:87], a[152:155], v[244:247]
  ds_read_b64_tr_b16 a[76:77], v41 offset:17152
  v_mfma_f32_16x16x32_bf16 v[244:247], a[88:91], a[168:171], v[244:247]
  s_add_u32 m0, s51, 33824
  ds_read_b64_tr_b16 a[78:79], v41 offset:17280
  v_mfma_f32_16x16x32_bf16 v[244:247], a[92:95], a[184:187], v[244:247]
  buffer_load_dwordx4 v4, s[12:15], 0 offen offset:1024 lds
  v_mfma_f32_16x16x32_bf16 v[252:255], a[92:95], a[188:191], v[252:255]
  s_add_u32 m0, s51, 33856
  v_mfma_f32_16x16x32_bf16 v[252:255], a[88:91], a[172:175], v[252:255]
  buffer_load_dwordx4 v4, s[12:15], 0 offen offset:2048 lds
  v_mfma_f32_16x16x32_bf16 v[252:255], a[84:87], a[156:159], v[252:255]
  s_waitcnt vmcnt(20)
  s_add_u32 m0, s51, 33888
  v_mfma_f32_16x16x32_bf16 v[252:255], a[80:83], a[140:143], v[252:255]
  s_waitcnt lgkmcnt(6)
  buffer_load_dwordx4 v4, s[12:15], 0 offen offset:3072 lds
  v_mfma_f32_16x16x32_bf16 v[60:63], a[64:67], a[204:207], v[60:63]
  s_waitcnt lgkmcnt(4)
  v_mfma_f32_16x16x32_bf16 v[60:63], a[68:71], a[220:223], v[60:63]
  s_waitcnt lgkmcnt(2)
  ds_read_b64_tr_b16 a[80:81], v41 offset:8448
  v_mfma_f32_16x16x32_bf16 v[60:63], a[72:75], a[108:111], v[60:63]
  s_waitcnt lgkmcnt(1)
  ds_read_b64_tr_b16 a[82:83], v41 offset:8576
  v_mfma_f32_16x16x32_bf16 v[60:63], a[76:79], a[124:127], v[60:63]
  s_add_u32 m0, s51, 50688
  ds_read_b64_tr_b16 a[84:85], v41 offset:8704
  v_mfma_f32_16x16x32_bf16 v[56:59], a[76:79], a[120:123], v[56:59]
  buffer_load_dwordx4 v4, s[12:15], s48 offen offset:0 lds
  v_mfma_f32_16x16x32_bf16 v[56:59], a[72:75], a[104:107], v[56:59]
  ds_read_b64_tr_b16 a[86:87], v41 offset:8832
  v_mfma_f32_16x16x32_bf16 v[56:59], a[68:71], a[216:219], v[56:59]
  ds_read_b64_tr_b16 a[88:89], v41 offset:25344
  v_mfma_f32_16x16x32_bf16 v[56:59], a[64:67], a[200:203], v[56:59]
  s_add_u32 m0, s51, 50720
  ds_read_b64_tr_b16 a[90:91], v41 offset:25472
  v_mfma_f32_16x16x32_bf16 v[52:55], a[64:67], a[196:199], v[52:55]
  buffer_load_dwordx4 v4, s[12:15], s48 offen offset:1024 lds
  v_mfma_f32_16x16x32_bf16 v[52:55], a[68:71], a[212:215], v[52:55]
  ds_read_b64_tr_b16 a[92:93], v41 offset:25600
  v_mfma_f32_16x16x32_bf16 v[52:55], a[72:75], a[100:103], v[52:55]
  s_add_u32 m0, s51, 50752
  ds_read_b64_tr_b16 a[94:95], v41 offset:25728
  v_mfma_f32_16x16x32_bf16 v[52:55], a[76:79], a[116:119], v[52:55]
  buffer_load_dwordx4 v4, s[12:15], s48 offen offset:2048 lds
  v_mfma_f32_16x16x32_bf16 v[48:51], a[76:79], a[112:115], v[48:51]
  s_add_u32 m0, s51, 50784
  v_mfma_f32_16x16x32_bf16 v[48:51], a[72:75], a[96:99], v[48:51]
  buffer_load_dwordx4 v4, s[12:15], s48 offen offset:3072 lds
  v_mfma_f32_16x16x32_bf16 v[48:51], a[68:71], a[208:211], v[48:51]
  v_mfma_f32_16x16x32_bf16 v[48:51], a[64:67], a[192:195], v[48:51]
  s_waitcnt lgkmcnt(6)
  v_mfma_f32_16x16x32_bf16 a[0:3], a[80:83], a[192:195], a[0:3]
  s_waitcnt lgkmcnt(4)
  v_mfma_f32_16x16x32_bf16 a[0:3], a[84:87], a[208:211], a[0:3]
  s_waitcnt lgkmcnt(2)
  ds_read_b64_tr_b16 a[64:65], v41 offset:32
  v_mfma_f32_16x16x32_bf16 a[0:3], a[88:91], a[96:99], a[0:3]
  s_waitcnt lgkmcnt(1)
  ds_read_b64_tr_b16 a[66:67], v41 offset:160
  v_mfma_f32_16x16x32_bf16 a[0:3], a[92:95], a[112:115], a[0:3]
  ds_read_b64_tr_b16 a[68:69], v41 offset:288
  v_mfma_f32_16x16x32_bf16 a[4:7], a[92:95], a[116:119], a[4:7]
  v_mfma_f32_16x16x32_bf16 a[4:7], a[88:91], a[100:103], a[4:7]
  ds_read_b64_tr_b16 a[70:71], v41 offset:416
  v_mfma_f32_16x16x32_bf16 a[4:7], a[84:87], a[212:215], a[4:7]
  ds_read_b64_tr_b16 a[72:73], v41 offset:16928
  v_mfma_f32_16x16x32_bf16 a[4:7], a[80:83], a[196:199], a[4:7]
  ds_read_b64_tr_b16 a[74:75], v41 offset:17056
  v_mfma_f32_16x16x32_bf16 a[8:11], a[80:83], a[200:203], a[8:11]
  v_mfma_f32_16x16x32_bf16 a[8:11], a[84:87], a[216:219], a[8:11]
  ds_read_b64_tr_b16 a[76:77], v41 offset:17184
  v_mfma_f32_16x16x32_bf16 a[8:11], a[88:91], a[104:107], a[8:11]
  ds_read_b64_tr_b16 a[78:79], v41 offset:17312
  v_mfma_f32_16x16x32_bf16 a[8:11], a[92:95], a[120:123], a[8:11]
  v_mfma_f32_16x16x32_bf16 a[12:15], a[92:95], a[124:127], a[12:15]
  v_mfma_f32_16x16x32_bf16 a[12:15], a[88:91], a[108:111], a[12:15]
  v_mfma_f32_16x16x32_bf16 a[12:15], a[84:87], a[220:223], a[12:15]
  v_mfma_f32_16x16x32_bf16 a[12:15], a[80:83], a[204:207], a[12:15]
  s_waitcnt lgkmcnt(6)
  v_mfma_f32_16x16x32_bf16 v[76:79], a[64:67], a[204:207], v[76:79]
  s_waitcnt lgkmcnt(4)
  v_mfma_f32_16x16x32_bf16 v[76:79], a[68:71], a[220:223], v[76:79]
  s_waitcnt lgkmcnt(2)
  ds_read_b64_tr_b16 a[80:81], v41 offset:8480
  v_mfma_f32_16x16x32_bf16 v[76:79], a[72:75], a[108:111], v[76:79]
  s_waitcnt lgkmcnt(1)
  ds_read_b64_tr_b16 a[82:83], v41 offset:8608
  v_mfma_f32_16x16x32_bf16 v[76:79], a[76:79], a[124:127], v[76:79]
  ds_read_b64_tr_b16 a[84:85], v41 offset:8736
  v_accvgpr_read_b32 v12, a0
  v_mfma_f32_16x16x32_bf16 v[72:75], a[76:79], a[120:123], v[72:75]
  v_accvgpr_read_b32 v13, a1
  v_accvgpr_read_b32 v14, a2
  v_mfma_f32_16x16x32_bf16 v[72:75], a[72:75], a[104:107], v[72:75]
  ds_read_b64_tr_b16 a[86:87], v41 offset:8864
  v_accvgpr_read_b32 v15, a3
  v_mfma_f32_16x16x32_bf16 v[72:75], a[68:71], a[216:219], v[72:75]
  ds_read_b64_tr_b16 a[88:89], v41 offset:25376
  v_mul_f32 v12, v12, v48
  v_mfma_f32_16x16x32_bf16 v[72:75], a[64:67], a[200:203], v[72:75]
  ds_read_b64_tr_b16 a[90:91], v41 offset:25504
  v_mul_f32 v13, v13, v49
  v_mfma_f32_16x16x32_bf16 v[68:71], a[64:67], a[196:199], v[68:71]
  v_mul_f32 v14, v14, v50
  v_mul_f32 v15, v15, v51
  v_mfma_f32_16x16x32_bf16 v[68:71], a[68:71], a[212:215], v[68:71]
  ds_read_b64_tr_b16 a[92:93], v41 offset:25632
  v_cvt_pk_bf16_f32 v48, v12, v13
  v_mfma_f32_16x16x32_bf16 v[68:71], a[72:75], a[100:103], v[68:71]
  ds_read_b64_tr_b16 a[94:95], v41 offset:25760
  v_cvt_pk_bf16_f32 v49, v14, v15
  v_mfma_f32_16x16x32_bf16 v[68:71], a[76:79], a[116:119], v[68:71]
  v_accvgpr_read_b32 v16, a4
  v_accvgpr_read_b32 v17, a5
  v_mfma_f32_16x16x32_bf16 v[64:67], a[76:79], a[112:115], v[64:67]
  v_accvgpr_read_b32 v18, a6
  v_accvgpr_read_b32 v19, a7
  v_mfma_f32_16x16x32_bf16 v[64:67], a[72:75], a[96:99], v[64:67]
  v_mul_f32 v16, v16, v52
  v_mul_f32 v17, v17, v53
  v_mfma_f32_16x16x32_bf16 v[64:67], a[68:71], a[208:211], v[64:67]
  v_mul_f32 v18, v18, v54
  v_mul_f32 v19, v19, v55
  v_mfma_f32_16x16x32_bf16 v[64:67], a[64:67], a[192:195], v[64:67]
  s_waitcnt lgkmcnt(6)
  v_cvt_pk_bf16_f32 v52, v16, v17
  v_cvt_pk_bf16_f32 v53, v18, v19
  v_mfma_f32_16x16x32_bf16 a[16:19], a[80:83], a[192:195], a[16:19]
  s_waitcnt lgkmcnt(4)
  v_accvgpr_read_b32 v12, a8
  v_accvgpr_read_b32 v13, a9
  v_mfma_f32_16x16x32_bf16 a[16:19], a[84:87], a[208:211], a[16:19]
  s_waitcnt lgkmcnt(2)
  ds_read_b64_tr_b16 a[64:65], v41 offset:64
  v_accvgpr_read_b32 v14, a10
  v_mfma_f32_16x16x32_bf16 a[16:19], a[88:91], a[96:99], a[16:19]
  s_waitcnt lgkmcnt(1)
  ds_read_b64_tr_b16 a[66:67], v41 offset:192
  v_accvgpr_read_b32 v15, a11
  v_mfma_f32_16x16x32_bf16 a[16:19], a[92:95], a[112:115], a[16:19]
  ds_read_b64_tr_b16 a[68:69], v41 offset:320
  v_mul_f32 v12, v12, v56
  v_mfma_f32_16x16x32_bf16 a[20:23], a[92:95], a[116:119], a[20:23]
  v_mul_f32 v13, v13, v57
  v_mul_f32 v14, v14, v58
  v_mfma_f32_16x16x32_bf16 a[20:23], a[88:91], a[100:103], a[20:23]
  ds_read_b64_tr_b16 a[70:71], v41 offset:448
  v_mul_f32 v15, v15, v59
  v_mfma_f32_16x16x32_bf16 a[20:23], a[84:87], a[212:215], a[20:23]
  ds_read_b64_tr_b16 a[72:73], v41 offset:16960
  v_cvt_pk_bf16_f32 v56, v12, v13
  v_mfma_f32_16x16x32_bf16 a[20:23], a[80:83], a[196:199], a[20:23]
  ds_read_b64_tr_b16 a[74:75], v41 offset:17088
  v_cvt_pk_bf16_f32 v57, v14, v15
  v_mfma_f32_16x16x32_bf16 a[24:27], a[80:83], a[200:203], a[24:27]
  v_accvgpr_read_b32 v16, a12
  v_accvgpr_read_b32 v17, a13
  v_mfma_f32_16x16x32_bf16 a[24:27], a[84:87], a[216:219], a[24:27]
  ds_read_b64_tr_b16 a[76:77], v41 offset:17216
  v_accvgpr_read_b32 v18, a14
  v_mfma_f32_16x16x32_bf16 a[24:27], a[88:91], a[104:107], a[24:27]
  ds_read_b64_tr_b16 a[78:79], v41 offset:17344
  v_accvgpr_read_b32 v19, a15
  v_mfma_f32_16x16x32_bf16 a[24:27], a[92:95], a[120:123], a[24:27]
  v_mul_f32 v16, v16, v60
  v_mul_f32 v17, v17, v61
  v_mfma_f32_16x16x32_bf16 a[28:31], a[92:95], a[124:127], a[28:31]
  v_mul_f32 v18, v18, v62
  v_mul_f32 v19, v19, v63
  v_mfma_f32_16x16x32_bf16 a[28:31], a[88:91], a[108:111], a[28:31]
  v_cvt_pk_bf16_f32 v60, v16, v17
  v_cvt_pk_bf16_f32 v61, v18, v19
  v_mfma_f32_16x16x32_bf16 a[28:31], a[84:87], a[220:223], a[28:31]
  v_mfma_f32_16x16x32_bf16 a[28:31], a[80:83], a[204:207], a[28:31]
  s_waitcnt lgkmcnt(6)
  v_mfma_f32_16x16x32_bf16 v[92:95], a[64:67], a[204:207], v[92:95]
  s_waitcnt lgkmcnt(4)
  v_mfma_f32_16x16x32_bf16 v[92:95], a[68:71], a[220:223], v[92:95]
  s_waitcnt lgkmcnt(2)
  ds_read_b64_tr_b16 a[80:81], v41 offset:8512
  v_mfma_f32_16x16x32_bf16 v[92:95], a[72:75], a[108:111], v[92:95]
  s_waitcnt lgkmcnt(1)
  ds_read_b64_tr_b16 a[82:83], v41 offset:8640
  v_mfma_f32_16x16x32_bf16 v[92:95], a[76:79], a[124:127], v[92:95]
  ds_read_b64_tr_b16 a[84:85], v41 offset:8768
  v_accvgpr_read_b32 v12, a16
  v_mfma_f32_16x16x32_bf16 v[88:91], a[76:79], a[120:123], v[88:91]
  v_accvgpr_read_b32 v13, a17
  v_accvgpr_read_b32 v14, a18
  v_mfma_f32_16x16x32_bf16 v[88:91], a[72:75], a[104:107], v[88:91]
  ds_read_b64_tr_b16 a[86:87], v41 offset:8896
  v_accvgpr_read_b32 v15, a19
  v_mfma_f32_16x16x32_bf16 v[88:91], a[68:71], a[216:219], v[88:91]
  ds_read_b64_tr_b16 a[88:89], v41 offset:25408
  v_mul_f32 v12, v12, v64
  v_mfma_f32_16x16x32_bf16 v[88:91], a[64:67], a[200:203], v[88:91]
  ds_read_b64_tr_b16 a[90:91], v41 offset:25536
  v_mul_f32 v13, v13, v65
  v_mfma_f32_16x16x32_bf16 v[84:87], a[64:67], a[196:199], v[84:87]
  v_mul_f32 v14, v14, v66
  v_mul_f32 v15, v15, v67
  v_mfma_f32_16x16x32_bf16 v[84:87], a[68:71], a[212:215], v[84:87]
  ds_read_b64_tr_b16 a[92:93], v41 offset:25664
  v_cvt_pk_bf16_f32 v50, v12, v13
  v_mfma_f32_16x16x32_bf16 v[84:87], a[72:75], a[100:103], v[84:87]
  ds_read_b64_tr_b16 a[94:95], v41 offset:25792
  v_cvt_pk_bf16_f32 v51, v14, v15
  v_mfma_f32_16x16x32_bf16 v[84:87], a[76:79], a[116:119], v[84:87]
  v_accvgpr_read_b32 v16, a20
  v_accvgpr_read_b32 v17, a21
  v_mfma_f32_16x16x32_bf16 v[80:83], a[76:79], a[112:115], v[80:83]
  v_accvgpr_read_b32 v18, a22
  v_accvgpr_read_b32 v19, a23
  v_mfma_f32_16x16x32_bf16 v[80:83], a[72:75], a[96:99], v[80:83]
  v_mul_f32 v16, v16, v68
  v_mul_f32 v17, v17, v69
  v_mfma_f32_16x16x32_bf16 v[80:83], a[68:71], a[208:211], v[80:83]
  v_mul_f32 v18, v18, v70
  v_mul_f32 v19, v19, v71
  v_mfma_f32_16x16x32_bf16 v[80:83], a[64:67], a[192:195], v[80:83]
  s_waitcnt lgkmcnt(6)
  v_cvt_pk_bf16_f32 v54, v16, v17
  v_cvt_pk_bf16_f32 v55, v18, v19
  v_mfma_f32_16x16x32_bf16 a[32:35], a[80:83], a[192:195], a[32:35]
  s_waitcnt lgkmcnt(4)
  v_accvgpr_read_b32 v12, a24
  v_accvgpr_read_b32 v13, a25
  v_mfma_f32_16x16x32_bf16 a[32:35], a[84:87], a[208:211], a[32:35]
  s_waitcnt lgkmcnt(2)
  ds_read_b64_tr_b16 a[64:65], v41 offset:96
  v_accvgpr_read_b32 v14, a26
  v_mfma_f32_16x16x32_bf16 a[32:35], a[88:91], a[96:99], a[32:35]
  s_waitcnt lgkmcnt(1)
  ds_read_b64_tr_b16 a[66:67], v41 offset:224
  v_accvgpr_read_b32 v15, a27
  v_mfma_f32_16x16x32_bf16 a[32:35], a[92:95], a[112:115], a[32:35]
  ds_read_b64_tr_b16 a[68:69], v41 offset:352
  v_mul_f32 v12, v12, v72
  v_mfma_f32_16x16x32_bf16 a[36:39], a[92:95], a[116:119], a[36:39]
  v_mul_f32 v13, v13, v73
  v_mul_f32 v14, v14, v74
  v_mfma_f32_16x16x32_bf16 a[36:39], a[88:91], a[100:103], a[36:39]
  ds_read_b64_tr_b16 a[70:71], v41 offset:480
  v_mul_f32 v15, v15, v75
  v_mfma_f32_16x16x32_bf16 a[36:39], a[84:87], a[212:215], a[36:39]
  ds_read_b64_tr_b16 a[72:73], v41 offset:16992
  v_cvt_pk_bf16_f32 v58, v12, v13
  v_mfma_f32_16x16x32_bf16 a[36:39], a[80:83], a[196:199], a[36:39]
  ds_read_b64_tr_b16 a[74:75], v41 offset:17120
  v_cvt_pk_bf16_f32 v59, v14, v15
  v_mfma_f32_16x16x32_bf16 a[40:43], a[80:83], a[200:203], a[40:43]
  v_accvgpr_read_b32 v16, a28
  v_accvgpr_read_b32 v17, a29
  v_mfma_f32_16x16x32_bf16 a[40:43], a[84:87], a[216:219], a[40:43]
  ds_read_b64_tr_b16 a[76:77], v41 offset:17248
  v_accvgpr_read_b32 v18, a30
  v_mfma_f32_16x16x32_bf16 a[40:43], a[88:91], a[104:107], a[40:43]
  ds_read_b64_tr_b16 a[78:79], v41 offset:17376
  v_accvgpr_read_b32 v19, a31
  v_mfma_f32_16x16x32_bf16 a[40:43], a[92:95], a[120:123], a[40:43]
  v_mul_f32 v16, v16, v76
  v_mul_f32 v17, v17, v77
  v_mfma_f32_16x16x32_bf16 a[44:47], a[92:95], a[124:127], a[44:47]
  v_mul_f32 v18, v18, v78
  v_mul_f32 v19, v19, v79
  v_mfma_f32_16x16x32_bf16 a[44:47], a[88:91], a[108:111], a[44:47]
  v_cvt_pk_bf16_f32 v62, v16, v17
  v_cvt_pk_bf16_f32 v63, v18, v19
  v_mfma_f32_16x16x32_bf16 a[44:47], a[84:87], a[220:223], a[44:47]
  v_mfma_f32_16x16x32_bf16 a[44:47], a[80:83], a[204:207], a[44:47]
  s_waitcnt lgkmcnt(6)
  v_mfma_f32_16x16x32_bf16 v[108:111], a[64:67], a[204:207], v[108:111]
  s_waitcnt lgkmcnt(4)
  v_mfma_f32_16x16x32_bf16 v[108:111], a[68:71], a[220:223], v[108:111]
  s_waitcnt lgkmcnt(2)
  ds_read_b64_tr_b16 a[80:81], v41 offset:8544
  v_mfma_f32_16x16x32_bf16 v[108:111], a[72:75], a[108:111], v[108:111]
  s_waitcnt lgkmcnt(1)
  ds_read_b64_tr_b16 a[82:83], v41 offset:8672
  v_mfma_f32_16x16x32_bf16 v[108:111], a[76:79], a[124:127], v[108:111]
  ds_read_b64_tr_b16 a[84:85], v41 offset:8800
  v_accvgpr_read_b32 v12, a32
  v_mfma_f32_16x16x32_bf16 v[104:107], a[76:79], a[120:123], v[104:107]
  v_accvgpr_read_b32 v13, a33
  v_accvgpr_read_b32 v14, a34
  v_mfma_f32_16x16x32_bf16 v[104:107], a[72:75], a[104:107], v[104:107]
  ds_read_b64_tr_b16 a[86:87], v41 offset:8928
  v_accvgpr_read_b32 v15, a35
  v_mfma_f32_16x16x32_bf16 v[104:107], a[68:71], a[216:219], v[104:107]
  ds_read_b64_tr_b16 a[88:89], v41 offset:25440
  v_mul_f32 v12, v12, v80
  v_mfma_f32_16x16x32_bf16 v[104:107], a[64:67], a[200:203], v[104:107]
  ds_read_b64_tr_b16 a[90:91], v41 offset:25568
  v_mul_f32 v13, v13, v81
  v_mfma_f32_16x16x32_bf16 v[100:103], a[64:67], a[196:199], v[100:103]
  v_mul_f32 v14, v14, v82
  v_mul_f32 v15, v15, v83
  v_mfma_f32_16x16x32_bf16 v[100:103], a[68:71], a[212:215], v[100:103]
  ds_read_b64_tr_b16 a[92:93], v41 offset:25696
  v_cvt_pk_bf16_f32 v80, v12, v13
  v_mfma_f32_16x16x32_bf16 v[100:103], a[72:75], a[100:103], v[100:103]
  ds_read_b64_tr_b16 a[94:95], v41 offset:25824
  v_cvt_pk_bf16_f32 v81, v14, v15
  v_mfma_f32_16x16x32_bf16 v[100:103], a[76:79], a[116:119], v[100:103]
  v_accvgpr_read_b32 v16, a36
  v_accvgpr_read_b32 v17, a37
  v_mfma_f32_16x16x32_bf16 v[96:99], a[76:79], a[112:115], v[96:99]
  v_accvgpr_read_b32 v18, a38
  v_accvgpr_read_b32 v19, a39
  v_mfma_f32_16x16x32_bf16 v[96:99], a[72:75], a[96:99], v[96:99]
  v_mul_f32 v16, v16, v84
  v_mul_f32 v17, v17, v85
  v_mfma_f32_16x16x32_bf16 v[96:99], a[68:71], a[208:211], v[96:99]
  s_waitcnt vmcnt(17)
  v_mul_f32 v18, v18, v86
  v_mul_f32 v19, v19, v87
  v_mfma_f32_16x16x32_bf16 v[96:99], a[64:67], a[192:195], v[96:99]
  s_waitcnt lgkmcnt(6)
  s_waitcnt lgkmcnt(0)
  v_cvt_pk_bf16_f32 v84, v16, v17
  v_cvt_pk_bf16_f32 v85, v18, v19
  v_mfma_f32_16x16x32_bf16 a[48:51], a[80:83], a[192:195], a[48:51]
  s_barrier
  v_mfma_f32_16x16x32_bf16 a[48:51], a[84:87], a[208:211], a[48:51]
  ds_read_b64_tr_b16 a[64:65], v40 offset:0
  v_mfma_f32_16x16x32_bf16 a[48:51], a[88:91], a[96:99], a[48:51]
  ds_read_b64_tr_b16 a[66:67], v40 offset:256
  v_mfma_f32_16x16x32_bf16 a[48:51], a[92:95], a[112:115], a[48:51]
  ds_read_b64_tr_b16 a[68:69], v40 offset:512
  v_mfma_f32_16x16x32_bf16 a[52:55], a[92:95], a[116:119], a[52:55]
  buffer_store_dwordx4 v[48:51], v1, s[8:11], s86 offen offset:0 sc1
  v_mfma_f32_16x16x32_bf16 a[52:55], a[88:91], a[100:103], a[52:55]
  ds_read_b64_tr_b16 a[70:71], v40 offset:768
  v_accvgpr_read_b32 v12, a40
  v_mfma_f32_16x16x32_bf16 a[52:55], a[84:87], a[212:215], a[52:55]
  ds_read_b64_tr_b16 a[72:73], v40 offset:16896
  v_accvgpr_read_b32 v13, a41
  v_mfma_f32_16x16x32_bf16 a[52:55], a[80:83], a[196:199], a[52:55]
  ds_read_b64_tr_b16 a[74:75], v40 offset:17152
  v_accvgpr_read_b32 v14, a42
  v_mfma_f32_16x16x32_bf16 a[56:59], a[80:83], a[200:203], a[56:59]
  v_accvgpr_read_b32 v15, a43
  v_mul_f32 v12, v12, v88
  v_mfma_f32_16x16x32_bf16 a[56:59], a[84:87], a[216:219], a[56:59]
  ds_read_b64_tr_b16 a[76:77], v40 offset:17408
  v_mul_f32 v13, v13, v89
  v_mfma_f32_16x16x32_bf16 a[56:59], a[88:91], a[104:107], a[56:59]
  ds_read_b64_tr_b16 a[78:79], v40 offset:17664
  v_mul_f32 v14, v14, v90
  v_mfma_f32_16x16x32_bf16 a[56:59], a[92:95], a[120:123], a[56:59]
  v_mul_f32 v15, v15, v91
  v_cvt_pk_bf16_f32 v88, v12, v13
  v_mfma_f32_16x16x32_bf16 a[60:63], a[92:95], a[124:127], a[60:63]
  v_cvt_pk_bf16_f32 v89, v14, v15
  v_accvgpr_read_b32 v16, a44
  v_mfma_f32_16x16x32_bf16 a[60:63], a[88:91], a[108:111], a[60:63]
  v_accvgpr_read_b32 v17, a45
  v_accvgpr_read_b32 v18, a46
  v_mfma_f32_16x16x32_bf16 a[60:63], a[84:87], a[220:223], a[60:63]
  v_accvgpr_read_b32 v19, a47
  v_mul_f32 v16, v16, v92
  v_mfma_f32_16x16x32_bf16 a[60:63], a[80:83], a[204:207], a[60:63]
  s_waitcnt lgkmcnt(6)
  v_mul_f32 v17, v17, v93
  v_mul_f32 v18, v18, v94
  v_mfma_f32_16x16x32_bf16 v[152:155], a[64:67], a[204:207], v[152:155]
  s_waitcnt lgkmcnt(4)
  v_mul_f32 v19, v19, v95
  v_cvt_pk_bf16_f32 v92, v16, v17
  v_mfma_f32_16x16x32_bf16 v[152:155], a[68:71], a[220:223], v[152:155]
  s_waitcnt lgkmcnt(2)
  ds_read_b64_tr_b16 a[80:81], v40 offset:8
  v_cvt_pk_bf16_f32 v93, v18, v19
  v_mfma_f32_16x16x32_bf16 v[152:155], a[72:75], a[108:111], v[152:155]
  s_waitcnt lgkmcnt(1)
  ds_read_b64_tr_b16 a[82:83], v40 offset:264
  v_mfma_f32_16x16x32_bf16 v[152:155], a[76:79], a[124:127], v[152:155]
  ds_read_b64_tr_b16 a[84:85], v40 offset:520
  v_mfma_f32_16x16x32_bf16 v[144:147], a[76:79], a[120:123], v[144:147]
  buffer_store_dwordx4 v[52:55], v1, s[8:11], s86 offen offset:1024 sc1
  v_mfma_f32_16x16x32_bf16 v[144:147], a[72:75], a[104:107], v[144:147]
  ds_read_b64_tr_b16 a[86:87], v40 offset:776
  v_accvgpr_read_b32 v12, a48
  v_mfma_f32_16x16x32_bf16 v[144:147], a[68:71], a[216:219], v[144:147]
  ds_read_b64_tr_b16 a[88:89], v40 offset:16904
  v_accvgpr_read_b32 v13, a49
  v_mfma_f32_16x16x32_bf16 v[144:147], a[64:67], a[200:203], v[144:147]
  ds_read_b64_tr_b16 a[90:91], v40 offset:17160
  v_accvgpr_read_b32 v14, a50
  v_mfma_f32_16x16x32_bf16 v[136:139], a[64:67], a[196:199], v[136:139]
  v_accvgpr_read_b32 v15, a51
  v_mul_f32 v12, v12, v96
  v_mfma_f32_16x16x32_bf16 v[136:139], a[68:71], a[212:215], v[136:139]
  ds_read_b64_tr_b16 a[92:93], v40 offset:17416
  v_mul_f32 v13, v13, v97
  v_mfma_f32_16x16x32_bf16 v[136:139], a[72:75], a[100:103], v[136:139]
  ds_read_b64_tr_b16 a[94:95], v40 offset:17672
  v_mul_f32 v14, v14, v98
  v_mfma_f32_16x16x32_bf16 v[136:139], a[76:79], a[116:119], v[136:139]
  v_mul_f32 v15, v15, v99
  v_cvt_pk_bf16_f32 v82, v12, v13
  v_mfma_f32_16x16x32_bf16 v[128:131], a[76:79], a[112:115], v[128:131]
  v_cvt_pk_bf16_f32 v83, v14, v15
  v_accvgpr_read_b32 v16, a52
  v_mfma_f32_16x16x32_bf16 v[128:131], a[72:75], a[96:99], v[128:131]
  v_accvgpr_read_b32 v17, a53
  v_accvgpr_read_b32 v18, a54
  v_mfma_f32_16x16x32_bf16 v[128:131], a[68:71], a[208:211], v[128:131]
  v_accvgpr_read_b32 v19, a55
  v_mul_f32 v16, v16, v100
  v_mfma_f32_16x16x32_bf16 v[128:131], a[64:67], a[192:195], v[128:131]
  s_waitcnt lgkmcnt(6)
  v_mul_f32 v17, v17, v101
  v_mul_f32 v18, v18, v102
  v_mfma_f32_16x16x32_bf16 v[132:135], a[80:83], a[192:195], v[132:135]
  s_waitcnt lgkmcnt(4)
  v_mul_f32 v19, v19, v103
  v_cvt_pk_bf16_f32 v86, v16, v17
  v_mfma_f32_16x16x32_bf16 v[132:135], a[84:87], a[208:211], v[132:135]
  s_waitcnt lgkmcnt(2)
  ds_read_b64_tr_b16 a[64:65], v40 offset:64
  v_cvt_pk_bf16_f32 v87, v18, v19
  v_mfma_f32_16x16x32_bf16 v[132:135], a[88:91], a[96:99], v[132:135]
  s_waitcnt lgkmcnt(1)
  ds_read_b64_tr_b16 a[66:67], v40 offset:320
  v_mfma_f32_16x16x32_bf16 v[132:135], a[92:95], a[112:115], v[132:135]
  ds_read_b64_tr_b16 a[68:69], v40 offset:576
  v_mfma_f32_16x16x32_bf16 v[140:143], a[92:95], a[116:119], v[140:143]
  buffer_store_dwordx4 v[56:59], v1, s[8:11], s86 offen offset:2048 sc1
  v_mfma_f32_16x16x32_bf16 v[140:143], a[88:91], a[100:103], v[140:143]
  ds_read_b64_tr_b16 a[70:71], v40 offset:832
  v_accvgpr_read_b32 v12, a56
  v_mfma_f32_16x16x32_bf16 v[140:143], a[84:87], a[212:215], v[140:143]
  ds_read_b64_tr_b16 a[72:73], v40 offset:16960
  v_accvgpr_read_b32 v13, a57
  v_mfma_f32_16x16x32_bf16 v[140:143], a[80:83], a[196:199], v[140:143]
  ds_read_b64_tr_b16 a[74:75], v40 offset:17216
  v_accvgpr_read_b32 v14, a58
  v_mfma_f32_16x16x32_bf16 v[148:151], a[80:83], a[200:203], v[148:151]
  v_accvgpr_read_b32 v15, a59
  v_mul_f32 v12, v12, v104
  v_mfma_f32_16x16x32_bf16 v[148:151], a[84:87], a[216:219], v[148:151]
  ds_read_b64_tr_b16 a[76:77], v40 offset:17472
  v_mul_f32 v13, v13, v105
  v_mfma_f32_16x16x32_bf16 v[148:151], a[88:91], a[104:107], v[148:151]
  ds_read_b64_tr_b16 a[78:79], v40 offset:17728
  v_mul_f32 v14, v14, v106
  v_mfma_f32_16x16x32_bf16 v[148:151], a[92:95], a[120:123], v[148:151]
  v_mul_f32 v15, v15, v107
  v_cvt_pk_bf16_f32 v90, v12, v13
  v_mfma_f32_16x16x32_bf16 v[156:159], a[92:95], a[124:127], v[156:159]
  v_cvt_pk_bf16_f32 v91, v14, v15
  v_accvgpr_read_b32 v16, a60
  v_mfma_f32_16x16x32_bf16 v[156:159], a[88:91], a[108:111], v[156:159]
  v_accvgpr_read_b32 v17, a61
  v_accvgpr_read_b32 v18, a62
  v_mfma_f32_16x16x32_bf16 v[156:159], a[84:87], a[220:223], v[156:159]
  v_accvgpr_read_b32 v19, a63
  v_mul_f32 v16, v16, v108
  v_mfma_f32_16x16x32_bf16 v[156:159], a[80:83], a[204:207], v[156:159]
  s_waitcnt lgkmcnt(6)
  v_mul_f32 v17, v17, v109
  v_mul_f32 v18, v18, v110
  v_mfma_f32_16x16x32_bf16 v[184:187], a[64:67], a[204:207], v[184:187]
  s_waitcnt lgkmcnt(4)
  v_mul_f32 v19, v19, v111
  v_cvt_pk_bf16_f32 v94, v16, v17
  v_mfma_f32_16x16x32_bf16 v[184:187], a[68:71], a[220:223], v[184:187]
  s_waitcnt lgkmcnt(2)
  ds_read_b64_tr_b16 a[80:81], v40 offset:72
  v_cvt_pk_bf16_f32 v95, v18, v19
  v_mfma_f32_16x16x32_bf16 v[184:187], a[72:75], a[108:111], v[184:187]
  s_waitcnt lgkmcnt(1)
  ds_read_b64_tr_b16 a[82:83], v40 offset:328
  v_mfma_f32_16x16x32_bf16 v[184:187], a[76:79], a[124:127], v[184:187]
  ds_read_b64_tr_b16 a[84:85], v40 offset:584
  v_mfma_f32_16x16x32_bf16 v[176:179], a[76:79], a[120:123], v[176:179]
  buffer_store_dwordx4 v[60:63], v1, s[8:11], s86 offen offset:3072 sc1
  v_mfma_f32_16x16x32_bf16 v[176:179], a[72:75], a[104:107], v[176:179]
  ds_read_b64_tr_b16 a[86:87], v40 offset:840
  v_cvt_pk_bf16_f32 v128, v128, v129
  v_mfma_f32_16x16x32_bf16 v[176:179], a[68:71], a[216:219], v[176:179]
  ds_read_b64_tr_b16 a[88:89], v40 offset:16968
  v_cvt_pk_bf16_f32 v129, v130, v131
  v_mfma_f32_16x16x32_bf16 v[176:179], a[64:67], a[200:203], v[176:179]
  ds_read_b64_tr_b16 a[90:91], v40 offset:17224
  v_cvt_pk_bf16_f32 v130, v132, v133
  v_mfma_f32_16x16x32_bf16 v[168:171], a[64:67], a[196:199], v[168:171]
  v_cvt_pk_bf16_f32 v131, v134, v135
  v_cvt_pk_bf16_f32 v132, v136, v137
  v_mfma_f32_16x16x32_bf16 v[168:171], a[68:71], a[212:215], v[168:171]
  ds_read_b64_tr_b16 a[92:93], v40 offset:17480
  v_cvt_pk_bf16_f32 v133, v138, v139
  v_mfma_f32_16x16x32_bf16 v[168:171], a[72:75], a[100:103], v[168:171]
  ds_read_b64_tr_b16 a[94:95], v40 offset:17736
  v_cvt_pk_bf16_f32 v134, v140, v141
  v_mfma_f32_16x16x32_bf16 v[168:171], a[76:79], a[116:119], v[168:171]
  v_cvt_pk_bf16_f32 v135, v142, v143
  v_cvt_pk_bf16_f32 v136, v144, v145
  v_mfma_f32_16x16x32_bf16 v[160:163], a[76:79], a[112:115], v[160:163]
  v_cvt_pk_bf16_f32 v137, v146, v147
  v_cvt_pk_bf16_f32 v138, v148, v149
  v_mfma_f32_16x16x32_bf16 v[160:163], a[72:75], a[96:99], v[160:163]
  v_cvt_pk_bf16_f32 v139, v150, v151
  v_cvt_pk_bf16_f32 v140, v152, v153
  v_mfma_f32_16x16x32_bf16 v[160:163], a[68:71], a[208:211], v[160:163]
  v_cvt_pk_bf16_f32 v141, v154, v155
  v_cvt_pk_bf16_f32 v142, v156, v157
  v_mfma_f32_16x16x32_bf16 v[160:163], a[64:67], a[192:195], v[160:163]
  s_waitcnt lgkmcnt(6)
  v_cvt_pk_bf16_f32 v143, v158, v159
  v_mfma_f32_16x16x32_bf16 v[164:167], a[80:83], a[192:195], v[164:167]
  s_waitcnt lgkmcnt(4)
  buffer_store_dwordx4 v[80:83], v124, s[8:11], s86 offen offset:0 sc1
  v_mfma_f32_16x16x32_bf16 v[164:167], a[84:87], a[208:211], v[164:167]
  s_waitcnt lgkmcnt(2)
  ds_read_b64_tr_b16 a[64:65], v40 offset:128
  v_mfma_f32_16x16x32_bf16 v[164:167], a[88:91], a[96:99], v[164:167]
  s_waitcnt lgkmcnt(1)
  ds_read_b64_tr_b16 a[66:67], v40 offset:384
  v_mfma_f32_16x16x32_bf16 v[164:167], a[92:95], a[112:115], v[164:167]
  ds_read_b64_tr_b16 a[68:69], v40 offset:640
  v_cvt_pk_bf16_f32 v144, v160, v161
  v_mfma_f32_16x16x32_bf16 v[172:175], a[92:95], a[116:119], v[172:175]
  v_cvt_pk_bf16_f32 v145, v162, v163
  v_cvt_pk_bf16_f32 v148, v168, v169
  v_mfma_f32_16x16x32_bf16 v[172:175], a[88:91], a[100:103], v[172:175]
  ds_read_b64_tr_b16 a[70:71], v40 offset:896
  v_cvt_pk_bf16_f32 v149, v170, v171
  v_mfma_f32_16x16x32_bf16 v[172:175], a[84:87], a[212:215], v[172:175]
  ds_read_b64_tr_b16 a[72:73], v40 offset:17024
  v_cvt_pk_bf16_f32 v152, v176, v177
  v_mfma_f32_16x16x32_bf16 v[172:175], a[80:83], a[196:199], v[172:175]
  ds_read_b64_tr_b16 a[74:75], v40 offset:17280
  v_cvt_pk_bf16_f32 v153, v178, v179
  v_mfma_f32_16x16x32_bf16 v[180:183], a[80:83], a[200:203], v[180:183]
  v_cvt_pk_bf16_f32 v156, v184, v185
  v_cvt_pk_bf16_f32 v157, v186, v187
  v_mfma_f32_16x16x32_bf16 v[180:183], a[84:87], a[216:219], v[180:183]
  ds_read_b64_tr_b16 a[76:77], v40 offset:17536
  v_mfma_f32_16x16x32_bf16 v[180:183], a[88:91], a[104:107], v[180:183]
  ds_read_b64_tr_b16 a[78:79], v40 offset:17792
  v_mfma_f32_16x16x32_bf16 v[180:183], a[92:95], a[120:123], v[180:183]
  buffer_store_dwordx4 v[84:87], v124, s[8:11], s86 offen offset:1024 sc1
  v_mfma_f32_16x16x32_bf16 v[188:191], a[92:95], a[124:127], v[188:191]
  v_mfma_f32_16x16x32_bf16 v[188:191], a[88:91], a[108:111], v[188:191]
  v_mfma_f32_16x16x32_bf16 v[188:191], a[84:87], a[220:223], v[188:191]
  v_mfma_f32_16x16x32_bf16 v[188:191], a[80:83], a[204:207], v[188:191]
  s_waitcnt lgkmcnt(6)
  v_mfma_f32_16x16x32_bf16 v[216:219], a[64:67], a[204:207], v[216:219]
  s_waitcnt lgkmcnt(4)
  v_mfma_f32_16x16x32_bf16 v[216:219], a[68:71], a[220:223], v[216:219]
  s_waitcnt lgkmcnt(2)
  ds_read_b64_tr_b16 a[80:81], v40 offset:136
  v_mfma_f32_16x16x32_bf16 v[216:219], a[72:75], a[108:111], v[216:219]
  s_waitcnt lgkmcnt(1)
  ds_read_b64_tr_b16 a[82:83], v40 offset:392
  v_mfma_f32_16x16x32_bf16 v[216:219], a[76:79], a[124:127], v[216:219]
  ds_read_b64_tr_b16 a[84:85], v40 offset:648
  v_cvt_pk_bf16_f32 v146, v164, v165
  v_mfma_f32_16x16x32_bf16 v[208:211], a[76:79], a[120:123], v[208:211]
  v_cvt_pk_bf16_f32 v147, v166, v167
  v_cvt_pk_bf16_f32 v150, v172, v173
  v_mfma_f32_16x16x32_bf16 v[208:211], a[72:75], a[104:107], v[208:211]
  ds_read_b64_tr_b16 a[86:87], v40 offset:904
  v_cvt_pk_bf16_f32 v151, v174, v175
  v_mfma_f32_16x16x32_bf16 v[208:211], a[68:71], a[216:219], v[208:211]
  ds_read_b64_tr_b16 a[88:89], v40 offset:17032
  v_cvt_pk_bf16_f32 v154, v180, v181
  v_mfma_f32_16x16x32_bf16 v[208:211], a[64:67], a[200:203], v[208:211]
  ds_read_b64_tr_b16 a[90:91], v40 offset:17288
  v_cvt_pk_bf16_f32 v155, v182, v183
  v_mfma_f32_16x16x32_bf16 v[200:203], a[64:67], a[196:199], v[200:203]
  v_cvt_pk_bf16_f32 v158, v188, v189
  v_cvt_pk_bf16_f32 v159, v190, v191
  v_mfma_f32_16x16x32_bf16 v[200:203], a[68:71], a[212:215], v[200:203]
  ds_read_b64_tr_b16 a[92:93], v40 offset:17544
  v_mfma_f32_16x16x32_bf16 v[200:203], a[72:75], a[100:103], v[200:203]
  ds_read_b64_tr_b16 a[94:95], v40 offset:17800
  v_mfma_f32_16x16x32_bf16 v[200:203], a[76:79], a[116:119], v[200:203]
  buffer_store_dwordx4 v[88:91], v124, s[8:11], s86 offen offset:2048 sc1
  v_mfma_f32_16x16x32_bf16 v[192:195], a[76:79], a[112:115], v[192:195]
  v_mfma_f32_16x16x32_bf16 v[192:195], a[72:75], a[96:99], v[192:195]
  v_mfma_f32_16x16x32_bf16 v[192:195], a[68:71], a[208:211], v[192:195]
  v_mfma_f32_16x16x32_bf16 v[192:195], a[64:67], a[192:195], v[192:195]
  s_waitcnt lgkmcnt(6)
  v_mfma_f32_16x16x32_bf16 v[196:199], a[80:83], a[192:195], v[196:199]
  s_waitcnt lgkmcnt(4)
  v_mfma_f32_16x16x32_bf16 v[196:199], a[84:87], a[208:211], v[196:199]
  s_waitcnt lgkmcnt(2)
  ds_read_b64_tr_b16 a[64:65], v40 offset:192
  v_mfma_f32_16x16x32_bf16 v[196:199], a[88:91], a[96:99], v[196:199]
  s_waitcnt lgkmcnt(1)
  ds_read_b64_tr_b16 a[66:67], v40 offset:448
  v_mfma_f32_16x16x32_bf16 v[196:199], a[92:95], a[112:115], v[196:199]
  ds_read_b64_tr_b16 a[68:69], v40 offset:704
  v_cvt_pk_bf16_f32 v160, v192, v193
  v_mfma_f32_16x16x32_bf16 v[204:207], a[92:95], a[116:119], v[204:207]
  v_cvt_pk_bf16_f32 v161, v194, v195
  v_cvt_pk_bf16_f32 v164, v200, v201
  v_mfma_f32_16x16x32_bf16 v[204:207], a[88:91], a[100:103], v[204:207]
  ds_read_b64_tr_b16 a[70:71], v40 offset:960
  v_cvt_pk_bf16_f32 v165, v202, v203
  v_mfma_f32_16x16x32_bf16 v[204:207], a[84:87], a[212:215], v[204:207]
  ds_read_b64_tr_b16 a[72:73], v40 offset:17088
  v_cvt_pk_bf16_f32 v168, v208, v209
  v_mfma_f32_16x16x32_bf16 v[204:207], a[80:83], a[196:199], v[204:207]
  ds_read_b64_tr_b16 a[74:75], v40 offset:17344
  v_cvt_pk_bf16_f32 v169, v210, v211
  v_mfma_f32_16x16x32_bf16 v[212:215], a[80:83], a[200:203], v[212:215]
  v_cvt_pk_bf16_f32 v172, v216, v217
  v_cvt_pk_bf16_f32 v173, v218, v219
  v_mfma_f32_16x16x32_bf16 v[212:215], a[84:87], a[216:219], v[212:215]
  ds_read_b64_tr_b16 a[76:77], v40 offset:17600
  v_mfma_f32_16x16x32_bf16 v[212:215], a[88:91], a[104:107], v[212:215]
  ds_read_b64_tr_b16 a[78:79], v40 offset:17856
  v_mfma_f32_16x16x32_bf16 v[212:215], a[92:95], a[120:123], v[212:215]
  buffer_store_dwordx4 v[92:95], v124, s[8:11], s86 offen offset:3072 sc1
  v_mfma_f32_16x16x32_bf16 v[220:223], a[92:95], a[124:127], v[220:223]
  v_mfma_f32_16x16x32_bf16 v[220:223], a[88:91], a[108:111], v[220:223]
  v_mfma_f32_16x16x32_bf16 v[220:223], a[84:87], a[220:223], v[220:223]
  v_mfma_f32_16x16x32_bf16 v[220:223], a[80:83], a[204:207], v[220:223]
  s_waitcnt lgkmcnt(6)
  v_mfma_f32_16x16x32_bf16 v[248:251], a[64:67], a[204:207], v[248:251]
  s_waitcnt lgkmcnt(4)
  v_mfma_f32_16x16x32_bf16 v[248:251], a[68:71], a[220:223], v[248:251]
  s_waitcnt lgkmcnt(2)
  ds_read_b64_tr_b16 a[80:81], v40 offset:200
  v_mfma_f32_16x16x32_bf16 v[248:251], a[72:75], a[108:111], v[248:251]
  s_waitcnt lgkmcnt(1)
  ds_read_b64_tr_b16 a[82:83], v40 offset:456
  v_mfma_f32_16x16x32_bf16 v[248:251], a[76:79], a[124:127], v[248:251]
  ds_read_b64_tr_b16 a[84:85], v40 offset:712
  v_cvt_pk_bf16_f32 v162, v196, v197
  v_mfma_f32_16x16x32_bf16 v[240:243], a[76:79], a[120:123], v[240:243]
  v_cvt_pk_bf16_f32 v163, v198, v199
  v_cvt_pk_bf16_f32 v166, v204, v205
  v_mfma_f32_16x16x32_bf16 v[240:243], a[72:75], a[104:107], v[240:243]
  ds_read_b64_tr_b16 a[86:87], v40 offset:968
  v_cvt_pk_bf16_f32 v167, v206, v207
  v_mfma_f32_16x16x32_bf16 v[240:243], a[68:71], a[216:219], v[240:243]
  ds_read_b64_tr_b16 a[88:89], v40 offset:17096
  v_cvt_pk_bf16_f32 v170, v212, v213
  v_mfma_f32_16x16x32_bf16 v[240:243], a[64:67], a[200:203], v[240:243]
  ds_read_b64_tr_b16 a[90:91], v40 offset:17352
  v_cvt_pk_bf16_f32 v171, v214, v215
  v_mfma_f32_16x16x32_bf16 v[232:235], a[64:67], a[196:199], v[232:235]
  v_cvt_pk_bf16_f32 v174, v220, v221
  v_cvt_pk_bf16_f32 v175, v222, v223
  v_mfma_f32_16x16x32_bf16 v[232:235], a[68:71], a[212:215], v[232:235]
  ds_read_b64_tr_b16 a[92:93], v40 offset:17608
  v_mfma_f32_16x16x32_bf16 v[232:235], a[72:75], a[100:103], v[232:235]
  ds_read_b64_tr_b16 a[94:95], v40 offset:17864
  v_mfma_f32_16x16x32_bf16 v[232:235], a[76:79], a[116:119], v[232:235]
  v_mfma_f32_16x16x32_bf16 v[224:227], a[76:79], a[112:115], v[224:227]
  v_mfma_f32_16x16x32_bf16 v[224:227], a[72:75], a[96:99], v[224:227]
  v_mfma_f32_16x16x32_bf16 v[224:227], a[68:71], a[208:211], v[224:227]
  s_waitcnt vmcnt(12)
  v_mfma_f32_16x16x32_bf16 v[224:227], a[64:67], a[192:195], v[224:227]
  s_waitcnt lgkmcnt(6)
  s_waitcnt lgkmcnt(0)
  v_mfma_f32_16x16x32_bf16 v[228:231], a[80:83], a[192:195], v[228:231]
  s_barrier
  v_mfma_f32_16x16x32_bf16 v[228:231], a[84:87], a[208:211], v[228:231]
  ds_read_b128 a[128:131], v2 offset:0
  v_mfma_f32_16x16x32_bf16 v[228:231], a[88:91], a[96:99], v[228:231]
  v_mfma_f32_16x16x32_bf16 v[228:231], a[92:95], a[112:115], v[228:231]
  ds_read_b128 a[132:135], v2 offset:64
  v_cvt_pk_bf16_f32 v176, v224, v225
  v_mfma_f32_16x16x32_bf16 v[236:239], a[92:95], a[116:119], v[236:239]
  v_cvt_pk_bf16_f32 v177, v226, v227
  v_cvt_pk_bf16_f32 v180, v232, v233
  v_mfma_f32_16x16x32_bf16 v[236:239], a[88:91], a[100:103], v[236:239]
  ds_read_b128 a[136:139], v2 offset:128
  v_cvt_pk_bf16_f32 v181, v234, v235
  v_mfma_f32_16x16x32_bf16 v[236:239], a[84:87], a[212:215], v[236:239]
  v_cvt_pk_bf16_f32 v184, v240, v241
  v_cvt_pk_bf16_f32 v185, v242, v243
  v_mfma_f32_16x16x32_bf16 v[236:239], a[80:83], a[196:199], v[236:239]
  ds_read_b128 a[140:143], v2 offset:192
  v_cvt_pk_bf16_f32 v188, v248, v249
  v_mfma_f32_16x16x32_bf16 v[244:247], a[80:83], a[200:203], v[244:247]
  v_cvt_pk_bf16_f32 v189, v250, v251
  v_cvt_pk_bf16_f32 v178, v228, v229
  v_mfma_f32_16x16x32_bf16 v[244:247], a[84:87], a[216:219], v[244:247]
  s_mov_b32 s48, 32768
  v_cvt_pk_bf16_f32 v179, v230, v231
  v_mfma_f32_16x16x32_bf16 v[244:247], a[88:91], a[104:107], v[244:247]
  s_mov_b32 s49, 32768
  v_mfma_f32_16x16x32_bf16 v[244:247], a[92:95], a[120:123], v[244:247]
  s_mov_b32 s20, s32
  v_cvt_pk_bf16_f32 v182, v236, v237
  v_cvt_pk_bf16_f32 v183, v238, v239
  v_mfma_f32_16x16x32_bf16 v[252:255], a[92:95], a[124:127], v[252:255]
  s_mov_b32 s21, s33
  v_mfma_f32_16x16x32_bf16 v[252:255], a[88:91], a[108:111], v[252:255]
  s_mov_b32 s22, s101
  v_mfma_f32_16x16x32_bf16 v[252:255], a[84:87], a[220:223], v[252:255]
  s_cmp_lg_u32 s53, 0
  v_mfma_f32_16x16x32_bf16 v[252:255], a[80:83], a[204:207], v[252:255]
  s_waitcnt lgkmcnt(3)
  v_cvt_pk_bf16_f32 v186, v244, v245
  v_cvt_pk_bf16_f32 v187, v246, v247
  s_cbranch_scc1 L_a_max
L_a_attn:
  v_mfma_f32_16x16x32_bf16 v[192:195], a[128:131], v[128:131], 0
  s_waitcnt lgkmcnt(2)
  v_mfma_f32_16x16x32_bf16 v[192:195], a[132:135], v[144:147], v[192:195]
  s_waitcnt lgkmcnt(1)
  ds_read_b128 a[144:147], v2 offset:256
  v_mfma_f32_16x16x32_bf16 v[192:195], a[136:139], v[160:163], v[192:195]
  s_waitcnt lgkmcnt(1)
  v_mfma_f32_16x16x32_bf16 v[192:195], a[140:143], v[176:179], v[192:195]
  ds_read_b128 a[148:151], v2 offset:320
  v_cvt_pk_bf16_f32 v190, v252, v253
  v_mfma_f32_16x16x32_bf16 v[196:199], a[128:131], v[132:135], 0
  v_cvt_pk_bf16_f32 v191, v254, v255
  v_mfma_f32_16x16x32_bf16 v[196:199], a[132:135], v[148:151], v[196:199]
  ds_read_b128 a[152:155], v2 offset:384
  v_mfma_f32_16x16x32_bf16 v[196:199], a[136:139], v[164:167], v[196:199]
  v_mfma_f32_16x16x32_bf16 v[196:199], a[140:143], v[180:183], v[196:199]
  ds_read_b128 a[156:159], v2 offset:448
  v_max3_f32 v12, v192, v193, v194
  v_mfma_f32_16x16x32_bf16 v[200:203], a[128:131], v[136:139], 0
  s_add_u32 m0, s51, 0
  v_max3_f32 v12, v12, v195, v24
  v_mfma_f32_16x16x32_bf16 v[200:203], a[132:135], v[152:155], v[200:203]
  buffer_load_dwordx4 v4, s[12:15], s48 offen offset:0 lds
  v_mfma_f32_16x16x32_bf16 v[200:203], a[136:139], v[168:171], v[200:203]
  v_mfma_f32_16x16x32_bf16 v[200:203], a[140:143], v[184:187], v[200:203]
  v_max3_f32 v13, v196, v197, v198
  v_max3_f32 v13, v13, v199, v25
  v_mfma_f32_16x16x32_bf16 v[204:207], a[128:131], v[140:143], 0
  s_add_u32 m0, s51, 32
  v_mfma_f32_16x16x32_bf16 v[204:207], a[132:135], v[156:159], v[204:207]
  buffer_load_dwordx4 v4, s[12:15], s48 offen offset:1024 lds
  v_mfma_f32_16x16x32_bf16 v[204:207], a[136:139], v[172:175], v[204:207]
  s_add_u32 m0, s51, 64
  v_mfma_f32_16x16x32_bf16 v[204:207], a[140:143], v[188:191], v[204:207]
  s_waitcnt lgkmcnt(0)
  buffer_load_dwordx4 v4, s[12:15], s48 offen offset:2048 lds
  v_max3_f32 v14, v200, v201, v202
  s_nop 4
  v_max3_f32 v15, v204, v205, v206
  v_max3_f32 v14, v14, v203, v26
  v_max3_f32 v15, v15, v207, v27
  s_nop 0
  v_permlane32_swap_b32 v12, v14
  v_permlane32_swap_b32 v13, v15
  v_max_f32 v12, v12, v14
  v_max_f32 v13, v13, v15
  s_nop 1
  v_permlane16_swap_b32 v12, v13
  v_max_f32 v12, v12, v13
  v_sub_f32 v32, 0, v12
  v_sub_f32 v36, 0, v12
  s_nop 1
  v_permlane16_swap_b32 v32, v36
  v_mov_b32 v40, v32
  v_mov_b32 v44, v36
  s_nop 0
  v_permlane32_swap_b32 v32, v40
  v_permlane32_swap_b32 v36, v44
  v_pk_mov_b32 v[46:47], v[44:45], v[44:45] op_sel:[0,0]
  v_pk_mov_b32 v[42:43], v[40:41], v[40:41] op_sel:[0,0]
  v_pk_mov_b32 v[38:39], v[36:37], v[36:37] op_sel:[0,0]
  v_pk_mov_b32 v[34:35], v[32:33], v[32:33] op_sel:[0,0]
  v_pk_mov_b32 v[44:45], v[44:45], v[44:45] op_sel:[0,0]
  v_pk_mov_b32 v[40:41], v[40:41], v[40:41] op_sel:[0,0]
  v_pk_mov_b32 v[36:37], v[36:37], v[36:37] op_sel:[0,0]
  v_pk_mov_b32 v[32:33], v[32:33], v[32:33] op_sel:[0,0]
  v_pk_add_f32 v[192:193], v[192:193], v[32:33]
  v_pk_add_f32 v[194:195], v[194:195], v[32:33]
  v_pk_add_f32 v[196:197], v[196:197], v[36:37]
  v_pk_add_f32 v[198:199], v[198:199], v[36:37]
  v_pk_add_f32 v[200:201], v[200:201], v[40:41]
  v_pk_add_f32 v[202:203], v[202:203], v[40:41]
  v_pk_add_f32 v[204:205], v[204:205], v[44:45]
  v_pk_add_f32 v[206:207], v[206:207], v[44:45]
  v_mfma_f32_16x16x32_bf16 v[220:223], a[144:147], v[140:143], v[44:47]
  v_exp_f32 v192, v192
  v_mfma_f32_16x16x32_bf16 v[220:223], a[148:151], v[156:159], v[220:223]
  ds_read_b128 a[128:131], v2 offset:512
  v_mfma_f32_16x16x32_bf16 v[220:223], a[152:155], v[172:175], v[220:223]
  v_exp_f32 v193, v193
  v_mfma_f32_16x16x32_bf16 v[220:223], a[156:159], v[188:191], v[220:223]
  ds_read_b128 a[132:135], v2 offset:576
  v_cvt_pk_bf16_f32 v48, v192, v193
  v_mfma_f32_16x16x32_bf16 v[216:219], a[156:159], v[184:187], v[40:43]
  v_exp_f32 v194, v194
  v_mfma_f32_16x16x32_bf16 v[216:219], a[152:155], v[168:171], v[216:219]
  ds_read_b128 a[136:139], v2 offset:640
  v_mfma_f32_16x16x32_bf16 v[216:219], a[148:151], v[152:155], v[216:219]
  v_exp_f32 v195, v195
  v_mfma_f32_16x16x32_bf16 v[216:219], a[144:147], v[136:139], v[216:219]
  ds_read_b128 a[140:143], v2 offset:704
  v_cvt_pk_bf16_f32 v49, v194, v195
  v_mfma_f32_16x16x32_bf16 v[212:215], a[144:147], v[132:135], v[36:39]
  s_add_u32 m0, s51, 96
  v_exp_f32 v196, v196
  v_mfma_f32_16x16x32_bf16 v[212:215], a[148:151], v[148:151], v[212:215]
  buffer_load_dwordx4 v4, s[12:15], s48 offen offset:3072 lds
  v_mfma_f32_16x16x32_bf16 v[212:215], a[152:155], v[164:167], v[212:215]
  v_exp_f32 v197, v197
  v_mfma_f32_16x16x32_bf16 v[212:215], a[156:159], v[180:183], v[212:215]
  v_exp_f32 v198, v198
  v_mfma_f32_16x16x32_bf16 v[208:211], a[156:159], v[176:179], v[32:35]
  v_exp_f32 v199, v199
  v_mfma_f32_16x16x32_bf16 v[208:211], a[152:155], v[160:163], v[208:211]
  v_cvt_pk_bf16_f32 v56, v196, v197
  v_cvt_pk_bf16_f32 v57, v198, v199
  v_mfma_f32_16x16x32_bf16 v[208:211], a[148:151], v[144:147], v[208:211]
  v_exp_f32 v200, v200
  v_mfma_f32_16x16x32_bf16 v[208:211], a[144:147], v[128:131], v[208:211]
  s_waitcnt lgkmcnt(0)
  v_exp_f32 v201, v201
  v_mfma_f32_16x16x32_bf16 v[224:227], a[128:131], v[128:131], v[32:35]
  v_exp_f32 v202, v202
  v_mfma_f32_16x16x32_bf16 v[224:227], a[132:135], v[144:147], v[224:227]
  ds_read_b128 a[144:147], v2 offset:768
  v_cvt_pk_bf16_f32 v64, v200, v201
  v_mfma_f32_16x16x32_bf16 v[224:227], a[136:139], v[160:163], v[224:227]
  v_exp_f32 v203, v203
  v_mfma_f32_16x16x32_bf16 v[224:227], a[140:143], v[176:179], v[224:227]
  ds_read_b128 a[148:151], v2 offset:832
  v_cvt_pk_bf16_f32 v65, v202, v203
  v_mfma_f32_16x16x32_bf16 v[228:231], a[140:143], v[180:183], v[36:39]
  v_exp_f32 v204, v204
  v_mfma_f32_16x16x32_bf16 v[228:231], a[136:139], v[164:167], v[228:231]
  ds_read_b128 a[152:155], v2 offset:896
  v_mfma_f32_16x16x32_bf16 v[228:231], a[132:135], v[148:151], v[228:231]
  v_exp_f32 v205, v205
  v_mfma_f32_16x16x32_bf16 v[228:231], a[128:131], v[132:135], v[228:231]
  ds_read_b128 a[156:159], v2 offset:960
  v_cvt_pk_bf16_f32 v72, v204, v205
  v_mfma_f32_16x16x32_bf16 v[232:235], a[128:131], v[136:139], v[40:43]
  v_exp_f32 v206, v206
  v_mfma_f32_16x16x32_bf16 v[232:235], a[132:135], v[152:155], v[232:235]
  v_exp_f32 v207, v207
  v_mfma_f32_16x16x32_bf16 v[232:235], a[136:139], v[168:171], v[232:235]
  v_exp_f32 v220, v220
  v_mfma_f32_16x16x32_bf16 v[232:235], a[140:143], v[184:187], v[232:235]
  v_exp_f32 v221, v221
  v_mfma_f32_16x16x32_bf16 v[236:239], a[140:143], v[188:191], v[44:47]
  v_cvt_pk_bf16_f32 v73, v206, v207
  v_cvt_pk_bf16_f32 v74, v220, v221
  v_mfma_f32_16x16x32_bf16 v[236:239], a[136:139], v[172:175], v[236:239]
  v_exp_f32 v222, v222
  v_mfma_f32_16x16x32_bf16 v[236:239], a[132:135], v[156:159], v[236:239]
  v_exp_f32 v223, v223
  v_mfma_f32_16x16x32_bf16 v[236:239], a[128:131], v[140:143], v[236:239]
  s_waitcnt lgkmcnt(0)
  v_exp_f32 v216, v216
  v_mfma_f32_16x16x32_bf16 v[252:255], a[144:147], v[140:143], v[44:47]
  v_exp_f32 v217, v217
  v_mfma_f32_16x16x32_bf16 v[252:255], a[148:151], v[156:159], v[252:255]
  v_cvt_pk_bf16_f32 v75, v222, v223
  v_cvt_pk_bf16_f32 v66, v216, v217
  v_mfma_f32_16x16x32_bf16 v[252:255], a[152:155], v[172:175], v[252:255]
  s_add_u32 s48, s48, 16384
  v_exp_f32 v218, v218
  v_mfma_f32_16x16x32_bf16 v[252:255], a[156:159], v[188:191], v[252:255]
  v_exp_f32 v219, v219
  v_mfma_f32_16x16x32_bf16 v[248:251], a[156:159], v[184:187], v[40:43]
  v_exp_f32 v212, v212
  v_mfma_f32_16x16x32_bf16 v[248:251], a[152:155], v[168:171], v[248:251]
  v_exp_f32 v213, v213
  v_mfma_f32_16x16x32_bf16 v[248:251], a[148:151], v[152:155], v[248:251]
  v_cvt_pk_bf16_f32 v67, v218, v219
  v_cvt_pk_bf16_f32 v58, v212, v213
  v_mfma_f32_16x16x32_bf16 v[248:251], a[144:147], v[136:139], v[248:251]
  v_exp_f32 v214, v214
  v_mfma_f32_16x16x32_bf16 v[244:247], a[144:147], v[132:135], v[36:39]
  v_exp_f32 v215, v215
  v_mfma_f32_16x16x32_bf16 v[244:247], a[148:151], v[148:151], v[244:247]
  v_exp_f32 v208, v208
  v_mfma_f32_16x16x32_bf16 v[244:247], a[152:155], v[164:167], v[244:247]
  v_exp_f32 v209, v209
  v_mfma_f32_16x16x32_bf16 v[244:247], a[156:159], v[180:183], v[244:247]
  v_cvt_pk_bf16_f32 v59, v214, v215
  v_cvt_pk_bf16_f32 v50, v208, v209
  v_mfma_f32_16x16x32_bf16 v[240:243], a[156:159], v[176:179], v[32:35]
  v_exp_f32 v210, v210
  v_mfma_f32_16x16x32_bf16 v[240:243], a[152:155], v[160:163], v[240:243]
  v_exp_f32 v211, v211
  v_mfma_f32_16x16x32_bf16 v[240:243], a[148:151], v[144:147], v[240:243]
  v_exp_f32 v224, v224
  v_mfma_f32_16x16x32_bf16 v[240:243], a[144:147], v[128:131], v[240:243]
  v_exp_f32 v225, v225
  v_exp_f32 v226, v226
  v_cvt_pk_bf16_f32 v51, v210, v211
  v_cvt_pk_bf16_f32 v52, v224, v225
  v_exp_f32 v227, v227
  s_waitcnt vmcnt(12)
  v_exp_f32 v228, v228
  v_cvt_pk_bf16_f32 v53, v226, v227
  v_exp_f32 v229, v229
  s_barrier
  v_exp_f32 v230, v230
  v_cvt_pk_bf16_f32 v60, v228, v229
  ds_read_b128 a[128:131], v2 offset:16896
  v_exp_f32 v231, v231
  ds_read_b128 a[132:135], v2 offset:16960
  v_exp_f32 v232, v232
  v_cvt_pk_bf16_f32 v61, v230, v231
  ds_read_b128 a[136:139], v2 offset:17024
  v_exp_f32 v233, v233
  ds_read_b128 a[140:143], v2 offset:17088
  v_exp_f32 v234, v234
  v_cvt_pk_bf16_f32 v68, v232, v233
  v_exp_f32 v235, v235
  v_exp_f32 v236, v236
  v_cvt_pk_bf16_f32 v69, v234, v235
  v_exp_f32 v237, v237
  v_exp_f32 v238, v238
  v_cvt_pk_bf16_f32 v76, v236, v237
  v_exp_f32 v239, v239
  v_exp_f32 v252, v252
  v_cvt_pk_bf16_f32 v77, v238, v239
  v_exp_f32 v253, v253
  v_exp_f32 v254, v254
  v_cvt_pk_bf16_f32 v78, v252, v253
  v_exp_f32 v255, v255
  s_nop 0
  v_cvt_pk_bf16_f32 v79, v254, v255
  s_waitcnt lgkmcnt(0)
  v_mfma_f32_16x16x32_bf16 v[192:195], a[128:131], v[128:131], v[32:35]
  v_exp_f32 v248, v248
  v_mfma_f32_16x16x32_bf16 v[192:195], a[132:135], v[144:147], v[192:195]
  ds_read_b128 a[144:147], v2 offset:17152
  v_accvgpr_write_b32 a208, -1
  v_mfma_f32_16x16x32_bf16 v[192:195], a[136:139], v[160:163], v[192:195]
  v_exp_f32 v249, v249
  v_mfma_f32_16x16x32_bf16 v[192:195], a[140:143], v[176:179], v[192:195]
  ds_read_b128 a[148:151], v2 offset:17216
  v_accvgpr_write_b32 a209, -1
  v_mfma_f32_16x16x32_bf16 v[196:199], a[140:143], v[180:183], v[36:39]
  v_exp_f32 v250, v250
  v_mfma_f32_16x16x32_bf16 v[196:199], a[136:139], v[164:167], v[196:199]
  ds_read_b128 a[152:155], v2 offset:17280
  v_accvgpr_write_b32 a210, -1
  v_mfma_f32_16x16x32_bf16 v[196:199], a[132:135], v[148:151], v[196:199]
  v_exp_f32 v251, v251
  v_mfma_f32_16x16x32_bf16 v[196:199], a[128:131], v[132:135], v[196:199]
  ds_read_b128 a[156:159], v2 offset:17344
  v_accvgpr_write_b32 a211, -1
  v_mfma_f32_16x16x32_bf16 v[200:203], a[128:131], v[136:139], v[40:43]
  s_add_u32 m0, s51, 16896
  v_mfma_f32_16x16x32_bf16 v[200:203], a[132:135], v[152:155], v[200:203]
  buffer_load_dwordx4 v4, s[12:15], s48 offen offset:0 lds
  v_mfma_f32_16x16x32_bf16 v[200:203], a[136:139], v[168:171], v[200:203]
  v_exp_f32 v244, v244
  v_mfma_f32_16x16x32_bf16 v[200:203], a[140:143], v[184:187], v[200:203]
  v_exp_f32 v245, v245
  v_mfma_f32_16x16x32_bf16 v[204:207], a[140:143], v[188:191], v[44:47]
  s_add_u32 m0, s51, 16928
  v_exp_f32 v246, v246
  v_mfma_f32_16x16x32_bf16 v[204:207], a[136:139], v[172:175], v[204:207]
  buffer_load_dwordx4 v4, s[12:15], s48 offen offset:1024 lds
  v_mfma_f32_16x16x32_bf16 v[204:207], a[132:135], v[156:159], v[204:207]
  s_add_u32 m0, s51, 16960
  v_exp_f32 v247, v247
  v_mfma_f32_16x16x32_bf16 v[204:207], a[128:131], v[140:143], v[204:207]
  s_waitcnt lgkmcnt(0)
  buffer_load_dwordx4 v4, s[12:15], s48 offen offset:2048 lds
  v_mfma_f32_16x16x32_bf16 v[220:223], a[144:147], v[140:143], v[44:47]
  v_exp_f32 v240, v240
  v_mfma_f32_16x16x32_bf16 v[220:223], a[148:151], v[156:159], v[220:223]
  ds_read_b128 a[128:131], v2 offset:17408
  v_add_u32 v10, 143360, v5
  v_mfma_f32_16x16x32_bf16 v[220:223], a[152:155], v[172:175], v[220:223]
  v_exp_f32 v241, v241
  v_mfma_f32_16x16x32_bf16 v[220:223], a[156:159], v[188:191], v[220:223]
  ds_read_b128 a[132:135], v2 offset:17472
  v_cvt_pk_bf16_f32 v70, v248, v249
  v_mfma_f32_16x16x32_bf16 v[216:219], a[156:159], v[184:187], v[40:43]
  v_exp_f32 v242, v242
  v_mfma_f32_16x16x32_bf16 v[216:219], a[152:155], v[168:171], v[216:219]
  ds_read_b128 a[136:139], v2 offset:17536
  v_cvt_pk_bf16_f32 v71, v250, v251
  v_mfma_f32_16x16x32_bf16 v[216:219], a[148:151], v[152:155], v[216:219]
  v_exp_f32 v243, v243
  v_mfma_f32_16x16x32_bf16 v[216:219], a[144:147], v[136:139], v[216:219]
  ds_read_b128 a[140:143], v2 offset:17600
  v_cvt_pk_bf16_f32 v62, v244, v245
  v_mfma_f32_16x16x32_bf16 v[212:215], a[144:147], v[132:135], v[36:39]
  s_add_u32 m0, s51, 16992
  v_exp_f32 v192, v192
  v_mfma_f32_16x16x32_bf16 v[212:215], a[148:151], v[148:151], v[212:215]
  buffer_load_dwordx4 v4, s[12:15], s48 offen offset:3072 lds
  v_mfma_f32_16x16x32_bf16 v[212:215], a[152:155], v[164:167], v[212:215]
  v_exp_f32 v193, v193
  v_mfma_f32_16x16x32_bf16 v[212:215], a[156:159], v[180:183], v[212:215]
  v_cvt_pk_bf16_f32 v63, v246, v247
  v_cvt_pk_bf16_f32 v54, v240, v241
  v_mfma_f32_16x16x32_bf16 v[208:211], a[156:159], v[176:179], v[32:35]
  s_add_u32 m0, s51, 67584
  v_exp_f32 v194, v194
  v_mfma_f32_16x16x32_bf16 v[208:211], a[152:155], v[160:163], v[208:211]
  buffer_load_dwordx4 v4, s[16:19], s49 offen offset:0 lds
  v_mfma_f32_16x16x32_bf16 v[208:211], a[148:151], v[144:147], v[208:211]
  s_add_u32 m0, s51, 67616
  v_exp_f32 v195, v195
  v_mfma_f32_16x16x32_bf16 v[208:211], a[144:147], v[128:131], v[208:211]
  s_waitcnt lgkmcnt(0)
  buffer_load_dwordx4 v4, s[16:19], s49 offen offset:1024 lds
  v_mfma_f32_16x16x32_bf16 v[224:227], a[128:131], v[128:131], v[32:35]
  v_exp_f32 v196, v196
  v_mfma_f32_16x16x32_bf16 v[224:227], a[132:135], v[144:147], v[224:227]
  ds_read_b128 a[144:147], v2 offset:17664
  v_cvt_pk_bf16_f32 v55, v242, v243
  v_mfma_f32_16x16x32_bf16 v[224:227], a[136:139], v[160:163], v[224:227]
  v_exp_f32 v197, v197
  v_mfma_f32_16x16x32_bf16 v[224:227], a[140:143], v[176:179], v[224:227]
  ds_read_b128 a[148:151], v2 offset:17728
  v_cvt_pk_bf16_f32 v80, v192, v193
  v_mfma_f32_16x16x32_bf16 v[228:231], a[140:143], v[180:183], v[36:39]
  v_exp_f32 v198, v198
  v_mfma_f32_16x16x32_bf16 v[228:231], a[136:139], v[164:167], v[228:231]
  ds_read_b128 a[152:155], v2 offset:17792
  v_cvt_pk_bf16_f32 v81, v194, v195
  v_mfma_f32_16x16x32_bf16 v[228:231], a[132:135], v[148:151], v[228:231]
  v_exp_f32 v199, v199
  v_mfma_f32_16x16x32_bf16 v[228:231], a[128:131], v[132:135], v[228:231]
  ds_read_b128 a[156:159], v2 offset:17856
  v_cvt_pk_bf16_f32 v88, v196, v197
  v_mfma_f32_16x16x32_bf16 v[232:235], a[128:131], v[136:139], v[40:43]
  s_add_u32 m0, s51, 67648
  v_exp_f32 v200, v200
  v_mfma_f32_16x16x32_bf16 v[232:235], a[132:135], v[152:155], v[232:235]
  buffer_load_dwordx4 v4, s[16:19], s49 offen offset:2048 lds
  v_mfma_f32_16x16x32_bf16 v[232:235], a[136:139], v[168:171], v[232:235]
  v_exp_f32 v201, v201
  v_mfma_f32_16x16x32_bf16 v[232:235], a[140:143], v[184:187], v[232:235]
  ds_write_b128 v10, a[208:211]
  v_cvt_pk_bf16_f32 v89, v198, v199
  v_mfma_f32_16x16x32_bf16 v[236:239], a[140:143], v[188:191], v[44:47]
  s_add_u32 m0, s51, 67680
  v_exp_f32 v202, v202
  v_mfma_f32_16x16x32_bf16 v[236:239], a[136:139], v[172:175], v[236:239]
  buffer_load_dwordx4 v4, s[16:19], s49 offen offset:3072 lds
  v_mfma_f32_16x16x32_bf16 v[236:239], a[132:135], v[156:159], v[236:239]
  v_exp_f32 v203, v203
  v_mfma_f32_16x16x32_bf16 v[236:239], a[128:131], v[140:143], v[236:239]
  s_waitcnt lgkmcnt(0)
  v_add_u32 v2, s57, v2
  v_cvt_pk_bf16_f32 v96, v200, v201
  v_mfma_f32_16x16x32_bf16 v[252:255], a[144:147], v[140:143], v[44:47]
  v_exp_f32 v204, v204
  v_mfma_f32_16x16x32_bf16 v[252:255], a[148:151], v[156:159], v[252:255]
  ds_read_b64_tr_b16 a[160:161], v3 offset:0
  v_cvt_pk_bf16_f32 v97, v202, v203
  v_mfma_f32_16x16x32_bf16 v[252:255], a[152:155], v[172:175], v[252:255]
  s_add_u32 s48, s48, 16384
  v_exp_f32 v205, v205
  v_mfma_f32_16x16x32_bf16 v[252:255], a[156:159], v[188:191], v[252:255]
  ds_read_b64_tr_b16 a[162:163], v3 offset:256
  buffer_store_dwordx4 a[208:211], v1, s[8:11], s88 offen offset:1024 sc1
  v_mfma_f32_16x16x32_bf16 v[248:251], a[156:159], v[184:187], v[40:43]
  s_add_u32 s49, s49, 16384
  v_exp_f32 v206, v206
  v_mfma_f32_16x16x32_bf16 v[248:251], a[152:155], v[168:171], v[248:251]
  ds_read_b64_tr_b16 a[164:165], v3 offset:512
  v_cvt_pk_bf16_f32 v104, v204, v205
  v_mfma_f32_16x16x32_bf16 v[248:251], a[148:151], v[152:155], v[248:251]
  s_add_u32 s50, s50, s57
  v_exp_f32 v207, v207
  v_mfma_f32_16x16x32_bf16 v[248:251], a[144:147], v[136:139], v[248:251]
  ds_read_b64_tr_b16 a[166:167], v3 offset:768
  v_cvt_pk_bf16_f32 v105, v206, v207
  v_mfma_f32_16x16x32_bf16 v[244:247], a[144:147], v[132:135], v[36:39]
  s_sub_u32 s51, s51, s57
  v_exp_f32 v220, v220
  v_mfma_f32_16x16x32_bf16 v[244:247], a[148:151], v[148:151], v[244:247]
  ds_read_b64_tr_b16 a[168:169], v3 offset:32
  v_mfma_f32_16x16x32_bf16 v[244:247], a[152:155], v[164:167], v[244:247]
  s_sub_u32 s57, 0, s57
  v_exp_f32 v221, v221
  v_mfma_f32_16x16x32_bf16 v[244:247], a[156:159], v[180:183], v[244:247]
  ds_read_b64_tr_b16 a[170:171], v3 offset:288
  v_cvt_pk_bf16_f32 v106, v220, v221
  v_mfma_f32_16x16x32_bf16 v[240:243], a[156:159], v[176:179], v[32:35]
  v_exp_f32 v222, v222
  v_mfma_f32_16x16x32_bf16 v[240:243], a[152:155], v[160:163], v[240:243]
  ds_read_b64_tr_b16 a[172:173], v3 offset:544
  v_mfma_f32_16x16x32_bf16 v[240:243], a[148:151], v[144:147], v[240:243]
  v_exp_f32 v223, v223
  v_mfma_f32_16x16x32_bf16 v[240:243], a[144:147], v[128:131], v[240:243]
  s_waitcnt lgkmcnt(3)
  ds_read_b64_tr_b16 a[174:175], v3 offset:800
  v_cvt_pk_bf16_f32 v107, v222, v223
  v_mfma_f32_16x16x32_bf16 a[12:15], a[160:163], v[72:75], 0
  s_cmp_lt_u32 s74, s75
  v_exp_f32 v216, v216
  v_mfma_f32_16x16x32_bf16 a[12:15], a[164:167], v[76:79], a[12:15]
  s_cselect_b32 s78, s69, 0x7ff00000
  ds_read_b64_tr_b16 a[176:177], v3 offset:64
  v_accvgpr_write_b32 a192, 0
  v_mfma_f32_16x16x32_bf16 a[8:11], a[160:163], v[64:67], 0
  s_add_u32 s69, s69, 40960
  v_exp_f32 v217, v217
  v_mfma_f32_16x16x32_bf16 a[8:11], a[164:167], v[68:71], a[8:11]
  s_add_u32 s74, s74, 1
  ds_read_b64_tr_b16 a[178:179], v3 offset:320
  v_cvt_pk_bf16_f32 v98, v216, v217
  v_mfma_f32_16x16x32_bf16 a[4:7], a[160:163], v[56:59], 0
  v_exp_f32 v218, v218
  v_mfma_f32_16x16x32_bf16 a[4:7], a[164:167], v[60:63], a[4:7]
  ds_read_b64_tr_b16 a[180:181], v3 offset:576
  v_accvgpr_write_b32 a193, 0
  v_mfma_f32_16x16x32_bf16 a[0:3], a[160:163], v[48:51], 0
  v_exp_f32 v219, v219
  v_mfma_f32_16x16x32_bf16 a[0:3], a[164:167], v[52:55], a[0:3]
  s_waitcnt lgkmcnt(3)
  ds_read_b64_tr_b16 a[182:183], v3 offset:832
  v_cvt_pk_bf16_f32 v99, v218, v219
  v_mfma_f32_16x16x32_bf16 a[16:19], a[168:171], v[48:51], 0
  v_exp_f32 v212, v212
  v_mfma_f32_16x16x32_bf16 a[16:19], a[172:175], v[52:55], a[16:19]
  ds_read_b64_tr_b16 a[184:185], v3 offset:96
  v_accvgpr_write_b32 a194, 0
  v_mfma_f32_16x16x32_bf16 a[20:23], a[168:171], v[56:59], 0
  v_exp_f32 v213, v213
  v_mfma_f32_16x16x32_bf16 a[20:23], a[172:175], v[60:63], a[20:23]
  ds_read_b64_tr_b16 a[186:187], v3 offset:352
  v_cvt_pk_bf16_f32 v90, v212, v213
  v_mfma_f32_16x16x32_bf16 a[24:27], a[168:171], v[64:67], 0
  v_exp_f32 v214, v214
  v_mfma_f32_16x16x32_bf16 a[24:27], a[172:175], v[68:71], a[24:27]
  ds_read_b64_tr_b16 a[188:189], v3 offset:608
  v_accvgpr_write_b32 a195, 0
  v_mfma_f32_16x16x32_bf16 a[28:31], a[168:171], v[72:75], 0
  v_exp_f32 v215, v215
  v_mfma_f32_16x16x32_bf16 a[28:31], a[172:175], v[76:79], a[28:31]
  s_waitcnt lgkmcnt(3)
  ds_read_b64_tr_b16 a[190:191], v3 offset:864
  v_cvt_pk_bf16_f32 v91, v214, v215
  v_mfma_f32_16x16x32_bf16 a[44:47], a[176:179], v[72:75], 0
  v_exp_f32 v208, v208
  v_mfma_f32_16x16x32_bf16 a[44:47], a[180:183], v[76:79], a[44:47]
  ds_read_b64_tr_b16 a[160:161], v3 offset:128
  v_accvgpr_write_b32 a196, 0
  v_mfma_f32_16x16x32_bf16 a[40:43], a[176:179], v[64:67], 0
  v_exp_f32 v209, v209
  v_mfma_f32_16x16x32_bf16 a[40:43], a[180:183], v[68:71], a[40:43]
  ds_read_b64_tr_b16 a[162:163], v3 offset:384
  v_cvt_pk_bf16_f32 v82, v208, v209
  v_mfma_f32_16x16x32_bf16 a[36:39], a[176:179], v[56:59], 0
  v_exp_f32 v210, v210
  v_mfma_f32_16x16x32_bf16 a[36:39], a[180:183], v[60:63], a[36:39]
  ds_read_b64_tr_b16 a[164:165], v3 offset:640
  v_accvgpr_write_b32 a197, 0
  v_mfma_f32_16x16x32_bf16 a[32:35], a[176:179], v[48:51], 0
  v_exp_f32 v211, v211
  v_mfma_f32_16x16x32_bf16 a[32:35], a[180:183], v[52:55], a[32:35]
  s_waitcnt lgkmcnt(3)
  ds_read_b64_tr_b16 a[166:167], v3 offset:896
  v_cvt_pk_bf16_f32 v83, v210, v211
  v_mfma_f32_16x16x32_bf16 a[48:51], a[184:187], v[48:51], 0
  v_exp_f32 v224, v224
  v_mfma_f32_16x16x32_bf16 a[48:51], a[188:191], v[52:55], a[48:51]
  ds_read_b64_tr_b16 a[168:169], v3 offset:160
  v_accvgpr_write_b32 a198, 0
  v_mfma_f32_16x16x32_bf16 a[52:55], a[184:187], v[56:59], 0
  v_exp_f32 v225, v225
  v_mfma_f32_16x16x32_bf16 a[52:55], a[188:191], v[60:63], a[52:55]
  ds_read_b64_tr_b16 a[170:171], v3 offset:416
  v_cvt_pk_bf16_f32 v84, v224, v225
  v_mfma_f32_16x16x32_bf16 a[56:59], a[184:187], v[64:67], 0
  v_exp_f32 v226, v226
  v_mfma_f32_16x16x32_bf16 a[56:59], a[188:191], v[68:71], a[56:59]
  ds_read_b64_tr_b16 a[172:173], v3 offset:672
  v_accvgpr_write_b32 a199, 0
  v_mfma_f32_16x16x32_bf16 a[60:63], a[184:187], v[72:75], 0
  v_exp_f32 v227, v227
  v_mfma_f32_16x16x32_bf16 a[60:63], a[188:191], v[76:79], a[60:63]
  s_waitcnt lgkmcnt(3)
  ds_read_b64_tr_b16 a[174:175], v3 offset:928
  v_cvt_pk_bf16_f32 v85, v226, v227
  v_mfma_f32_16x16x32_bf16 a[76:79], a[160:163], v[72:75], 0
  v_exp_f32 v228, v228
  v_mfma_f32_16x16x32_bf16 a[76:79], a[164:167], v[76:79], a[76:79]
  ds_read_b64_tr_b16 a[176:177], v3 offset:192
  v_mfma_f32_16x16x32_bf16 a[72:75], a[160:163], v[64:67], 0
  v_exp_f32 v229, v229
  v_mfma_f32_16x16x32_bf16 a[72:75], a[164:167], v[68:71], a[72:75]
  ds_read_b64_tr_b16 a[178:179], v3 offset:448
  v_cvt_pk_bf16_f32 v92, v228, v229
  v_mfma_f32_16x16x32_bf16 a[68:71], a[160:163], v[56:59], 0
  v_exp_f32 v230, v230
  v_mfma_f32_16x16x32_bf16 a[68:71], a[164:167], v[60:63], a[68:71]
  ds_read_b64_tr_b16 a[180:181], v3 offset:704
  v_mfma_f32_16x16x32_bf16 a[64:67], a[160:163], v[48:51], 0
  v_exp_f32 v231, v231
  v_mfma_f32_16x16x32_bf16 a[64:67], a[164:167], v[52:55], a[64:67]
  s_waitcnt lgkmcnt(3)
  ds_read_b64_tr_b16 a[182:183], v3 offset:960
  v_cvt_pk_bf16_f32 v93, v230, v231
  v_mfma_f32_16x16x32_bf16 a[80:83], a[168:171], v[48:51], 0
  v_exp_f32 v232, v232
  v_mfma_f32_16x16x32_bf16 a[80:83], a[172:175], v[52:55], a[80:83]
  ds_read_b64_tr_b16 a[184:185], v3 offset:224
  v_mfma_f32_16x16x32_bf16 a[84:87], a[168:171], v[56:59], 0
  v_exp_f32 v233, v233
  v_mfma_f32_16x16x32_bf16 a[84:87], a[172:175], v[60:63], a[84:87]
  ds_read_b64_tr_b16 a[186:187], v3 offset:480
  v_cvt_pk_bf16_f32 v100, v232, v233
  v_mfma_f32_16x16x32_bf16 a[88:91], a[168:171], v[64:67], 0
  v_exp_f32 v234, v234
  v_mfma_f32_16x16x32_bf16 a[88:91], a[172:175], v[68:71], a[88:91]
  ds_read_b64_tr_b16 a[188:189], v3 offset:736
  v_mfma_f32_16x16x32_bf16 a[92:95], a[168:171], v[72:75], 0
  s_waitcnt vmcnt(9)
  v_exp_f32 v235, v235
  v_mfma_f32_16x16x32_bf16 a[92:95], a[172:175], v[76:79], a[92:95]
  s_waitcnt lgkmcnt(3)
  ds_read_b64_tr_b16 a[190:191], v3 offset:992
  v_cvt_pk_bf16_f32 v101, v234, v235
  v_mfma_f32_16x16x32_bf16 a[108:111], a[176:179], v[72:75], 0
  s_barrier
  v_mfma_f32_16x16x32_bf16 a[108:111], a[180:183], v[76:79], a[108:111]
  ds_read_b128 a[128:131], v2 offset:0
  v_mfma_f32_16x16x32_bf16 a[104:107], a[176:179], v[64:67], 0
  v_exp_f32 v236, v236
  v_mfma_f32_16x16x32_bf16 a[104:107], a[180:183], v[68:71], a[104:107]
  ds_read_b128 a[132:135], v2 offset:64
  v_mfma_f32_16x16x32_bf16 a[100:103], a[176:179], v[56:59], 0
  v_exp_f32 v237, v237
  v_mfma_f32_16x16x32_bf16 a[100:103], a[180:183], v[60:63], a[100:103]
  ds_read_b128 a[136:139], v2 offset:128
  v_cvt_pk_bf16_f32 v108, v236, v237
  v_mfma_f32_16x16x32_bf16 a[96:99], a[176:179], v[48:51], 0
  v_exp_f32 v238, v238
  v_mfma_f32_16x16x32_bf16 a[96:99], a[180:183], v[52:55], a[96:99]
  s_waitcnt lgkmcnt(3)
  ds_read_b128 a[140:143], v2 offset:192
  v_mfma_f32_16x16x32_bf16 a[112:115], a[184:187], v[48:51], 0
  v_exp_f32 v239, v239
  v_mfma_f32_16x16x32_bf16 a[112:115], a[188:191], v[52:55], a[112:115]
  v_exp_f32 v252, v252
  v_mfma_f32_16x16x32_bf16 a[116:119], a[184:187], v[56:59], 0
  s_add_u32 m0, s68, s89
  v_exp_f32 v253, v253
  v_mfma_f32_16x16x32_bf16 a[116:119], a[188:191], v[60:63], a[116:119]
  buffer_load_dwordx4 v117, s[20:23], s78 offen lds
  v_mfma_f32_16x16x32_bf16 a[120:123], a[184:187], v[64:67], 0
  v_exp_f32 v254, v254
  v_mfma_f32_16x16x32_bf16 a[120:123], a[188:191], v[68:71], a[120:123]
  v_cvt_pk_bf16_f32 v109, v238, v239
  v_cvt_pk_bf16_f32 v110, v252, v253
  v_mfma_f32_16x16x32_bf16 a[124:127], a[184:187], v[72:75], 0
  v_exp_f32 v255, v255
  v_mfma_f32_16x16x32_bf16 a[124:127], a[188:191], v[76:79], a[124:127]
  v_cvt_pk_bf16_f32 v111, v254, v255
  v_smfmac_f32_16x16x64_bf16 a[196:199], v[20:23], v[72:79], v118
  v_smfmac_f32_16x16x64_bf16 a[196:199], v[28:31], v[64:71], v118
  s_waitcnt lgkmcnt(0)
  buffer_store_dwordx4 a[208:211], v1, s[8:11], s88 offen offset:0 sc1
  v_smfmac_f32_16x16x64_bf16 a[192:195], v[28:31], v[48:55], v118
  v_smfmac_f32_16x16x64_bf16 a[192:195], v[20:23], v[56:63], v118
.p2align 6
L_a_loop:
  v_mfma_f32_16x16x32_bf16 v[192:195], a[128:131], v[128:131], v[32:35]
  v_exp_f32 v248, v248
  v_mfma_f32_16x16x32_bf16 v[192:195], a[132:135], v[144:147], v[192:195]
  ds_read_b128 a[144:147], v2 offset:256
  v_mfma_f32_16x16x32_bf16 v[192:195], a[136:139], v[160:163], v[192:195]
  v_exp_f32 v249, v249
  v_mfma_f32_16x16x32_bf16 v[192:195], a[140:143], v[176:179], v[192:195]
  ds_read_b128 a[148:151], v2 offset:320
  v_cvt_pk_bf16_f32 v102, v248, v249
  v_mfma_f32_16x16x32_bf16 v[196:199], a[140:143], v[180:183], v[36:39]
  v_exp_f32 v250, v250
  v_mfma_f32_16x16x32_bf16 v[196:199], a[136:139], v[164:167], v[196:199]
  ds_read_b128 a[152:155], v2 offset:384
  v_mfma_f32_16x16x32_bf16 v[196:199], a[132:135], v[148:151], v[196:199]
  v_exp_f32 v251, v251
  v_mfma_f32_16x16x32_bf16 v[196:199], a[128:131], v[132:135], v[196:199]
  ds_read_b128 a[156:159], v2 offset:448
  v_cvt_pk_bf16_f32 v103, v250, v251
  v_mfma_f32_16x16x32_bf16 v[200:203], a[128:131], v[136:139], v[40:43]
  s_add_u32 m0, s51, 0
  v_mfma_f32_16x16x32_bf16 v[200:203], a[132:135], v[152:155], v[200:203]
  buffer_load_dwordx4 v4, s[12:15], s48 offen offset:0 lds
  v_mfma_f32_16x16x32_bf16 v[200:203], a[136:139], v[168:171], v[200:203]
  v_exp_f32 v244, v244
  v_mfma_f32_16x16x32_bf16 v[200:203], a[140:143], v[184:187], v[200:203]
  v_exp_f32 v245, v245
  v_mfma_f32_16x16x32_bf16 v[204:207], a[140:143], v[188:191], v[44:47]
  s_add_u32 m0, s51, 32
  v_exp_f32 v246, v246
  v_mfma_f32_16x16x32_bf16 v[204:207], a[136:139], v[172:175], v[204:207]
  buffer_load_dwordx4 v4, s[12:15], s48 offen offset:1024 lds
  v_mfma_f32_16x16x32_bf16 v[204:207], a[132:135], v[156:159], v[204:207]
  s_add_u32 m0, s51, 64
  v_exp_f32 v247, v247
  v_mfma_f32_16x16x32_bf16 v[204:207], a[128:131], v[140:143], v[204:207]
  s_waitcnt lgkmcnt(0)
  buffer_load_dwordx4 v4, s[12:15], s48 offen offset:2048 lds
  v_mfma_f32_16x16x32_bf16 v[220:223], a[144:147], v[140:143], v[44:47]
  v_exp_f32 v240, v240
  v_mfma_f32_16x16x32_bf16 v[220:223], a[148:151], v[156:159], v[220:223]
  ds_read_b128 a[128:131], v2 offset:512
  v_cvt_pk_bf16_f32 v94, v244, v245
  v_mfma_f32_16x16x32_bf16 v[220:223], a[152:155], v[172:175], v[220:223]
  v_exp_f32 v241, v241
  v_mfma_f32_16x16x32_bf16 v[220:223], a[156:159], v[188:191], v[220:223]
  ds_read_b128 a[132:135], v2 offset:576
  v_cvt_pk_bf16_f32 v95, v246, v247
  v_mfma_f32_16x16x32_bf16 v[216:219], a[156:159], v[184:187], v[40:43]
  v_exp_f32 v242, v242
  v_mfma_f32_16x16x32_bf16 v[216:219], a[152:155], v[168:171], v[216:219]
  ds_read_b128 a[136:139], v2 offset:640
  v_cvt_pk_bf16_f32 v86, v240, v241
  v_mfma_f32_16x16x32_bf16 v[216:219], a[148:151], v[152:155], v[216:219]
  v_exp_f32 v243, v243
  v_mfma_f32_16x16x32_bf16 v[216:219], a[144:147], v[136:139], v[216:219]
  ds_read_b128 a[140:143], v2 offset:704
  v_cvt_pk_bf16_f32 v87, v242, v243
  v_mfma_f32_16x16x32_bf16 v[212:215], a[144:147], v[132:135], v[36:39]
  s_add_u32 m0, s51, 96
  v_exp_f32 v192, v192
  v_mfma_f32_16x16x32_bf16 v[212:215], a[148:151], v[148:151], v[212:215]
  buffer_load_dwordx4 v4, s[12:15], s48 offen offset:3072 lds
  v_mfma_f32_16x16x32_bf16 v[212:215], a[152:155], v[164:167], v[212:215]
  v_exp_f32 v193, v193
  v_mfma_f32_16x16x32_bf16 v[212:215], a[156:159], v[180:183], v[212:215]
  v_cvt_pk_bf16_f32 v48, v192, v193
  v_mfma_f32_16x16x32_bf16 v[208:211], a[156:159], v[176:179], v[32:35]
  s_add_u32 m0, s50, 84480
  v_exp_f32 v194, v194
  v_mfma_f32_16x16x32_bf16 v[208:211], a[152:155], v[160:163], v[208:211]
  buffer_load_dwordx4 v4, s[16:19], s49 offen offset:0 lds
  v_mfma_f32_16x16x32_bf16 v[208:211], a[148:151], v[144:147], v[208:211]
  s_add_u32 m0, s50, 84512
  v_exp_f32 v195, v195
  v_mfma_f32_16x16x32_bf16 v[208:211], a[144:147], v[128:131], v[208:211]
  s_waitcnt lgkmcnt(0)
  buffer_load_dwordx4 v4, s[16:19], s49 offen offset:1024 lds
  v_mfma_f32_16x16x32_bf16 v[224:227], a[128:131], v[128:131], v[32:35]
  v_exp_f32 v196, v196
  v_mfma_f32_16x16x32_bf16 v[224:227], a[132:135], v[144:147], v[224:227]
  ds_read_b128 a[144:147], v2 offset:768
  v_cvt_pk_bf16_f32 v49, v194, v195
  v_mfma_f32_16x16x32_bf16 v[224:227], a[136:139], v[160:163], v[224:227]
  v_exp_f32 v197, v197
  v_mfma_f32_16x16x32_bf16 v[224:227], a[140:143], v[176:179], v[224:227]
  ds_read_b128 a[148:151], v2 offset:832
  v_cvt_pk_bf16_f32 v56, v196, v197
  v_mfma_f32_16x16x32_bf16 v[228:231], a[140:143], v[180:183], v[36:39]
  v_exp_f32 v198, v198
  v_mfma_f32_16x16x32_bf16 v[228:231], a[136:139], v[164:167], v[228:231]
  ds_read_b128 a[152:155], v2 offset:896
  v_mfma_f32_16x16x32_bf16 v[228:231], a[132:135], v[148:151], v[228:231]
  v_exp_f32 v199, v199
  v_mfma_f32_16x16x32_bf16 v[228:231], a[128:131], v[132:135], v[228:231]
  ds_read_b128 a[156:159], v2 offset:960
  v_cvt_pk_bf16_f32 v57, v198, v199
  v_mfma_f32_16x16x32_bf16 v[232:235], a[128:131], v[136:139], v[40:43]
  s_add_u32 m0, s50, 84544
  v_exp_f32 v200, v200
  v_mfma_f32_16x16x32_bf16 v[232:235], a[132:135], v[152:155], v[232:235]
  buffer_load_dwordx4 v4, s[16:19], s49 offen offset:2048 lds
  v_mfma_f32_16x16x32_bf16 v[232:235], a[136:139], v[168:171], v[232:235]
  v_exp_f32 v201, v201
  v_mfma_f32_16x16x32_bf16 v[232:235], a[140:143], v[184:187], v[232:235]
  v_cvt_pk_bf16_f32 v64, v200, v201
  v_mfma_f32_16x16x32_bf16 v[236:239], a[140:143], v[188:191], v[44:47]
  s_add_u32 m0, s50, 84576
  v_exp_f32 v202, v202
  v_mfma_f32_16x16x32_bf16 v[236:239], a[136:139], v[172:175], v[236:239]
  buffer_load_dwordx4 v4, s[16:19], s49 offen offset:3072 lds
  v_mfma_f32_16x16x32_bf16 v[236:239], a[132:135], v[156:159], v[236:239]
  v_exp_f32 v203, v203
  v_mfma_f32_16x16x32_bf16 v[236:239], a[128:131], v[140:143], v[236:239]
  s_waitcnt lgkmcnt(0)
  v_cvt_pk_bf16_f32 v65, v202, v203
  v_mfma_f32_16x16x32_bf16 v[252:255], a[144:147], v[140:143], v[44:47]
  v_exp_f32 v204, v204
  v_mfma_f32_16x16x32_bf16 v[252:255], a[148:151], v[156:159], v[252:255]
  ds_read_b64_tr_b16 a[160:161], v3 offset:16896
  v_mfma_f32_16x16x32_bf16 v[252:255], a[152:155], v[172:175], v[252:255]
  s_add_u32 s48, s48, 16384
  v_exp_f32 v205, v205
  v_mfma_f32_16x16x32_bf16 v[252:255], a[156:159], v[188:191], v[252:255]
  ds_read_b64_tr_b16 a[162:163], v3 offset:17152
  v_cvt_pk_bf16_f32 v72, v204, v205
  v_mfma_f32_16x16x32_bf16 v[248:251], a[156:159], v[184:187], v[40:43]
  s_add_u32 s49, s49, 16384
  v_exp_f32 v206, v206
  v_mfma_f32_16x16x32_bf16 v[248:251], a[152:155], v[168:171], v[248:251]
  ds_read_b64_tr_b16 a[164:165], v3 offset:17408
  v_mfma_f32_16x16x32_bf16 v[248:251], a[148:151], v[152:155], v[248:251]
  v_exp_f32 v207, v207
  v_mfma_f32_16x16x32_bf16 v[248:251], a[144:147], v[136:139], v[248:251]
  ds_read_b64_tr_b16 a[166:167], v3 offset:17664
  v_cvt_pk_bf16_f32 v73, v206, v207
  v_mfma_f32_16x16x32_bf16 v[244:247], a[144:147], v[132:135], v[36:39]
  v_exp_f32 v220, v220
  v_mfma_f32_16x16x32_bf16 v[244:247], a[148:151], v[148:151], v[244:247]
  ds_read_b64_tr_b16 a[168:169], v3 offset:16928
  v_mfma_f32_16x16x32_bf16 v[244:247], a[152:155], v[164:167], v[244:247]
  v_exp_f32 v221, v221
  v_mfma_f32_16x16x32_bf16 v[244:247], a[156:159], v[180:183], v[244:247]
  ds_read_b64_tr_b16 a[170:171], v3 offset:17184
  v_cvt_pk_bf16_f32 v74, v220, v221
  v_mfma_f32_16x16x32_bf16 v[240:243], a[156:159], v[176:179], v[32:35]
  v_exp_f32 v222, v222
  v_mfma_f32_16x16x32_bf16 v[240:243], a[152:155], v[160:163], v[240:243]
  ds_read_b64_tr_b16 a[172:173], v3 offset:17440
  v_mfma_f32_16x16x32_bf16 v[240:243], a[148:151], v[144:147], v[240:243]
  v_exp_f32 v223, v223
  v_mfma_f32_16x16x32_bf16 v[240:243], a[144:147], v[128:131], v[240:243]
  s_waitcnt lgkmcnt(3)
  ds_read_b64_tr_b16 a[174:175], v3 offset:17696
  v_cvt_pk_bf16_f32 v75, v222, v223
  v_mfma_f32_16x16x32_bf16 a[12:15], a[160:163], v[104:107], a[12:15]
  v_exp_f32 v216, v216
  v_mfma_f32_16x16x32_bf16 a[12:15], a[164:167], v[108:111], a[12:15]
  ds_read_b64_tr_b16 a[176:177], v3 offset:16960
  v_mfma_f32_16x16x32_bf16 a[8:11], a[160:163], v[96:99], a[8:11]
  v_exp_f32 v217, v217
  v_mfma_f32_16x16x32_bf16 a[8:11], a[164:167], v[100:103], a[8:11]
  ds_read_b64_tr_b16 a[178:179], v3 offset:17216
  v_cvt_pk_bf16_f32 v66, v216, v217
  v_mfma_f32_16x16x32_bf16 a[4:7], a[160:163], v[88:91], a[4:7]
  v_exp_f32 v218, v218
  v_mfma_f32_16x16x32_bf16 a[4:7], a[164:167], v[92:95], a[4:7]
  ds_read_b64_tr_b16 a[180:181], v3 offset:17472
  v_mfma_f32_16x16x32_bf16 a[0:3], a[160:163], v[80:83], a[0:3]
  v_exp_f32 v219, v219
  v_mfma_f32_16x16x32_bf16 a[0:3], a[164:167], v[84:87], a[0:3]
  s_waitcnt lgkmcnt(3)
  ds_read_b64_tr_b16 a[182:183], v3 offset:17728
  v_cvt_pk_bf16_f32 v67, v218, v219
  v_mfma_f32_16x16x32_bf16 a[16:19], a[168:171], v[80:83], a[16:19]
  v_exp_f32 v212, v212
  v_mfma_f32_16x16x32_bf16 a[16:19], a[172:175], v[84:87], a[16:19]
  ds_read_b64_tr_b16 a[184:185], v3 offset:16992
  v_mfma_f32_16x16x32_bf16 a[20:23], a[168:171], v[88:91], a[20:23]
  v_exp_f32 v213, v213
  v_mfma_f32_16x16x32_bf16 a[20:23], a[172:175], v[92:95], a[20:23]
  ds_read_b64_tr_b16 a[186:187], v3 offset:17248
  v_cvt_pk_bf16_f32 v58, v212, v213
  v_mfma_f32_16x16x32_bf16 a[24:27], a[168:171], v[96:99], a[24:27]
  v_exp_f32 v214, v214
  v_mfma_f32_16x16x32_bf16 a[24:27], a[172:175], v[100:103], a[24:27]
  ds_read_b64_tr_b16 a[188:189], v3 offset:17504
  v_mfma_f32_16x16x32_bf16 a[28:31], a[168:171], v[104:107], a[28:31]
  v_exp_f32 v215, v215
  v_mfma_f32_16x16x32_bf16 a[28:31], a[172:175], v[108:111], a[28:31]
  s_waitcnt lgkmcnt(3)
  ds_read_b64_tr_b16 a[190:191], v3 offset:17760
  v_cvt_pk_bf16_f32 v59, v214, v215
  v_mfma_f32_16x16x32_bf16 a[44:47], a[176:179], v[104:107], a[44:47]
  v_exp_f32 v208, v208
  v_mfma_f32_16x16x32_bf16 a[44:47], a[180:183], v[108:111], a[44:47]
  ds_read_b64_tr_b16 a[160:161], v3 offset:17024
  v_mfma_f32_16x16x32_bf16 a[40:43], a[176:179], v[96:99], a[40:43]
  v_exp_f32 v209, v209
  v_mfma_f32_16x16x32_bf16 a[40:43], a[180:183], v[100:103], a[40:43]
  ds_read_b64_tr_b16 a[162:163], v3 offset:17280
  v_cvt_pk_bf16_f32 v50, v208, v209
  v_mfma_f32_16x16x32_bf16 a[36:39], a[176:179], v[88:91], a[36:39]
  v_exp_f32 v210, v210
  v_mfma_f32_16x16x32_bf16 a[36:39], a[180:183], v[92:95], a[36:39]
  ds_read_b64_tr_b16 a[164:165], v3 offset:17536
  v_mfma_f32_16x16x32_bf16 a[32:35], a[176:179], v[80:83], a[32:35]
  v_exp_f32 v211, v211
  v_mfma_f32_16x16x32_bf16 a[32:35], a[180:183], v[84:87], a[32:35]
  s_waitcnt lgkmcnt(3)
  ds_read_b64_tr_b16 a[166:167], v3 offset:17792
  v_cvt_pk_bf16_f32 v51, v210, v211
  v_mfma_f32_16x16x32_bf16 a[48:51], a[184:187], v[80:83], a[48:51]
  v_exp_f32 v224, v224
  v_mfma_f32_16x16x32_bf16 a[48:51], a[188:191], v[84:87], a[48:51]
  ds_read_b64_tr_b16 a[168:169], v3 offset:17056
  v_mfma_f32_16x16x32_bf16 a[52:55], a[184:187], v[88:91], a[52:55]
  v_exp_f32 v225, v225
  v_mfma_f32_16x16x32_bf16 a[52:55], a[188:191], v[92:95], a[52:55]
  ds_read_b64_tr_b16 a[170:171], v3 offset:17312
  v_cvt_pk_bf16_f32 v52, v224, v225
  v_mfma_f32_16x16x32_bf16 a[56:59], a[184:187], v[96:99], a[56:59]
  v_exp_f32 v226, v226
  v_mfma_f32_16x16x32_bf16 a[56:59], a[188:191], v[100:103], a[56:59]
  ds_read_b64_tr_b16 a[172:173], v3 offset:17568
  v_mfma_f32_16x16x32_bf16 a[60:63], a[184:187], v[104:107], a[60:63]
  v_exp_f32 v227, v227
  v_mfma_f32_16x16x32_bf16 a[60:63], a[188:191], v[108:111], a[60:63]
  s_waitcnt lgkmcnt(3)
  ds_read_b64_tr_b16 a[174:175], v3 offset:17824
  v_cvt_pk_bf16_f32 v53, v226, v227
  v_mfma_f32_16x16x32_bf16 a[76:79], a[160:163], v[104:107], a[76:79]
  v_exp_f32 v228, v228
  v_mfma_f32_16x16x32_bf16 a[76:79], a[164:167], v[108:111], a[76:79]
  ds_read_b64_tr_b16 a[176:177], v3 offset:17088
  v_mfma_f32_16x16x32_bf16 a[72:75], a[160:163], v[96:99], a[72:75]
  v_exp_f32 v229, v229
  v_mfma_f32_16x16x32_bf16 a[72:75], a[164:167], v[100:103], a[72:75]
  ds_read_b64_tr_b16 a[178:179], v3 offset:17344
  v_cvt_pk_bf16_f32 v60, v228, v229
  v_mfma_f32_16x16x32_bf16 a[68:71], a[160:163], v[88:91], a[68:71]
  v_exp_f32 v230, v230
  v_mfma_f32_16x16x32_bf16 a[68:71], a[164:167], v[92:95], a[68:71]
  ds_read_b64_tr_b16 a[180:181], v3 offset:17600
  v_mfma_f32_16x16x32_bf16 a[64:67], a[160:163], v[80:83], a[64:67]
  v_exp_f32 v231, v231
  v_mfma_f32_16x16x32_bf16 a[64:67], a[164:167], v[84:87], a[64:67]
  s_waitcnt lgkmcnt(3)
  ds_read_b64_tr_b16 a[182:183], v3 offset:17856
  v_cvt_pk_bf16_f32 v61, v230, v231
  v_mfma_f32_16x16x32_bf16 a[80:83], a[168:171], v[80:83], a[80:83]
  v_exp_f32 v232, v232
  v_mfma_f32_16x16x32_bf16 a[80:83], a[172:175], v[84:87], a[80:83]
  ds_read_b64_tr_b16 a[184:185], v3 offset:17120
  v_mfma_f32_16x16x32_bf16 a[84:87], a[168:171], v[88:91], a[84:87]
  v_exp_f32 v233, v233
  v_mfma_f32_16x16x32_bf16 a[84:87], a[172:175], v[92:95], a[84:87]
  ds_read_b64_tr_b16 a[186:187], v3 offset:17376
  v_cvt_pk_bf16_f32 v68, v232, v233
  v_mfma_f32_16x16x32_bf16 a[88:91], a[168:171], v[96:99], a[88:91]
  v_exp_f32 v234, v234
  v_mfma_f32_16x16x32_bf16 a[88:91], a[172:175], v[100:103], a[88:91]
  ds_read_b64_tr_b16 a[188:189], v3 offset:17632
  v_mfma_f32_16x16x32_bf16 a[92:95], a[168:171], v[104:107], a[92:95]
  s_waitcnt vmcnt(10)
  v_exp_f32 v235, v235
  v_mfma_f32_16x16x32_bf16 a[92:95], a[172:175], v[108:111], a[92:95]
  s_waitcnt lgkmcnt(3)
  ds_read_b64_tr_b16 a[190:191], v3 offset:17888
  v_cvt_pk_bf16_f32 v69, v234, v235
  v_mfma_f32_16x16x32_bf16 a[108:111], a[176:179], v[104:107], a[108:111]
  s_barrier
  v_mfma_f32_16x16x32_bf16 a[108:111], a[180:183], v[108:111], a[108:111]
  ds_read_b128 a[128:131], v2 offset:16896
  v_mfma_f32_16x16x32_bf16 a[104:107], a[176:179], v[96:99], a[104:107]
  v_exp_f32 v236, v236
  v_mfma_f32_16x16x32_bf16 a[104:107], a[180:183], v[100:103], a[104:107]
  ds_read_b128 a[132:135], v2 offset:16960
  v_mfma_f32_16x16x32_bf16 a[100:103], a[176:179], v[88:91], a[100:103]
  v_exp_f32 v237, v237
  v_mfma_f32_16x16x32_bf16 a[100:103], a[180:183], v[92:95], a[100:103]
  ds_read_b128 a[136:139], v2 offset:17024
  v_cvt_pk_bf16_f32 v76, v236, v237
  v_mfma_f32_16x16x32_bf16 a[96:99], a[176:179], v[80:83], a[96:99]
  v_exp_f32 v238, v238
  v_mfma_f32_16x16x32_bf16 a[96:99], a[180:183], v[84:87], a[96:99]
  s_waitcnt lgkmcnt(3)
  ds_read_b128 a[140:143], v2 offset:17088
  v_mfma_f32_16x16x32_bf16 a[112:115], a[184:187], v[80:83], a[112:115]
  v_exp_f32 v239, v239
  v_mfma_f32_16x16x32_bf16 a[112:115], a[188:191], v[84:87], a[112:115]
  v_exp_f32 v252, v252
  v_mfma_f32_16x16x32_bf16 a[116:119], a[184:187], v[88:91], a[116:119]
  v_exp_f32 v253, v253
  v_mfma_f32_16x16x32_bf16 a[116:119], a[188:191], v[92:95], a[116:119]
  v_cvt_pk_bf16_f32 v77, v238, v239
  v_cvt_pk_bf16_f32 v78, v252, v253
  v_mfma_f32_16x16x32_bf16 a[120:123], a[184:187], v[96:99], a[120:123]
  v_exp_f32 v254, v254
  v_mfma_f32_16x16x32_bf16 a[120:123], a[188:191], v[100:103], a[120:123]
  v_sub_u32 v3, v3, s57
  v_mfma_f32_16x16x32_bf16 a[124:127], a[184:187], v[104:107], a[124:127]
  v_exp_f32 v255, v255
  v_mfma_f32_16x16x32_bf16 a[124:127], a[188:191], v[108:111], a[124:127]
  v_cvt_pk_bf16_f32 v79, v254, v255
  v_smfmac_f32_16x16x64_bf16 a[196:199], v[20:23], v[104:111], v118
  v_smfmac_f32_16x16x64_bf16 a[196:199], v[28:31], v[96:103], v118
  v_smfmac_f32_16x16x64_bf16 a[192:195], v[28:31], v[80:87], v118
  s_cmp_eq_u32 s52, 1
  v_smfmac_f32_16x16x64_bf16 a[192:195], v[20:23], v[88:95], v118
  s_waitcnt lgkmcnt(0)
  s_cbranch_scc1 L_a_post
  v_mfma_f32_16x16x32_bf16 v[192:195], a[128:131], v[128:131], v[32:35]
  v_exp_f32 v248, v248
  v_mfma_f32_16x16x32_bf16 v[192:195], a[132:135], v[144:147], v[192:195]
  ds_read_b128 a[144:147], v2 offset:17152
  v_mfma_f32_16x16x32_bf16 v[192:195], a[136:139], v[160:163], v[192:195]
  v_exp_f32 v249, v249
  v_mfma_f32_16x16x32_bf16 v[192:195], a[140:143], v[176:179], v[192:195]
  ds_read_b128 a[148:151], v2 offset:17216
  v_cvt_pk_bf16_f32 v70, v248, v249
  v_mfma_f32_16x16x32_bf16 v[196:199], a[140:143], v[180:183], v[36:39]
  v_exp_f32 v250, v250
  v_mfma_f32_16x16x32_bf16 v[196:199], a[136:139], v[164:167], v[196:199]
  ds_read_b128 a[152:155], v2 offset:17280
  v_mfma_f32_16x16x32_bf16 v[196:199], a[132:135], v[148:151], v[196:199]
  v_exp_f32 v251, v251
  v_mfma_f32_16x16x32_bf16 v[196:199], a[128:131], v[132:135], v[196:199]
  ds_read_b128 a[156:159], v2 offset:17344
  v_cvt_pk_bf16_f32 v71, v250, v251
  v_mfma_f32_16x16x32_bf16 v[200:203], a[128:131], v[136:139], v[40:43]
  s_add_u32 m0, s51, 16896
  v_mfma_f32_16x16x32_bf16 v[200:203], a[132:135], v[152:155], v[200:203]
  buffer_load_dwordx4 v4, s[12:15], s48 offen offset:0 lds
  v_mfma_f32_16x16x32_bf16 v[200:203], a[136:139], v[168:171], v[200:203]
  v_exp_f32 v244, v244
  v_mfma_f32_16x16x32_bf16 v[200:203], a[140:143], v[184:187], v[200:203]
  v_exp_f32 v245, v245
  v_mfma_f32_16x16x32_bf16 v[204:207], a[140:143], v[188:191], v[44:47]
  s_add_u32 m0, s51, 16928
  v_exp_f32 v246, v246
  v_mfma_f32_16x16x32_bf16 v[204:207], a[136:139], v[172:175], v[204:207]
  buffer_load_dwordx4 v4, s[12:15], s48 offen offset:1024 lds
  v_mfma_f32_16x16x32_bf16 v[204:207], a[132:135], v[156:159], v[204:207]
  s_add_u32 m0, s51, 16960
  v_exp_f32 v247, v247
  v_mfma_f32_16x16x32_bf16 v[204:207], a[128:131], v[140:143], v[204:207]
  s_waitcnt lgkmcnt(0)
  buffer_load_dwordx4 v4, s[12:15], s48 offen offset:2048 lds
  v_mfma_f32_16x16x32_bf16 v[220:223], a[144:147], v[140:143], v[44:47]
  v_exp_f32 v240, v240
  v_mfma_f32_16x16x32_bf16 v[220:223], a[148:151], v[156:159], v[220:223]
  ds_read_b128 a[128:131], v2 offset:17408
  v_cvt_pk_bf16_f32 v62, v244, v245
  v_mfma_f32_16x16x32_bf16 v[220:223], a[152:155], v[172:175], v[220:223]
  v_exp_f32 v241, v241
  v_mfma_f32_16x16x32_bf16 v[220:223], a[156:159], v[188:191], v[220:223]
  ds_read_b128 a[132:135], v2 offset:17472
  v_cvt_pk_bf16_f32 v63, v246, v247
  v_mfma_f32_16x16x32_bf16 v[216:219], a[156:159], v[184:187], v[40:43]
  v_exp_f32 v242, v242
  v_mfma_f32_16x16x32_bf16 v[216:219], a[152:155], v[168:171], v[216:219]
  ds_read_b128 a[136:139], v2 offset:17536
  v_cvt_pk_bf16_f32 v54, v240, v241
  v_mfma_f32_16x16x32_bf16 v[216:219], a[148:151], v[152:155], v[216:219]
  v_exp_f32 v243, v243
  v_mfma_f32_16x16x32_bf16 v[216:219], a[144:147], v[136:139], v[216:219]
  ds_read_b128 a[140:143], v2 offset:17600
  v_cvt_pk_bf16_f32 v55, v242, v243
  v_mfma_f32_16x16x32_bf16 v[212:215], a[144:147], v[132:135], v[36:39]
  s_add_u32 m0, s51, 16992
  v_exp_f32 v192, v192
  v_mfma_f32_16x16x32_bf16 v[212:215], a[148:151], v[148:151], v[212:215]
  buffer_load_dwordx4 v4, s[12:15], s48 offen offset:3072 lds
  v_mfma_f32_16x16x32_bf16 v[212:215], a[152:155], v[164:167], v[212:215]
  v_exp_f32 v193, v193
  v_mfma_f32_16x16x32_bf16 v[212:215], a[156:159], v[180:183], v[212:215]
  v_cvt_pk_bf16_f32 v80, v192, v193
  v_mfma_f32_16x16x32_bf16 v[208:211], a[156:159], v[176:179], v[32:35]
  s_add_u32 m0, s51, 67584
  v_exp_f32 v194, v194
  v_mfma_f32_16x16x32_bf16 v[208:211], a[152:155], v[160:163], v[208:211]
  buffer_load_dwordx4 v4, s[16:19], s49 offen offset:0 lds
  v_mfma_f32_16x16x32_bf16 v[208:211], a[148:151], v[144:147], v[208:211]
  s_add_u32 m0, s51, 67616
  v_exp_f32 v195, v195
  v_mfma_f32_16x16x32_bf16 v[208:211], a[144:147], v[128:131], v[208:211]
  s_waitcnt lgkmcnt(0)
  buffer_load_dwordx4 v4, s[16:19], s49 offen offset:1024 lds
  v_mfma_f32_16x16x32_bf16 v[224:227], a[128:131], v[128:131], v[32:35]
  v_exp_f32 v196, v196
  v_mfma_f32_16x16x32_bf16 v[224:227], a[132:135], v[144:147], v[224:227]
  ds_read_b128 a[144:147], v2 offset:17664
  v_cvt_pk_bf16_f32 v81, v194, v195
  v_mfma_f32_16x16x32_bf16 v[224:227], a[136:139], v[160:163], v[224:227]
  v_exp_f32 v197, v197
  v_mfma_f32_16x16x32_bf16 v[224:227], a[140:143], v[176:179], v[224:227]
  ds_read_b128 a[148:151], v2 offset:17728
  v_cvt_pk_bf16_f32 v88, v196, v197
  v_mfma_f32_16x16x32_bf16 v[228:231], a[140:143], v[180:183], v[36:39]
  v_exp_f32 v198, v198
  v_mfma_f32_16x16x32_bf16 v[228:231], a[136:139], v[164:167], v[228:231]
  ds_read_b128 a[152:155], v2 offset:17792
  v_mfma_f32_16x16x32_bf16 v[228:231], a[132:135], v[148:151], v[228:231]
  v_exp_f32 v199, v199
  v_mfma_f32_16x16x32_bf16 v[228:231], a[128:131], v[132:135], v[228:231]
  ds_read_b128 a[156:159], v2 offset:17856
  v_cvt_pk_bf16_f32 v89, v198, v199
  v_mfma_f32_16x16x32_bf16 v[232:235], a[128:131], v[136:139], v[40:43]
  s_add_u32 m0, s51, 67648
  v_exp_f32 v200, v200
  v_mfma_f32_16x16x32_bf16 v[232:235], a[132:135], v[152:155], v[232:235]
  buffer_load_dwordx4 v4, s[16:19], s49 offen offset:2048 lds
  v_mfma_f32_16x16x32_bf16 v[232:235], a[136:139], v[168:171], v[232:235]
  v_exp_f32 v201, v201
  v_mfma_f32_16x16x32_bf16 v[232:235], a[140:143], v[184:187], v[232:235]
  v_cvt_pk_bf16_f32 v96, v200, v201
  v_mfma_f32_16x16x32_bf16 v[236:239], a[140:143], v[188:191], v[44:47]
  s_add_u32 m0, s51, 67680
  v_exp_f32 v202, v202
  v_mfma_f32_16x16x32_bf16 v[236:239], a[136:139], v[172:175], v[236:239]
  buffer_load_dwordx4 v4, s[16:19], s49 offen offset:3072 lds
  v_mfma_f32_16x16x32_bf16 v[236:239], a[132:135], v[156:159], v[236:239]
  v_exp_f32 v203, v203
  v_mfma_f32_16x16x32_bf16 v[236:239], a[128:131], v[140:143], v[236:239]
  s_waitcnt lgkmcnt(0)
  v_add_u32 v2, s57, v2
  v_cvt_pk_bf16_f32 v97, v202, v203
  v_mfma_f32_16x16x32_bf16 v[252:255], a[144:147], v[140:143], v[44:47]
  v_exp_f32 v204, v204
  v_mfma_f32_16x16x32_bf16 v[252:255], a[148:151], v[156:159], v[252:255]
  ds_read_b64_tr_b16 a[160:161], v3 offset:0
  v_mfma_f32_16x16x32_bf16 v[252:255], a[152:155], v[172:175], v[252:255]
  s_add_u32 s48, s48, 16384
  v_exp_f32 v205, v205
  v_mfma_f32_16x16x32_bf16 v[252:255], a[156:159], v[188:191], v[252:255]
  ds_read_b64_tr_b16 a[162:163], v3 offset:256
  v_cvt_pk_bf16_f32 v104, v204, v205
  v_mfma_f32_16x16x32_bf16 v[248:251], a[156:159], v[184:187], v[40:43]
  s_add_u32 s49, s49, 16384
  v_exp_f32 v206, v206
  v_mfma_f32_16x16x32_bf16 v[248:251], a[152:155], v[168:171], v[248:251]
  ds_read_b64_tr_b16 a[164:165], v3 offset:512
  v_mfma_f32_16x16x32_bf16 v[248:251], a[148:151], v[152:155], v[248:251]
  s_add_u32 s50, s50, s57
  v_exp_f32 v207, v207
  v_mfma_f32_16x16x32_bf16 v[248:251], a[144:147], v[136:139], v[248:251]
  ds_read_b64_tr_b16 a[166:167], v3 offset:768
  v_cvt_pk_bf16_f32 v105, v206, v207
  v_mfma_f32_16x16x32_bf16 v[244:247], a[144:147], v[132:135], v[36:39]
  s_sub_u32 s51, s51, s57
  v_exp_f32 v220, v220
  v_mfma_f32_16x16x32_bf16 v[244:247], a[148:151], v[148:151], v[244:247]
  ds_read_b64_tr_b16 a[168:169], v3 offset:32
  v_mfma_f32_16x16x32_bf16 v[244:247], a[152:155], v[164:167], v[244:247]
  s_sub_u32 s57, 0, s57
  v_exp_f32 v221, v221
  v_mfma_f32_16x16x32_bf16 v[244:247], a[156:159], v[180:183], v[244:247]
  ds_read_b64_tr_b16 a[170:171], v3 offset:288
  v_cvt_pk_bf16_f32 v106, v220, v221
  v_mfma_f32_16x16x32_bf16 v[240:243], a[156:159], v[176:179], v[32:35]
  s_sub_u32 s52, s52, 1
  v_exp_f32 v222, v222
  v_mfma_f32_16x16x32_bf16 v[240:243], a[152:155], v[160:163], v[240:243]
  ds_read_b64_tr_b16 a[172:173], v3 offset:544
  v_mfma_f32_16x16x32_bf16 v[240:243], a[148:151], v[144:147], v[240:243]
  v_exp_f32 v223, v223
  v_mfma_f32_16x16x32_bf16 v[240:243], a[144:147], v[128:131], v[240:243]
  s_waitcnt lgkmcnt(3)
  ds_read_b64_tr_b16 a[174:175], v3 offset:800
  v_cvt_pk_bf16_f32 v107, v222, v223
  v_mfma_f32_16x16x32_bf16 a[12:15], a[160:163], v[72:75], a[12:15]
  s_cmp_lt_u32 s74, s75
  v_exp_f32 v216, v216
  v_mfma_f32_16x16x32_bf16 a[12:15], a[164:167], v[76:79], a[12:15]
  s_cselect_b32 s78, s69, 0x7ff00000
  ds_read_b64_tr_b16 a[176:177], v3 offset:64
  v_mfma_f32_16x16x32_bf16 a[8:11], a[160:163], v[64:67], a[8:11]
  s_add_u32 s69, s69, 40960
  v_exp_f32 v217, v217
  v_mfma_f32_16x16x32_bf16 a[8:11], a[164:167], v[68:71], a[8:11]
  s_cmp_le_u32 s74, s75
  ds_read_b64_tr_b16 a[178:179], v3 offset:320
  v_cvt_pk_bf16_f32 v98, v216, v217
  v_mfma_f32_16x16x32_bf16 a[4:7], a[160:163], v[56:59], a[4:7]
  s_cselect_b32 s79, s72, 0x7ff00000
  v_exp_f32 v218, v218
  v_mfma_f32_16x16x32_bf16 a[4:7], a[164:167], v[60:63], a[4:7]
  s_add_u32 s72, s72, s73
  ds_read_b64_tr_b16 a[180:181], v3 offset:576
  v_mfma_f32_16x16x32_bf16 a[0:3], a[160:163], v[48:51], a[0:3]
  v_exp_f32 v219, v219
  v_mfma_f32_16x16x32_bf16 a[0:3], a[164:167], v[52:55], a[0:3]
  s_waitcnt lgkmcnt(3)
  ds_read_b64_tr_b16 a[182:183], v3 offset:832
  v_cvt_pk_bf16_f32 v99, v218, v219
  v_mfma_f32_16x16x32_bf16 a[16:19], a[168:171], v[48:51], a[16:19]
  s_cmp_gt_u32 s74, 8
  v_exp_f32 v212, v212
  v_mfma_f32_16x16x32_bf16 a[16:19], a[172:175], v[52:55], a[16:19]
  s_cselect_b32 s79, s76, s79
  ds_read_b64_tr_b16 a[184:185], v3 offset:96
  v_mfma_f32_16x16x32_bf16 a[20:23], a[168:171], v[56:59], a[20:23]
  s_cselect_b32 s34, 143360, s89
  v_exp_f32 v213, v213
  v_mfma_f32_16x16x32_bf16 a[20:23], a[172:175], v[60:63], a[20:23]
  s_add_u32 s76, s76, 1024
  ds_read_b64_tr_b16 a[186:187], v3 offset:352
  v_cvt_pk_bf16_f32 v90, v212, v213
  v_mfma_f32_16x16x32_bf16 a[24:27], a[168:171], v[64:67], a[24:27]
  s_xor_b32 s89, s89, 12288
  v_exp_f32 v214, v214
  v_mfma_f32_16x16x32_bf16 a[24:27], a[172:175], v[68:71], a[24:27]
  s_add_u32 s74, s74, 1
  ds_read_b64_tr_b16 a[188:189], v3 offset:608
  v_mfma_f32_16x16x32_bf16 a[28:31], a[168:171], v[72:75], a[28:31]
  v_exp_f32 v215, v215
  v_mfma_f32_16x16x32_bf16 a[28:31], a[172:175], v[76:79], a[28:31]
  s_waitcnt lgkmcnt(3)
  ds_read_b64_tr_b16 a[190:191], v3 offset:864
  v_cvt_pk_bf16_f32 v91, v214, v215
  v_mfma_f32_16x16x32_bf16 a[44:47], a[176:179], v[72:75], a[44:47]
  v_exp_f32 v208, v208
  v_mfma_f32_16x16x32_bf16 a[44:47], a[180:183], v[76:79], a[44:47]
  ds_read_b64_tr_b16 a[160:161], v3 offset:128
  v_mfma_f32_16x16x32_bf16 a[40:43], a[176:179], v[64:67], a[40:43]
  v_exp_f32 v209, v209
  v_mfma_f32_16x16x32_bf16 a[40:43], a[180:183], v[68:71], a[40:43]
  ds_read_b64_tr_b16 a[162:163], v3 offset:384
  v_cvt_pk_bf16_f32 v82, v208, v209
  v_mfma_f32_16x16x32_bf16 a[36:39], a[176:179], v[56:59], a[36:39]
  v_exp_f32 v210, v210
  v_mfma_f32_16x16x32_bf16 a[36:39], a[180:183], v[60:63], a[36:39]
  ds_read_b64_tr_b16 a[164:165], v3 offset:640
  v_mfma_f32_16x16x32_bf16 a[32:35], a[176:179], v[48:51], a[32:35]
  v_exp_f32 v211, v211
  v_mfma_f32_16x16x32_bf16 a[32:35], a[180:183], v[52:55], a[32:35]
  s_waitcnt lgkmcnt(3)
  ds_read_b64_tr_b16 a[166:167], v3 offset:896
  v_cvt_pk_bf16_f32 v83, v210, v211
  v_mfma_f32_16x16x32_bf16 a[48:51], a[184:187], v[48:51], a[48:51]
  v_exp_f32 v224, v224
  v_mfma_f32_16x16x32_bf16 a[48:51], a[188:191], v[52:55], a[48:51]
  ds_read_b64_tr_b16 a[168:169], v3 offset:160
  v_mfma_f32_16x16x32_bf16 a[52:55], a[184:187], v[56:59], a[52:55]
  v_exp_f32 v225, v225
  v_mfma_f32_16x16x32_bf16 a[52:55], a[188:191], v[60:63], a[52:55]
  ds_read_b64_tr_b16 a[170:171], v3 offset:416
  v_cvt_pk_bf16_f32 v84, v224, v225
  v_mfma_f32_16x16x32_bf16 a[56:59], a[184:187], v[64:67], a[56:59]
  v_exp_f32 v226, v226
  v_mfma_f32_16x16x32_bf16 a[56:59], a[188:191], v[68:71], a[56:59]
  ds_read_b64_tr_b16 a[172:173], v3 offset:672
  v_mfma_f32_16x16x32_bf16 a[60:63], a[184:187], v[72:75], a[60:63]
  v_exp_f32 v227, v227
  v_mfma_f32_16x16x32_bf16 a[60:63], a[188:191], v[76:79], a[60:63]
  s_waitcnt lgkmcnt(3)
  ds_read_b64_tr_b16 a[174:175], v3 offset:928
  v_cvt_pk_bf16_f32 v85, v226, v227
  v_mfma_f32_16x16x32_bf16 a[76:79], a[160:163], v[72:75], a[76:79]
  v_exp_f32 v228, v228
  v_mfma_f32_16x16x32_bf16 a[76:79], a[164:167], v[76:79], a[76:79]
  ds_read_b64_tr_b16 a[176:177], v3 offset:192
  v_mfma_f32_16x16x32_bf16 a[72:75], a[160:163], v[64:67], a[72:75]
  v_exp_f32 v229, v229
  v_mfma_f32_16x16x32_bf16 a[72:75], a[164:167], v[68:71], a[72:75]
  ds_read_b64_tr_b16 a[178:179], v3 offset:448
  v_cvt_pk_bf16_f32 v92, v228, v229
  v_mfma_f32_16x16x32_bf16 a[68:71], a[160:163], v[56:59], a[68:71]
  v_exp_f32 v230, v230
  v_mfma_f32_16x16x32_bf16 a[68:71], a[164:167], v[60:63], a[68:71]
  ds_read_b64_tr_b16 a[180:181], v3 offset:704
  v_mfma_f32_16x16x32_bf16 a[64:67], a[160:163], v[48:51], a[64:67]
  v_exp_f32 v231, v231
  v_mfma_f32_16x16x32_bf16 a[64:67], a[164:167], v[52:55], a[64:67]
  s_waitcnt lgkmcnt(3)
  ds_read_b64_tr_b16 a[182:183], v3 offset:960
  v_cvt_pk_bf16_f32 v93, v230, v231
  v_mfma_f32_16x16x32_bf16 a[80:83], a[168:171], v[48:51], a[80:83]
  v_exp_f32 v232, v232
  v_mfma_f32_16x16x32_bf16 a[80:83], a[172:175], v[52:55], a[80:83]
  ds_read_b64_tr_b16 a[184:185], v3 offset:224
  v_mfma_f32_16x16x32_bf16 a[84:87], a[168:171], v[56:59], a[84:87]
  v_exp_f32 v233, v233
  v_mfma_f32_16x16x32_bf16 a[84:87], a[172:175], v[60:63], a[84:87]
  ds_read_b64_tr_b16 a[186:187], v3 offset:480
  v_cvt_pk_bf16_f32 v100, v232, v233
  v_mfma_f32_16x16x32_bf16 a[88:91], a[168:171], v[64:67], a[88:91]
  v_exp_f32 v234, v234
  v_mfma_f32_16x16x32_bf16 a[88:91], a[172:175], v[68:71], a[88:91]
  ds_read_b64_tr_b16 a[188:189], v3 offset:736
  v_mfma_f32_16x16x32_bf16 a[92:95], a[168:171], v[72:75], a[92:95]
  s_waitcnt vmcnt(8)
  v_exp_f32 v235, v235
  v_mfma_f32_16x16x32_bf16 a[92:95], a[172:175], v[76:79], a[92:95]
  s_waitcnt lgkmcnt(3)
  ds_read_b64_tr_b16 a[190:191], v3 offset:992
  v_add_u32 v10, s34, v122
  v_mfma_f32_16x16x32_bf16 a[108:111], a[176:179], v[72:75], a[108:111]
  s_barrier
  v_mfma_f32_16x16x32_bf16 a[108:111], a[180:183], v[76:79], a[108:111]
  ds_read_b128 a[128:131], v2 offset:0
  v_cvt_pk_bf16_f32 v101, v234, v235
  v_mfma_f32_16x16x32_bf16 a[104:107], a[176:179], v[64:67], a[104:107]
  v_exp_f32 v236, v236
  v_mfma_f32_16x16x32_bf16 a[104:107], a[180:183], v[68:71], a[104:107]
  ds_read_b128 a[132:135], v2 offset:64
  v_mfma_f32_16x16x32_bf16 a[100:103], a[176:179], v[56:59], a[100:103]
  v_exp_f32 v237, v237
  v_mfma_f32_16x16x32_bf16 a[100:103], a[180:183], v[60:63], a[100:103]
  ds_read_b128 a[136:139], v2 offset:128
  v_cvt_pk_bf16_f32 v108, v236, v237
  v_mfma_f32_16x16x32_bf16 a[96:99], a[176:179], v[48:51], a[96:99]
  v_exp_f32 v238, v238
  v_mfma_f32_16x16x32_bf16 a[96:99], a[180:183], v[52:55], a[96:99]
  s_waitcnt lgkmcnt(3)
  ds_read_b128 a[140:143], v2 offset:192
  v_mfma_f32_16x16x32_bf16 a[112:115], a[184:187], v[48:51], a[112:115]
  v_exp_f32 v239, v239
  v_mfma_f32_16x16x32_bf16 a[112:115], a[188:191], v[52:55], a[112:115]
  ds_read_b64_tr_b16 a[208:209], v10 offset:0
  ds_read_b64_tr_b16 a[210:211], v10 offset:2048
  v_mfma_f32_16x16x32_bf16 a[116:119], a[184:187], v[56:59], a[116:119]
  s_add_u32 m0, s68, s89
  v_exp_f32 v252, v252
  v_mfma_f32_16x16x32_bf16 a[116:119], a[188:191], v[60:63], a[116:119]
  buffer_load_dwordx4 v117, s[20:23], s78 offen lds
  v_mfma_f32_16x16x32_bf16 a[120:123], a[184:187], v[64:67], a[120:123]
  v_exp_f32 v253, v253
  v_mfma_f32_16x16x32_bf16 a[120:123], a[188:191], v[68:71], a[120:123]
  v_exp_f32 v254, v254
  v_mfma_f32_16x16x32_bf16 a[124:127], a[184:187], v[72:75], a[124:127]
  v_exp_f32 v255, v255
  v_mfma_f32_16x16x32_bf16 a[124:127], a[188:191], v[76:79], a[124:127]
  v_cvt_pk_bf16_f32 v109, v238, v239
  v_cvt_pk_bf16_f32 v110, v252, v253
  v_smfmac_f32_16x16x64_bf16 a[196:199], v[20:23], v[72:79], v118
  v_cvt_pk_bf16_f32 v111, v254, v255
  v_smfmac_f32_16x16x64_bf16 a[196:199], v[28:31], v[64:71], v118
  s_waitcnt lgkmcnt(0)
  buffer_store_dwordx4 a[208:211], v1, s[8:11], s79 offen offset:0 sc1
  v_smfmac_f32_16x16x64_bf16 a[192:195], v[28:31], v[48:55], v118
  s_bitcmp1_b32 s99, s52
  v_smfmac_f32_16x16x64_bf16 a[192:195], v[20:23], v[56:63], v118
  s_cbranch_scc0 L_a_loop
L_a_hooks:
  s_cmp_eq_u32 s52, 2
  s_cbranch_scc1 L_a_h2
  s_cmp_eq_u32 s52, 1
  s_cbranch_scc1 L_a_h1
L_a_h5:
  s_lshl_b32 s58, s2, 2
  s_add_u32 s58, s58, 0x318000
  buffer_store_dword v125, v123, s[8:11], s58 offen sc1
  s_branch L_a_loop
L_a_h2:
  s_mov_b32 s61, 0x318000
  buffer_load_dwordx4 v[12:15], v1, s[8:11], s61 offen sc1
  s_getpc_b64 s[4:5]
L_pc_a:
  s_add_u32 s4, s4, L_a_post-L_pc_a
  s_addc_u32 s5, s5, 0
  s_lshr_b32 s3, s2, 3
  s_lshl_b32 s3, s3, 11
  v_lshl_add_u32 v120, v0, 3, s3
  v_min_u32 v120, L_a_end-L_a_post, v120
  v_mov_b32 v121, s5
  v_add_co_u32 v120, vcc, s4, v120
  s_nop 1
  v_addc_co_u32 v121, vcc, 0, v121, vcc
  global_load_dword v119, v[120:121], off
  s_branch L_a_loop
L_a_h1:
  v_xor_b32 v13, v12, v13
  v_xor_b32 v14, v12, v14
  v_xor_b32 v15, v12, v15
  v_xor_b32 v12, v12, v125
  v_or3_b32 v13, v13, v14, v15
  v_or_b32 v12, v12, v13
  v_cmp_ne_u32 vcc, 0, v12
  s_nop 1
  s_cbranch_vccnz L_slow_w
L_back_w:
  s_mov_b32 s12, s8
  s_mov_b32 s13, s9
  s_mov_b32 s14, s10
  s_bfe_u32 s58, 0x3020100, s62
  s_mul_i32 s58, s58, 15360
  s_add_u32 s48, s58, s82
  s_branch L_a_loop
L_a_post:
  v_mfma_f32_16x16x32_bf16 v[192:195], a[128:131], v[128:131], v[32:35]
  s_bfe_u32 s65, 0x3020100, s62
  s_mul_i32 s65, s65, 12288
  s_add_u32 s64, s65, s83
  buffer_load_dwordx4 a[200:203], v1, s[8:11], s64 offen sc1
  v_exp_f32 v248, v248
  v_mfma_f32_16x16x32_bf16 v[192:195], a[132:135], v[144:147], v[192:195]
  ds_read_b128 a[144:147], v2 offset:17152
  v_mfma_f32_16x16x32_bf16 v[192:195], a[136:139], v[160:163], v[192:195]
  v_exp_f32 v249, v249
  v_mfma_f32_16x16x32_bf16 v[192:195], a[140:143], v[176:179], v[192:195]
  ds_read_b128 a[148:151], v2 offset:17216
  v_cvt_pk_bf16_f32 v70, v248, v249
  v_mfma_f32_16x16x32_bf16 v[196:199], a[140:143], v[180:183], v[36:39]
  buffer_load_dwordx4 a[204:207], v124, s[8:11], s64 offen sc1
  v_exp_f32 v250, v250
  v_mfma_f32_16x16x32_bf16 v[196:199], a[136:139], v[164:167], v[196:199]
  ds_read_b128 a[152:155], v2 offset:17280
  v_mfma_f32_16x16x32_bf16 v[196:199], a[132:135], v[148:151], v[196:199]
  v_exp_f32 v251, v251
  v_mfma_f32_16x16x32_bf16 v[196:199], a[128:131], v[132:135], v[196:199]
  s_add_u32 s64, s64, 8192
  ds_read_b128 a[156:159], v2 offset:17344
  v_cvt_pk_bf16_f32 v71, v250, v251
  v_mfma_f32_16x16x32_bf16 v[200:203], a[128:131], v[136:139], v[40:43]
  buffer_load_dwordx4 a[208:211], v1, s[8:11], s64 offen sc1
  v_exp_f32 v244, v244
  v_mfma_f32_16x16x32_bf16 v[200:203], a[132:135], v[152:155], v[200:203]
  v_mfma_f32_16x16x32_bf16 v[200:203], a[136:139], v[168:171], v[200:203]
  v_exp_f32 v245, v245
  v_mfma_f32_16x16x32_bf16 v[200:203], a[140:143], v[184:187], v[200:203]
  s_add_u32 s64, s65, s85
  v_cvt_pk_bf16_f32 v62, v244, v245
  v_mfma_f32_16x16x32_bf16 v[204:207], a[140:143], v[188:191], v[44:47]
  buffer_load_dwordx4 a[212:215], v1, s[8:11], s64 offen sc1
  v_exp_f32 v246, v246
  v_mfma_f32_16x16x32_bf16 v[204:207], a[136:139], v[172:175], v[204:207]
  v_mfma_f32_16x16x32_bf16 v[204:207], a[132:135], v[156:159], v[204:207]
  v_exp_f32 v247, v247
  v_mfma_f32_16x16x32_bf16 v[204:207], a[128:131], v[140:143], v[204:207]
  s_waitcnt lgkmcnt(3)
  s_waitcnt lgkmcnt(0)
  buffer_load_dwordx4 a[216:219], v124, s[8:11], s64 offen sc1
  v_mfma_f32_16x16x32_bf16 v[220:223], a[144:147], v[140:143], v[44:47]
  v_exp_f32 v240, v240
  v_mfma_f32_16x16x32_bf16 v[220:223], a[148:151], v[156:159], v[220:223]
  ds_read_b128 a[128:131], v2 offset:17408
  v_cvt_pk_bf16_f32 v63, v246, v247
  v_mfma_f32_16x16x32_bf16 v[220:223], a[152:155], v[172:175], v[220:223]
  v_exp_f32 v241, v241
  v_mfma_f32_16x16x32_bf16 v[220:223], a[156:159], v[188:191], v[220:223]
  s_add_u32 s64, s64, 8192
  ds_read_b128 a[132:135], v2 offset:17472
  v_cvt_pk_bf16_f32 v54, v240, v241
  v_mfma_f32_16x16x32_bf16 v[216:219], a[156:159], v[184:187], v[40:43]
  buffer_load_dwordx4 a[220:223], v1, s[8:11], s64 offen sc1
  v_exp_f32 v242, v242
  v_mfma_f32_16x16x32_bf16 v[216:219], a[152:155], v[168:171], v[216:219]
  s_bfe_u32 s67, 0x30201, s62
  s_mul_i32 s67, s67, 15360
  ds_read_b128 a[136:139], v2 offset:17536
  v_mfma_f32_16x16x32_bf16 v[216:219], a[148:151], v[152:155], v[216:219]
  s_add_u32 s66, s67, s82
  v_exp_f32 v243, v243
  v_mfma_f32_16x16x32_bf16 v[216:219], a[144:147], v[136:139], v[216:219]
  s_add_u32 m0, s68, 0
  ds_read_b128 a[140:143], v2 offset:17600
  v_cvt_pk_bf16_f32 v55, v242, v243
  v_mfma_f32_16x16x32_bf16 v[212:215], a[144:147], v[132:135], v[36:39]
  buffer_load_dwordx4 v5, s[8:11], s66 offen lds
  v_exp_f32 v192, v192
  v_mfma_f32_16x16x32_bf16 v[212:215], a[148:151], v[148:151], v[212:215]
  v_mfma_f32_16x16x32_bf16 v[212:215], a[152:155], v[164:167], v[212:215]
  v_exp_f32 v193, v193
  v_mfma_f32_16x16x32_bf16 v[212:215], a[156:159], v[180:183], v[212:215]
  s_add_u32 m0, s68, 4096
  v_cvt_pk_bf16_f32 v80, v192, v193
  v_mfma_f32_16x16x32_bf16 v[208:211], a[156:159], v[176:179], v[32:35]
  buffer_load_dwordx4 v6, s[8:11], s66 offen lds
  v_exp_f32 v194, v194
  v_mfma_f32_16x16x32_bf16 v[208:211], a[152:155], v[160:163], v[208:211]
  v_mfma_f32_16x16x32_bf16 v[208:211], a[148:151], v[144:147], v[208:211]
  s_add_u32 m0, s68, 8192
  v_exp_f32 v195, v195
  v_mfma_f32_16x16x32_bf16 v[208:211], a[144:147], v[128:131], v[208:211]
  s_waitcnt lgkmcnt(3)
  s_waitcnt lgkmcnt(0)
  buffer_load_dwordx4 v7, s[8:11], s66 offen lds
  v_mfma_f32_16x16x32_bf16 v[224:227], a[128:131], v[128:131], v[32:35]
  v_exp_f32 v196, v196
  v_mfma_f32_16x16x32_bf16 v[224:227], a[132:135], v[144:147], v[224:227]
  ds_read_b128 a[144:147], v2 offset:17664
  v_cvt_pk_bf16_f32 v81, v194, v195
  v_mfma_f32_16x16x32_bf16 v[224:227], a[136:139], v[160:163], v[224:227]
  v_exp_f32 v197, v197
  v_mfma_f32_16x16x32_bf16 v[224:227], a[140:143], v[176:179], v[224:227]
  s_add_u32 m0, s68, 12288
  ds_read_b128 a[148:151], v2 offset:17728
  v_cvt_pk_bf16_f32 v88, v196, v197
  v_mfma_f32_16x16x32_bf16 v[228:231], a[140:143], v[180:183], v[36:39]
  buffer_load_dwordx4 v8, s[8:11], s66 offen lds
  v_exp_f32 v198, v198
  v_mfma_f32_16x16x32_bf16 v[228:231], a[136:139], v[164:167], v[228:231]
  s_bfe_u32 s65, 0x30201, s62
  ds_read_b128 a[152:155], v2 offset:17792
  v_mfma_f32_16x16x32_bf16 v[228:231], a[132:135], v[148:151], v[228:231]
  s_mul_i32 s65, s65, 12288
  v_exp_f32 v199, v199
  v_mfma_f32_16x16x32_bf16 v[228:231], a[128:131], v[132:135], v[228:231]
  s_add_u32 s64, s65, s83
  ds_read_b128 a[156:159], v2 offset:17856
  v_cvt_pk_bf16_f32 v89, v198, v199
  v_mfma_f32_16x16x32_bf16 v[232:235], a[128:131], v[136:139], v[40:43]
  buffer_load_dwordx4 a[224:227], v1, s[8:11], s64 offen sc1
  v_exp_f32 v200, v200
  v_mfma_f32_16x16x32_bf16 v[232:235], a[132:135], v[152:155], v[232:235]
  v_mfma_f32_16x16x32_bf16 v[232:235], a[136:139], v[168:171], v[232:235]
  v_exp_f32 v201, v201
  v_mfma_f32_16x16x32_bf16 v[232:235], a[140:143], v[184:187], v[232:235]
  v_cvt_pk_bf16_f32 v96, v200, v201
  v_mfma_f32_16x16x32_bf16 v[236:239], a[140:143], v[188:191], v[44:47]
  buffer_load_dwordx4 a[228:231], v124, s[8:11], s64 offen sc1
  v_exp_f32 v202, v202
  v_mfma_f32_16x16x32_bf16 v[236:239], a[136:139], v[172:175], v[236:239]
  v_mfma_f32_16x16x32_bf16 v[236:239], a[132:135], v[156:159], v[236:239]
  v_exp_f32 v203, v203
  v_mfma_f32_16x16x32_bf16 v[236:239], a[128:131], v[140:143], v[236:239]
  s_waitcnt lgkmcnt(3)
  s_waitcnt lgkmcnt(0)
  s_add_u32 s64, s64, 8192
  v_cvt_pk_bf16_f32 v97, v202, v203
  v_mfma_f32_16x16x32_bf16 v[252:255], a[144:147], v[140:143], v[44:47]
  buffer_load_dwordx4 a[232:235], v1, s[8:11], s64 offen sc1
  v_exp_f32 v204, v204
  v_mfma_f32_16x16x32_bf16 v[252:255], a[148:151], v[156:159], v[252:255]
  ds_read_b64_tr_b16 a[160:161], v3 offset:0
  v_mfma_f32_16x16x32_bf16 v[252:255], a[152:155], v[172:175], v[252:255]
  v_exp_f32 v205, v205
  v_mfma_f32_16x16x32_bf16 v[252:255], a[156:159], v[188:191], v[252:255]
  s_add_u32 s64, s65, s85
  ds_read_b64_tr_b16 a[162:163], v3 offset:256
  v_cvt_pk_bf16_f32 v104, v204, v205
  v_mfma_f32_16x16x32_bf16 v[248:251], a[156:159], v[184:187], v[40:43]
  buffer_load_dwordx4 a[236:239], v1, s[8:11], s64 offen sc1
  v_exp_f32 v206, v206
  v_mfma_f32_16x16x32_bf16 v[248:251], a[152:155], v[168:171], v[248:251]
  ds_read_b64_tr_b16 a[164:165], v3 offset:512
  v_mfma_f32_16x16x32_bf16 v[248:251], a[148:151], v[152:155], v[248:251]
  v_exp_f32 v207, v207
  v_mfma_f32_16x16x32_bf16 v[248:251], a[144:147], v[136:139], v[248:251]
  ds_read_b64_tr_b16 a[166:167], v3 offset:768
  v_cvt_pk_bf16_f32 v105, v206, v207
  v_mfma_f32_16x16x32_bf16 v[244:247], a[144:147], v[132:135], v[36:39]
  buffer_load_dwordx4 a[240:243], v124, s[8:11], s64 offen sc1
  v_exp_f32 v220, v220
  v_mfma_f32_16x16x32_bf16 v[244:247], a[148:151], v[148:151], v[244:247]
  ds_read_b64_tr_b16 a[168:169], v3 offset:32
  v_mfma_f32_16x16x32_bf16 v[244:247], a[152:155], v[164:167], v[244:247]
  v_exp_f32 v221, v221
  v_mfma_f32_16x16x32_bf16 v[244:247], a[156:159], v[180:183], v[244:247]
  s_add_u32 s64, s64, 8192
  ds_read_b64_tr_b16 a[170:171], v3 offset:288
  v_cvt_pk_bf16_f32 v106, v220, v221
  v_mfma_f32_16x16x32_bf16 v[240:243], a[156:159], v[176:179], v[32:35]
  buffer_load_dwordx4 a[244:247], v1, s[8:11], s64 offen sc1
  v_exp_f32 v222, v222
  v_mfma_f32_16x16x32_bf16 v[240:243], a[152:155], v[160:163], v[240:243]
  s_bfe_u32 s67, 0x1000302, s62
  s_mul_i32 s67, s67, 15360
  ds_read_b64_tr_b16 a[172:173], v3 offset:544
  v_mfma_f32_16x16x32_bf16 v[240:243], a[148:151], v[144:147], v[240:243]
  s_add_u32 s66, s67, s82
  v_exp_f32 v223, v223
  v_mfma_f32_16x16x32_bf16 v[240:243], a[144:147], v[128:131], v[240:243]
  s_waitcnt lgkmcnt(5)
  s_waitcnt lgkmcnt(3)
  s_add_u32 m0, s68, 53248
  ds_read_b64_tr_b16 a[174:175], v3 offset:800
  v_cvt_pk_bf16_f32 v107, v222, v223
  v_mfma_f32_16x16x32_bf16 a[12:15], a[160:163], v[72:75], a[12:15]
  buffer_load_dwordx4 v5, s[8:11], s66 offen lds
  v_exp_f32 v216, v216
  v_mfma_f32_16x16x32_bf16 a[12:15], a[164:167], v[76:79], a[12:15]
  ds_read_b64_tr_b16 a[176:177], v3 offset:64
  v_mfma_f32_16x16x32_bf16 a[8:11], a[160:163], v[64:67], a[8:11]
  v_exp_f32 v217, v217
  v_mfma_f32_16x16x32_bf16 a[8:11], a[164:167], v[68:71], a[8:11]
  s_add_u32 m0, s68, 57344
  ds_read_b64_tr_b16 a[178:179], v3 offset:320
  v_cvt_pk_bf16_f32 v98, v216, v217
  v_mfma_f32_16x16x32_bf16 a[4:7], a[160:163], v[56:59], a[4:7]
  buffer_load_dwordx4 v6, s[8:11], s66 offen lds
  v_exp_f32 v218, v218
  v_mfma_f32_16x16x32_bf16 a[4:7], a[164:167], v[60:63], a[4:7]
  ds_read_b64_tr_b16 a[180:181], v3 offset:576
  v_mfma_f32_16x16x32_bf16 a[0:3], a[160:163], v[48:51], a[0:3]
  v_exp_f32 v219, v219
  v_mfma_f32_16x16x32_bf16 a[0:3], a[164:167], v[52:55], a[0:3]
  s_waitcnt lgkmcnt(5)
  s_waitcnt lgkmcnt(3)
  s_add_u32 m0, s68, 61440
  ds_read_b64_tr_b16 a[182:183], v3 offset:832
  v_cvt_pk_bf16_f32 v99, v218, v219
  v_mfma_f32_16x16x32_bf16 a[16:19], a[168:171], v[48:51], a[16:19]
  buffer_load_dwordx4 v7, s[8:11], s66 offen lds
  v_exp_f32 v212, v212
  v_mfma_f32_16x16x32_bf16 a[16:19], a[172:175], v[52:55], a[16:19]
  ds_read_b64_tr_b16 a[184:185], v3 offset:96
  v_mfma_f32_16x16x32_bf16 a[20:23], a[168:171], v[56:59], a[20:23]
  v_exp_f32 v213, v213
  v_mfma_f32_16x16x32_bf16 a[20:23], a[172:175], v[60:63], a[20:23]
  s_add_u32 m0, s68, 102400
  ds_read_b64_tr_b16 a[186:187], v3 offset:352
  v_cvt_pk_bf16_f32 v90, v212, v213
  v_mfma_f32_16x16x32_bf16 a[24:27], a[168:171], v[64:67], a[24:27]
  buffer_load_dwordx4 v8, s[8:11], s66 offen lds
  v_exp_f32 v214, v214
  v_mfma_f32_16x16x32_bf16 a[24:27], a[172:175], v[68:71], a[24:27]
  s_bfe_u32 s65, 0x1000302, s62
  ds_read_b64_tr_b16 a[188:189], v3 offset:608
  v_mfma_f32_16x16x32_bf16 a[28:31], a[168:171], v[72:75], a[28:31]
  s_mul_i32 s65, s65, 12288
  v_exp_f32 v215, v215
  v_mfma_f32_16x16x32_bf16 a[28:31], a[172:175], v[76:79], a[28:31]
  s_waitcnt lgkmcnt(5)
  s_waitcnt lgkmcnt(3)
  s_add_u32 s64, s65, s83
  ds_read_b64_tr_b16 a[190:191], v3 offset:864
  v_cvt_pk_bf16_f32 v91, v214, v215
  v_mfma_f32_16x16x32_bf16 a[44:47], a[176:179], v[72:75], a[44:47]
  buffer_load_dwordx4 a[248:251], v1, s[8:11], s64 offen sc1
  v_exp_f32 v208, v208
  v_mfma_f32_16x16x32_bf16 a[44:47], a[180:183], v[76:79], a[44:47]
  ds_read_b64_tr_b16 a[160:161], v3 offset:128
  v_mfma_f32_16x16x32_bf16 a[40:43], a[176:179], v[64:67], a[40:43]
  v_exp_f32 v209, v209
  v_mfma_f32_16x16x32_bf16 a[40:43], a[180:183], v[68:71], a[40:43]
  ds_read_b64_tr_b16 a[162:163], v3 offset:384
  v_cvt_pk_bf16_f32 v82, v208, v209
  v_mfma_f32_16x16x32_bf16 a[36:39], a[176:179], v[56:59], a[36:39]
  buffer_load_dwordx4 a[252:255], v124, s[8:11], s64 offen sc1
  v_exp_f32 v210, v210
  v_mfma_f32_16x16x32_bf16 a[36:39], a[180:183], v[60:63], a[36:39]
  ds_read_b64_tr_b16 a[164:165], v3 offset:640
  v_mfma_f32_16x16x32_bf16 a[32:35], a[176:179], v[48:51], a[32:35]
  v_exp_f32 v211, v211
  v_mfma_f32_16x16x32_bf16 a[32:35], a[180:183], v[52:55], a[32:35]
  s_waitcnt lgkmcnt(5)
  s_waitcnt lgkmcnt(3)
  s_add_u32 s64, s64, 8192
  ds_read_b64_tr_b16 a[166:167], v3 offset:896
  v_cvt_pk_bf16_f32 v83, v210, v211
  v_mfma_f32_16x16x32_bf16 a[48:51], a[184:187], v[48:51], a[48:51]
  buffer_load_dwordx4 v[128:131], v1, s[8:11], s64 offen sc1
  v_exp_f32 v224, v224
  v_mfma_f32_16x16x32_bf16 a[48:51], a[188:191], v[52:55], a[48:51]
  ds_read_b64_tr_b16 a[168:169], v3 offset:160
  v_mfma_f32_16x16x32_bf16 a[52:55], a[184:187], v[56:59], a[52:55]
  v_exp_f32 v225, v225
  v_mfma_f32_16x16x32_bf16 a[52:55], a[188:191], v[60:63], a[52:55]
  s_add_u32 s64, s65, s85
  ds_read_b64_tr_b16 a[170:171], v3 offset:416
  v_cvt_pk_bf16_f32 v84, v224, v225
  v_mfma_f32_16x16x32_bf16 a[56:59], a[184:187], v[64:67], a[56:59]
  buffer_load_dwordx4 v[132:135], v1, s[8:11], s64 offen sc1
  v_exp_f32 v226, v226
  v_mfma_f32_16x16x32_bf16 a[56:59], a[188:191], v[68:71], a[56:59]
  ds_read_b64_tr_b16 a[172:173], v3 offset:672
  v_mfma_f32_16x16x32_bf16 a[60:63], a[184:187], v[72:75], a[60:63]
  v_exp_f32 v227, v227
  v_mfma_f32_16x16x32_bf16 a[60:63], a[188:191], v[76:79], a[60:63]
  s_waitcnt lgkmcnt(5)
  s_waitcnt lgkmcnt(3)
  ds_read_b64_tr_b16 a[174:175], v3 offset:928
  v_cvt_pk_bf16_f32 v85, v226, v227
  v_mfma_f32_16x16x32_bf16 a[76:79], a[160:163], v[72:75], a[76:79]
  buffer_load_dwordx4 v[136:139], v124, s[8:11], s64 offen sc1
  v_exp_f32 v228, v228
  v_mfma_f32_16x16x32_bf16 a[76:79], a[164:167], v[76:79], a[76:79]
  ds_read_b64_tr_b16 a[176:177], v3 offset:192
  v_mfma_f32_16x16x32_bf16 a[72:75], a[160:163], v[64:67], a[72:75]
  v_exp_f32 v229, v229
  v_mfma_f32_16x16x32_bf16 a[72:75], a[164:167], v[68:71], a[72:75]
  s_add_u32 s64, s64, 8192
  ds_read_b64_tr_b16 a[178:179], v3 offset:448
  v_cvt_pk_bf16_f32 v92, v228, v229
  v_mfma_f32_16x16x32_bf16 a[68:71], a[160:163], v[56:59], a[68:71]
  buffer_load_dwordx4 v[140:143], v1, s[8:11], s64 offen sc1
  v_exp_f32 v230, v230
  v_mfma_f32_16x16x32_bf16 a[68:71], a[164:167], v[60:63], a[68:71]
  s_bfe_u32 s67, 0x2010003, s62
  s_mul_i32 s67, s67, 15360
  ds_read_b64_tr_b16 a[180:181], v3 offset:704
  v_mfma_f32_16x16x32_bf16 a[64:67], a[160:163], v[48:51], a[64:67]
  s_add_u32 s66, s67, s82
  v_exp_f32 v231, v231
  v_mfma_f32_16x16x32_bf16 a[64:67], a[164:167], v[52:55], a[64:67]
  s_waitcnt lgkmcnt(5)
  s_waitcnt lgkmcnt(3)
  s_add_u32 m0, s68, 106496
  ds_read_b64_tr_b16 a[182:183], v3 offset:960
  v_cvt_pk_bf16_f32 v93, v230, v231
  v_mfma_f32_16x16x32_bf16 a[80:83], a[168:171], v[48:51], a[80:83]
  buffer_load_dwordx4 v5, s[8:11], s66 offen lds
  v_exp_f32 v232, v232
  v_mfma_f32_16x16x32_bf16 a[80:83], a[172:175], v[52:55], a[80:83]
  ds_read_b64_tr_b16 a[184:185], v3 offset:224
  v_mfma_f32_16x16x32_bf16 a[84:87], a[168:171], v[56:59], a[84:87]
  v_exp_f32 v233, v233
  v_mfma_f32_16x16x32_bf16 a[84:87], a[172:175], v[60:63], a[84:87]
  s_add_u32 m0, s68, 110592
  ds_read_b64_tr_b16 a[186:187], v3 offset:480
  v_cvt_pk_bf16_f32 v100, v232, v233
  v_mfma_f32_16x16x32_bf16 a[88:91], a[168:171], v[64:67], a[88:91]
  buffer_load_dwordx4 v6, s[8:11], s66 offen lds
  v_exp_f32 v234, v234
  v_mfma_f32_16x16x32_bf16 a[88:91], a[172:175], v[68:71], a[88:91]
  ds_read_b64_tr_b16 a[188:189], v3 offset:736
  v_mfma_f32_16x16x32_bf16 a[92:95], a[168:171], v[72:75], a[92:95]
  s_waitcnt vmcnt(28)
  v_exp_f32 v235, v235
  v_mfma_f32_16x16x32_bf16 a[92:95], a[172:175], v[76:79], a[92:95]
  s_waitcnt lgkmcnt(5)
  s_waitcnt lgkmcnt(3)
  ds_read_b64_tr_b16 a[190:191], v3 offset:992
  v_cvt_pk_bf16_f32 v101, v234, v235
  v_mfma_f32_16x16x32_bf16 a[108:111], a[176:179], v[72:75], a[108:111]
  s_barrier
  v_exp_f32 v236, v236
  v_mfma_f32_16x16x32_bf16 a[108:111], a[180:183], v[76:79], a[108:111]
  s_add_u32 m0, s68, 114688
  s_nop 0
  buffer_load_dwordx4 v7, s[8:11], s66 offen lds
  v_mfma_f32_16x16x32_bf16 a[104:107], a[176:179], v[64:67], a[104:107]
  s_add_u32 m0, s68, 118784
  v_exp_f32 v237, v237
  v_mfma_f32_16x16x32_bf16 a[104:107], a[180:183], v[68:71], a[104:107]
  buffer_load_dwordx4 v8, s[8:11], s66 offen lds
  v_mfma_f32_16x16x32_bf16 a[100:103], a[176:179], v[56:59], a[100:103]
  s_bfe_u32 s65, 0x2010003, s62
  v_exp_f32 v238, v238
  v_mfma_f32_16x16x32_bf16 a[100:103], a[180:183], v[60:63], a[100:103]
  s_mul_i32 s65, s65, 12288
  v_cvt_pk_bf16_f32 v108, v236, v237
  v_mfma_f32_16x16x32_bf16 a[96:99], a[176:179], v[48:51], a[96:99]
  s_add_u32 s64, s65, s83
  v_exp_f32 v239, v239
  v_mfma_f32_16x16x32_bf16 a[96:99], a[180:183], v[52:55], a[96:99]
  s_waitcnt lgkmcnt(2)
  s_waitcnt lgkmcnt(0)
  buffer_load_dwordx4 v[144:147], v1, s[8:11], s64 offen sc1
  v_mfma_f32_16x16x32_bf16 a[112:115], a[184:187], v[48:51], a[112:115]
  v_exp_f32 v252, v252
  v_mfma_f32_16x16x32_bf16 a[112:115], a[188:191], v[52:55], a[112:115]
  v_cvt_pk_bf16_f32 v109, v238, v239
  v_mfma_f32_16x16x32_bf16 a[116:119], a[184:187], v[56:59], a[116:119]
  v_exp_f32 v253, v253
  v_mfma_f32_16x16x32_bf16 a[116:119], a[188:191], v[60:63], a[116:119]
  buffer_load_dwordx4 v[148:151], v124, s[8:11], s64 offen sc1
  v_mfma_f32_16x16x32_bf16 a[120:123], a[184:187], v[64:67], a[120:123]
  v_exp_f32 v254, v254
  v_mfma_f32_16x16x32_bf16 a[120:123], a[188:191], v[68:71], a[120:123]
  v_cvt_pk_bf16_f32 v110, v252, v253
  v_mfma_f32_16x16x32_bf16 a[124:127], a[184:187], v[72:75], a[124:127]
  s_add_u32 s64, s64, 8192
  v_exp_f32 v255, v255
  v_mfma_f32_16x16x32_bf16 a[124:127], a[188:191], v[76:79], a[124:127]
  buffer_load_dwordx4 v[152:155], v1, s[8:11], s64 offen sc1
  v_smfmac_f32_16x16x64_bf16 a[196:199], v[20:23], v[72:79], v118
  s_add_u32 s64, s65, s85
  v_cvt_pk_bf16_f32 v111, v254, v255
  v_smfmac_f32_16x16x64_bf16 a[196:199], v[28:31], v[64:71], v118
  buffer_load_dwordx4 v[156:159], v1, s[8:11], s64 offen sc1
  v_smfmac_f32_16x16x64_bf16 a[192:195], v[28:31], v[48:55], v118
  v_smfmac_f32_16x16x64_bf16 a[192:195], v[20:23], v[56:63], v118
  buffer_load_dwordx4 v[160:163], v124, s[8:11], s64 offen sc1
  v_exp_f32 v248, v248
  v_exp_f32 v249, v249
  s_nop 0
  v_cvt_pk_bf16_f32 v102, v248, v249
  s_add_u32 s64, s64, 8192
  v_exp_f32 v250, v250
  buffer_load_dwordx4 v[164:167], v1, s[8:11], s64 offen sc1
  v_exp_f32 v251, v251
  s_nop 0
  v_cvt_pk_bf16_f32 v103, v250, v251
  v_exp_f32 v244, v244
  v_exp_f32 v245, v245
  s_nop 0
  v_cvt_pk_bf16_f32 v94, v244, v245
  v_exp_f32 v246, v246
  v_exp_f32 v247, v247
  s_bfe_u32 s67, 0x7060504, s62
  v_cvt_pk_bf16_f32 v95, v246, v247
  s_mul_i32 s67, s67, 15360
  v_exp_f32 v240, v240
  s_add_u32 s66, s67, s82
  v_exp_f32 v241, v241
  s_add_u32 m0, s68, 122880
  v_cvt_pk_bf16_f32 v86, v240, v241
  buffer_load_dwordx4 v5, s[8:11], s66 offen lds
  v_exp_f32 v242, v242
  v_exp_f32 v243, v243
  s_nop 0
  v_cvt_pk_bf16_f32 v87, v242, v243
  ds_read_b64_tr_b16 a[160:161], v3 offset:16896
  ds_read_b64_tr_b16 a[162:163], v3 offset:17152
  ds_read_b64_tr_b16 a[164:165], v3 offset:17408
  ds_read_b64_tr_b16 a[166:167], v3 offset:17664
  ds_read_b64_tr_b16 a[168:169], v3 offset:16928
  ds_read_b64_tr_b16 a[170:171], v3 offset:17184
  ds_read_b64_tr_b16 a[172:173], v3 offset:17440
  v_smfmac_f32_16x16x64_bf16 a[196:199], v[20:23], v[104:111], v118
  s_add_u32 m0, s68, 126976
  v_smfmac_f32_16x16x64_bf16 a[196:199], v[28:31], v[96:103], v118
  buffer_load_dwordx4 v6, s[8:11], s66 offen lds
  v_smfmac_f32_16x16x64_bf16 a[192:195], v[28:31], v[80:87], v118
  v_smfmac_f32_16x16x64_bf16 a[192:195], v[20:23], v[88:95], v118
  s_waitcnt lgkmcnt(5)
  s_waitcnt lgkmcnt(3)
  ds_read_b64_tr_b16 a[174:175], v3 offset:17696
  v_mfma_f32_16x16x32_bf16 a[12:15], a[160:163], v[104:107], a[12:15]
  s_mov_b32 s60, 0x53800000
  v_accvgpr_read_b32 v23, a198
  v_accvgpr_read_b32 v15, a199
  v_mfma_f32_16x16x32_bf16 a[12:15], a[164:167], v[108:111], a[12:15]
  s_lshl2_add_u32 s3, s54, 85504
  s_add_u32 m0, s68, 131072
  ds_read_b64_tr_b16 a[176:177], v3 offset:16960
  v_accvgpr_read_b32 v22, a196
  v_mfma_f32_16x16x32_bf16 a[8:11], a[160:163], v[96:99], a[8:11]
  s_mul_i32 s58, s56, 182
  buffer_load_dwordx4 v7, s[8:11], s66 offen lds
  v_mfma_f32_16x16x32_bf16 a[8:11], a[164:167], v[100:103], a[8:11]
  s_lshl2_add_u32 s58, s55, s58
  ds_read_b64_tr_b16 a[178:179], v3 offset:17216
  v_accvgpr_read_b32 v14, a197
  v_mfma_f32_16x16x32_bf16 a[4:7], a[160:163], v[88:91], a[4:7]
  s_lshl_b32 s58, s58, 12
  v_accvgpr_read_b32 v20, a192
  v_accvgpr_read_b32 v12, a193
  v_mfma_f32_16x16x32_bf16 a[4:7], a[164:167], v[92:95], a[4:7]
  s_add_u32 s58, s58, 0x436000
  s_add_u32 m0, s68, 135168
  ds_read_b64_tr_b16 a[180:181], v3 offset:17472
  v_accvgpr_read_b32 v21, a194
  v_mfma_f32_16x16x32_bf16 a[0:3], a[160:163], v[80:83], a[0:3]
  buffer_load_dwordx4 v8, s[8:11], s66 offen lds
  v_mfma_f32_16x16x32_bf16 a[0:3], a[164:167], v[84:87], a[0:3]
  s_waitcnt lgkmcnt(5)
  s_waitcnt lgkmcnt(3)
  ds_read_b64_tr_b16 a[182:183], v3 offset:17728
  v_accvgpr_read_b32 v13, a195
  v_mfma_f32_16x16x32_bf16 a[16:19], a[168:171], v[80:83], a[16:19]
  v_add_f32 v23, v23, v15
  v_add_f32 v22, v22, v14
  v_mfma_f32_16x16x32_bf16 a[16:19], a[172:175], v[84:87], a[16:19]
  s_bfe_u32 s65, 0x7060504, s62
  ds_read_b64_tr_b16 a[184:185], v3 offset:16992
  v_add_f32 v20, v20, v12
  v_mfma_f32_16x16x32_bf16 a[20:23], a[168:171], v[88:91], a[20:23]
  s_mul_i32 s65, s65, 12288
  v_add_f32 v21, v21, v13
  v_mfma_f32_16x16x32_bf16 a[20:23], a[172:175], v[92:95], a[20:23]
  s_add_u32 s64, s65, s83
  ds_read_b64_tr_b16 a[186:187], v3 offset:17248
  v_mfma_f32_16x16x32_bf16 a[24:27], a[168:171], v[96:99], a[24:27]
  buffer_load_dwordx4 v[168:171], v1, s[8:11], s64 offen sc1
  v_mfma_f32_16x16x32_bf16 a[24:27], a[172:175], v[100:103], a[24:27]
  ds_read_b64_tr_b16 a[188:189], v3 offset:17504
  v_mfma_f32_16x16x32_bf16 a[28:31], a[168:171], v[104:107], a[28:31]
  v_rcp_f32 v12, v20
  v_mfma_f32_16x16x32_bf16 a[28:31], a[172:175], v[108:111], a[28:31]
  s_waitcnt lgkmcnt(5)
  s_waitcnt lgkmcnt(3)
  ds_read_b64_tr_b16 a[190:191], v3 offset:17760
  v_mfma_f32_16x16x32_bf16 a[44:47], a[176:179], v[104:107], a[44:47]
  buffer_load_dwordx4 v[172:175], v124, s[8:11], s64 offen sc1
  v_mfma_f32_16x16x32_bf16 a[44:47], a[180:183], v[108:111], a[44:47]
  ds_read_b64_tr_b16 a[160:161], v3 offset:17024
  v_mfma_f32_16x16x32_bf16 a[40:43], a[176:179], v[96:99], a[40:43]
  v_rcp_f32 v14, v21
  v_mfma_f32_16x16x32_bf16 a[40:43], a[180:183], v[100:103], a[40:43]
  s_add_u32 s64, s64, 8192
  ds_read_b64_tr_b16 a[162:163], v3 offset:17280
  v_mfma_f32_16x16x32_bf16 a[36:39], a[176:179], v[88:91], a[36:39]
  buffer_load_dwordx4 v[176:179], v1, s[8:11], s64 offen sc1
  v_mfma_f32_16x16x32_bf16 a[36:39], a[180:183], v[92:95], a[36:39]
  ds_read_b64_tr_b16 a[164:165], v3 offset:17536
  v_mfma_f32_16x16x32_bf16 a[32:35], a[176:179], v[80:83], a[32:35]
  v_rcp_f32 v16, v22
  v_mfma_f32_16x16x32_bf16 a[32:35], a[180:183], v[84:87], a[32:35]
  s_waitcnt lgkmcnt(5)
  s_waitcnt lgkmcnt(3)
  ds_read_b64_tr_b16 a[166:167], v3 offset:17792
  v_mfma_f32_16x16x32_bf16 a[48:51], a[184:187], v[80:83], a[48:51]
  v_rcp_f32 v18, v23
  v_mfma_f32_16x16x32_bf16 a[48:51], a[188:191], v[84:87], a[48:51]
  s_add_u32 s64, s65, s85
  ds_read_b64_tr_b16 a[168:169], v3 offset:17056
  v_add_f32 v20, v20, v21
  v_mfma_f32_16x16x32_bf16 a[52:55], a[184:187], v[88:91], a[52:55]
  buffer_load_dwordx4 v[180:183], v1, s[8:11], s64 offen sc1
  v_mfma_f32_16x16x32_bf16 a[52:55], a[188:191], v[92:95], a[52:55]
  ds_read_b64_tr_b16 a[170:171], v3 offset:17312
  v_add_f32 v22, v22, v23
  v_mfma_f32_16x16x32_bf16 a[56:59], a[184:187], v[96:99], a[56:59]
  v_mov_b32 v24, s3
  v_add_f32 v20, v20, v22
  v_mfma_f32_16x16x32_bf16 a[56:59], a[188:191], v[100:103], a[56:59]
  ds_read_b64_tr_b16 a[172:173], v3 offset:17568
  v_and_b32 v26, 3, v0
  v_mfma_f32_16x16x32_bf16 a[60:63], a[184:187], v[104:107], a[60:63]
  buffer_load_dwordx4 v[184:187], v124, s[8:11], s64 offen sc1
  v_mfma_f32_16x16x32_bf16 a[60:63], a[188:191], v[108:111], a[60:63]
  s_waitcnt lgkmcnt(5)
  s_waitcnt lgkmcnt(3)
  ds_read_b64_tr_b16 a[174:175], v3 offset:17824
  v_cmp_nge_f32 vcc, s60, v20
  v_mfma_f32_16x16x32_bf16 a[76:79], a[160:163], v[104:107], a[76:79]
  v_lshlrev_b32 v26, 2, v26
  v_add_u32 v26, 85504, v26
  v_mfma_f32_16x16x32_bf16 a[76:79], a[164:167], v[108:111], a[76:79]
  s_add_u32 s64, s64, 8192
  ds_read_b64_tr_b16 a[176:177], v3 offset:17088
  s_cmp_lg_u64 vcc, 0
  s_cselect_b32 s60, 1, 0
  v_mfma_f32_16x16x32_bf16 a[72:75], a[160:163], v[96:99], a[72:75]
  buffer_load_dwordx4 v[188:191], v1, s[8:11], s64 offen sc1
  v_mfma_f32_16x16x32_bf16 a[72:75], a[164:167], v[100:103], a[72:75]
  s_bfe_u32 s67, 0x4070605, s62
  s_mul_i32 s67, s67, 15360
  ds_read_b64_tr_b16 a[178:179], v3 offset:17344
  s_andn2_b32 s60, s60, s53
  v_mfma_f32_16x16x32_bf16 a[68:71], a[160:163], v[88:91], a[68:71]
  s_add_u32 s66, s67, s82
  v_mov_b32 v25, s60
  ds_write_b32 v24, v25
  v_mfma_f32_16x16x32_bf16 a[68:71], a[164:167], v[92:95], a[68:71]
  s_add_u32 m0, s68, 139264
  ds_read_b64_tr_b16 a[180:181], v3 offset:17600
  v_add_u32 v2, 65536, v1
  v_mfma_f32_16x16x32_bf16 a[64:67], a[160:163], v[80:83], a[64:67]
  buffer_load_dwordx4 v5, s[8:11], s66 offen lds
  v_mfma_f32_16x16x32_bf16 a[64:67], a[164:167], v[84:87], a[64:67]
  s_waitcnt lgkmcnt(6)
  s_waitcnt lgkmcnt(3)
  ds_read_b64_tr_b16 a[182:183], v3 offset:17856
  v_accvgpr_read_b32 v192, a0
  v_mfma_f32_16x16x32_bf16 a[80:83], a[168:171], v[80:83], a[80:83]
  v_accvgpr_read_b32 v193, a1
  v_accvgpr_read_b32 v194, a2
  v_mfma_f32_16x16x32_bf16 a[80:83], a[172:175], v[84:87], a[80:83]
  s_add_u32 m0, s68, 143360
  ds_read_b64_tr_b16 a[184:185], v3 offset:17120
  v_accvgpr_read_b32 v195, a3
  v_mfma_f32_16x16x32_bf16 a[84:87], a[168:171], v[88:91], a[84:87]
  buffer_load_dwordx4 v6, s[8:11], s66 offen lds
  v_mfma_f32_16x16x32_bf16 a[84:87], a[172:175], v[92:95], a[84:87]
  ds_read_b64_tr_b16 a[186:187], v3 offset:17376
  v_accvgpr_read_b32 v196, a16
  v_mfma_f32_16x16x32_bf16 a[88:91], a[168:171], v[96:99], a[88:91]
  v_accvgpr_read_b32 v197, a17
  v_accvgpr_read_b32 v198, a18
  v_mfma_f32_16x16x32_bf16 a[88:91], a[172:175], v[100:103], a[88:91]
  s_add_u32 m0, s68, 147456
  ds_read_b64_tr_b16 a[188:189], v3 offset:17632
  v_accvgpr_read_b32 v199, a19
  v_mfma_f32_16x16x32_bf16 a[92:95], a[168:171], v[104:107], a[92:95]
  buffer_load_dwordx4 v7, s[8:11], s66 offen lds
  v_mfma_f32_16x16x32_bf16 a[92:95], a[172:175], v[108:111], a[92:95]
  s_waitcnt lgkmcnt(6)
  s_waitcnt lgkmcnt(3)
  ds_read_b64_tr_b16 a[190:191], v3 offset:17888
  v_mul_f32 v192, v192, v12
  v_mfma_f32_16x16x32_bf16 a[108:111], a[176:179], v[104:107], a[108:111]
  v_mul_f32 v193, v193, v12
  v_mul_f32 v194, v194, v12
  v_mfma_f32_16x16x32_bf16 a[108:111], a[180:183], v[108:111], a[108:111]
  v_mul_f32 v195, v195, v12
  v_mul_f32 v196, v196, v12
  v_mfma_f32_16x16x32_bf16 a[104:107], a[176:179], v[96:99], a[104:107]
  s_add_u32 m0, s68, 151552
  v_mul_f32 v197, v197, v12
  v_mul_f32 v198, v198, v12
  v_mfma_f32_16x16x32_bf16 a[104:107], a[180:183], v[100:103], a[104:107]
  buffer_load_dwordx4 v8, s[8:11], s66 offen lds
  v_mfma_f32_16x16x32_bf16 a[100:103], a[176:179], v[88:91], a[100:103]
  v_mul_f32 v199, v199, v12
  v_cvt_pk_bf16_f32 v224, v192, v193
  v_mfma_f32_16x16x32_bf16 a[100:103], a[180:183], v[92:95], a[100:103]
  v_cvt_pk_bf16_f32 v225, v194, v195
  v_cvt_pk_bf16_f32 v226, v196, v197
  v_mfma_f32_16x16x32_bf16 a[96:99], a[176:179], v[80:83], a[96:99]
  v_cvt_pk_bf16_f32 v227, v198, v199
  v_mfma_f32_16x16x32_bf16 a[96:99], a[180:183], v[84:87], a[96:99]
  s_waitcnt lgkmcnt(2)
  s_waitcnt lgkmcnt(0)
  buffer_store_dwordx4 v[224:227], v1, s[8:11], s58 offen offset:0 sc1
  v_mfma_f32_16x16x32_bf16 a[112:115], a[184:187], v[80:83], a[112:115]
  s_bfe_u32 s67, 0x5040706, s62
  v_accvgpr_read_b32 v200, a4
  v_accvgpr_read_b32 v201, a5
  v_mfma_f32_16x16x32_bf16 a[112:115], a[188:191], v[84:87], a[112:115]
  s_mul_i32 s67, s67, 15360
  v_accvgpr_read_b32 v202, a6
  v_accvgpr_read_b32 v203, a7
  v_mfma_f32_16x16x32_bf16 a[116:119], a[184:187], v[88:91], a[116:119]
  s_add_u32 s66, s67, s82
  v_accvgpr_read_b32 v204, a20
  v_accvgpr_read_b32 v205, a21
  v_mfma_f32_16x16x32_bf16 a[116:119], a[188:191], v[92:95], a[116:119]
  s_add_u32 m0, s68, 155648
  v_accvgpr_read_b32 v206, a22
  v_accvgpr_read_b32 v207, a23
  v_mfma_f32_16x16x32_bf16 a[120:123], a[184:187], v[96:99], a[120:123]
  buffer_load_dwordx4 v5, s[8:11], s66 offen lds
  v_mfma_f32_16x16x32_bf16 a[120:123], a[188:191], v[100:103], a[120:123]
  v_mul_f32 v200, v200, v14
  v_mul_f32 v201, v201, v14
  v_mfma_f32_16x16x32_bf16 a[124:127], a[184:187], v[104:107], a[124:127]
  v_mul_f32 v202, v202, v14
  v_mul_f32 v203, v203, v14
  v_mfma_f32_16x16x32_bf16 a[124:127], a[188:191], v[108:111], a[124:127]
  v_mul_f32 v204, v204, v14
  v_mul_f32 v205, v205, v14
  v_mul_f32 v206, v206, v14
  v_mul_f32 v207, v207, v14
  v_cvt_pk_bf16_f32 v228, v200, v201
  v_cvt_pk_bf16_f32 v229, v202, v203
  v_cvt_pk_bf16_f32 v230, v204, v205
  v_cvt_pk_bf16_f32 v231, v206, v207
  buffer_store_dwordx4 v[228:231], v1, s[8:11], s58 offen offset:1024 sc1
  v_accvgpr_read_b32 v208, a8
  v_accvgpr_read_b32 v209, a9
  v_accvgpr_read_b32 v210, a10
  v_accvgpr_read_b32 v211, a11
  v_accvgpr_read_b32 v212, a24
  v_accvgpr_read_b32 v213, a25
  v_accvgpr_read_b32 v214, a26
  v_accvgpr_read_b32 v215, a27
  v_mul_f32 v208, v208, v16
  v_mul_f32 v209, v209, v16
  v_mul_f32 v210, v210, v16
  v_mul_f32 v211, v211, v16
  v_mul_f32 v212, v212, v16
  v_mul_f32 v213, v213, v16
  v_mul_f32 v214, v214, v16
  v_mul_f32 v215, v215, v16
  v_cvt_pk_bf16_f32 v232, v208, v209
  v_cvt_pk_bf16_f32 v233, v210, v211
  v_cvt_pk_bf16_f32 v234, v212, v213
  v_cvt_pk_bf16_f32 v235, v214, v215
  buffer_store_dwordx4 v[232:235], v1, s[8:11], s58 offen offset:2048 sc1
  v_add_u32 v3, 131072, v1
  v_accvgpr_read_b32 v216, a12
  v_accvgpr_read_b32 v217, a13
  v_accvgpr_read_b32 v218, a14
  v_accvgpr_read_b32 v219, a15
  v_accvgpr_read_b32 v220, a28
  v_accvgpr_read_b32 v221, a29
  v_accvgpr_read_b32 v222, a30
  v_accvgpr_read_b32 v223, a31
  v_pk_mul_f32 v[216:217], v[216:217], v[18:19] op_sel_hi:[1,0]
  v_pk_mul_f32 v[218:219], v[218:219], v[18:19] op_sel_hi:[1,0]
  v_pk_mul_f32 v[220:221], v[220:221], v[18:19] op_sel_hi:[1,0]
  v_pk_mul_f32 v[222:223], v[222:223], v[18:19] op_sel_hi:[1,0]
  v_cvt_pk_bf16_f32 v236, v216, v217
  v_cvt_pk_bf16_f32 v237, v218, v219
  v_cvt_pk_bf16_f32 v238, v220, v221
  v_cvt_pk_bf16_f32 v239, v222, v223
  buffer_store_dwordx4 v[236:239], v1, s[8:11], s58 offen offset:3072 sc1
  s_add_u32 s58, s58, 4096
  s_waitcnt lgkmcnt(0)
  s_barrier
  ds_read_b32 v27, v26
  ds_read_b128 a[128:131], v1 offset:33792
  ds_read_b128 a[132:135], v1 offset:39072
  ds_read_b128 a[136:139], v1 offset:44352
  ds_read_b128 a[140:143], v1 offset:34848
  ds_read_b128 a[144:147], v1 offset:40128
  ds_read_b128 a[148:151], v1 offset:45408
  v_and_b32 v122, 25, v0
  v_lshlrev_b32 v122, 7, v122
  v_add_u32 v28, s87, v1
  v_add_u32 v29, s87, v124
  v_xor_b32 v30, 745472, v28
  v_add_u32 v31, 4096, v30
  v_accvgpr_read_b32 v192, a32
  v_accvgpr_read_b32 v193, a33
  v_accvgpr_read_b32 v194, a34
  v_accvgpr_read_b32 v195, a35
  v_accvgpr_read_b32 v196, a48
  v_accvgpr_read_b32 v197, a49
  v_accvgpr_read_b32 v198, a50
  v_accvgpr_read_b32 v199, a51
  v_pk_mul_f32 v[192:193], v[192:193], v[12:13] op_sel_hi:[1,0]
  v_pk_mul_f32 v[194:195], v[194:195], v[12:13] op_sel_hi:[1,0]
  v_pk_mul_f32 v[196:197], v[196:197], v[12:13] op_sel_hi:[1,0]
  v_pk_mul_f32 v[198:199], v[198:199], v[12:13] op_sel_hi:[1,0]
  v_cvt_pk_bf16_f32 v240, v192, v193
  v_cvt_pk_bf16_f32 v241, v194, v195
  v_cvt_pk_bf16_f32 v242, v196, v197
  v_cvt_pk_bf16_f32 v243, v198, v199
  buffer_store_dwordx4 v[240:243], v1, s[8:11], s58 offen offset:0 sc1
  s_waitcnt lgkmcnt(6)
  v_cmp_ne_u32 vcc, 0, v27
  s_nop 1
  s_cbranch_vccnz L_a_redo
  s_waitcnt vmcnt(55)
  s_waitcnt lgkmcnt(5)
  v_mfma_f32_16x16x32_bf16 v[68:71], a[128:131], a[200:203], 0
  s_waitcnt lgkmcnt(4)
  ds_read_b128 a[152:155], v1 offset:35904
  v_accvgpr_read_b32 v200, a36
  v_accvgpr_read_b32 v201, a37
  s_waitcnt vmcnt(54)
  v_mfma_f32_16x16x32_bf16 v[68:71], a[132:135], a[204:207], v[68:71]
  s_waitcnt lgkmcnt(4)
  v_accvgpr_read_b32 v202, a38
  v_accvgpr_read_b32 v203, a39
  s_waitcnt vmcnt(53)
  v_mfma_f32_16x16x32_bf16 v[68:71], a[136:139], a[208:211], v[68:71]
  ds_read_b128 a[156:159], v1 offset:41184
  v_accvgpr_read_b32 v204, a52
  v_accvgpr_read_b32 v205, a53
  s_bfe_u32 s65, 0x4070605, s62
  v_accvgpr_read_b32 v206, a54
  s_waitcnt vmcnt(50)
  s_mul_i32 s65, s65, 12288
  v_mfma_f32_16x16x32_bf16 v[48:51], a[136:139], a[220:223], 0
  s_add_u32 s64, s65, s83
  v_accvgpr_read_b32 v207, a55
  buffer_load_dwordx4 a[176:179], v1, s[8:11], s64 offen sc1
  v_mfma_f32_16x16x32_bf16 v[48:51], a[132:135], a[216:219], v[48:51]
  ds_read_b128 a[160:163], v1 offset:46464
  v_mul_f32 v200, v200, v14
  v_mul_f32 v201, v201, v14
  v_mul_f32 v202, v202, v14
  v_mfma_f32_16x16x32_bf16 v[48:51], a[128:131], a[212:215], v[48:51]
  s_waitcnt lgkmcnt(5)
  v_mul_f32 v203, v203, v14
  v_mul_f32 v204, v204, v14
  v_mfma_f32_16x16x32_bf16 v[52:55], a[140:143], a[212:215], 0
  s_waitcnt lgkmcnt(4)
  ds_read_b128 a[164:167], v1 offset:36960
  v_mul_f32 v205, v205, v14
  v_mul_f32 v206, v206, v14
  v_mul_f32 v207, v207, v14
  v_mfma_f32_16x16x32_bf16 v[52:55], a[144:147], a[216:219], v[52:55]
  s_waitcnt lgkmcnt(4)
  v_cvt_pk_bf16_f32 v244, v200, v201
  v_cvt_pk_bf16_f32 v245, v202, v203
  buffer_load_dwordx4 a[180:183], v124, s[8:11], s64 offen sc1
  v_mfma_f32_16x16x32_bf16 v[52:55], a[148:151], a[220:223], v[52:55]
  ds_read_b128 a[168:171], v1 offset:42240
  v_cvt_pk_bf16_f32 v246, v204, v205
  v_cvt_pk_bf16_f32 v247, v206, v207
  buffer_store_dwordx4 v[244:247], v1, s[8:11], s58 offen offset:1024 sc1
  v_mfma_f32_16x16x32_bf16 v[72:75], a[148:151], a[208:211], 0
  v_accvgpr_read_b32 v208, a40
  v_accvgpr_read_b32 v209, a41
  v_mfma_f32_16x16x32_bf16 v[72:75], a[144:147], a[204:207], v[72:75]
  ds_read_b128 a[172:175], v1 offset:47520
  v_accvgpr_read_b32 v210, a42
  v_accvgpr_read_b32 v211, a43
  v_accvgpr_read_b32 v212, a56
  v_mfma_f32_16x16x32_bf16 v[72:75], a[140:143], a[200:203], v[72:75]
  s_waitcnt lgkmcnt(5)
  v_accvgpr_read_b32 v213, a57
  v_accvgpr_read_b32 v214, a58
  v_mfma_f32_16x16x32_bf16 v[76:79], a[152:155], a[200:203], 0
  s_waitcnt lgkmcnt(4)
  ds_read_b128 a[136:139], v1 offset:38016
  v_accvgpr_read_b32 v215, a59
  v_mul_f32 v208, v208, v16
  v_mfma_f32_16x16x32_bf16 v[76:79], a[156:159], a[204:207], v[76:79]
  s_waitcnt lgkmcnt(4)
  v_mul_f32 v209, v209, v16
  v_mul_f32 v210, v210, v16
  v_mfma_f32_16x16x32_bf16 v[76:79], a[160:163], a[208:211], v[76:79]
  ds_read_b128 a[132:135], v1 offset:43296
  v_mul_f32 v211, v211, v16
  v_mul_f32 v212, v212, v16
  v_mul_f32 v213, v213, v16
  v_mfma_f32_16x16x32_bf16 v[56:59], a[160:163], a[220:223], 0
  v_mul_f32 v214, v214, v16
  s_add_u32 s64, s64, 8192
  v_mul_f32 v215, v215, v16
  buffer_load_dwordx4 a[184:187], v1, s[8:11], s64 offen sc1
  v_mfma_f32_16x16x32_bf16 v[56:59], a[156:159], a[216:219], v[56:59]
  ds_read_b128 a[128:131], v1 offset:48576
  v_cvt_pk_bf16_f32 v248, v208, v209
  v_cvt_pk_bf16_f32 v249, v210, v211
  s_waitcnt vmcnt(50)
  v_cvt_pk_bf16_f32 v250, v212, v213
  v_mfma_f32_16x16x32_bf16 v[56:59], a[152:155], a[212:215], v[56:59]
  s_waitcnt lgkmcnt(5)
  s_barrier
  v_cvt_pk_bf16_f32 v251, v214, v215
  buffer_store_dwordx4 v[248:251], v1, s[8:11], s58 offen offset:2048 sc1
  v_mfma_f32_16x16x32_bf16 v[60:63], a[164:167], a[212:215], 0
  s_waitcnt lgkmcnt(4)
  ds_read_b128 a[148:151], v1 offset:0
  v_accvgpr_read_b32 v216, a44
  v_accvgpr_read_b32 v217, a45
  v_accvgpr_read_b32 v218, a46
  v_mfma_f32_16x16x32_bf16 v[60:63], a[168:171], a[216:219], v[60:63]
  s_waitcnt lgkmcnt(4)
  v_accvgpr_read_b32 v219, a47
  v_accvgpr_read_b32 v220, a60
  v_mfma_f32_16x16x32_bf16 v[60:63], a[172:175], a[220:223], v[60:63]
  ds_read_b128 a[144:147], v1 offset:5120
  v_accvgpr_read_b32 v221, a61
  v_accvgpr_read_b32 v222, a62
  v_mfma_f32_16x16x32_bf16 v[80:83], a[172:175], a[208:211], 0
  v_accvgpr_read_b32 v223, a63
  v_mul_f32 v216, v216, v18
  v_mfma_f32_16x16x32_bf16 v[80:83], a[168:171], a[204:207], v[80:83]
  ds_read_b128 a[140:143], v1 offset:10240
  v_mul_f32 v217, v217, v18
  v_mul_f32 v218, v218, v18
  v_mfma_f32_16x16x32_bf16 v[80:83], a[164:167], a[200:203], v[80:83]
  s_waitcnt lgkmcnt(5)
  v_mul_f32 v219, v219, v18
  v_mul_f32 v220, v220, v18
  s_add_u32 s64, s65, s85
  v_mul_f32 v221, v221, v18
  buffer_load_dwordx4 a[188:191], v1, s[8:11], s64 offen sc1
  v_mfma_f32_16x16x32_bf16 v[84:87], a[136:139], a[200:203], 0
  s_waitcnt lgkmcnt(4)
  ds_read_b128 a[160:163], v1 offset:1024
  v_mul_f32 v222, v222, v18
  v_mul_f32 v223, v223, v18
  v_mfma_f32_16x16x32_bf16 v[84:87], a[132:135], a[204:207], v[84:87]
  s_waitcnt lgkmcnt(4)
  v_cvt_pk_bf16_f32 v252, v216, v217
  v_cvt_pk_bf16_f32 v253, v218, v219
  v_cvt_pk_bf16_f32 v254, v220, v221
  v_mfma_f32_16x16x32_bf16 v[84:87], a[128:131], a[208:211], v[84:87]
  ds_read_b128 a[156:159], v1 offset:6144
  v_cvt_pk_bf16_f32 v255, v222, v223
  buffer_store_dwordx4 v[252:255], v1, s[8:11], s58 offen offset:3072 sc1
  v_mfma_f32_16x16x32_bf16 v[64:67], a[128:131], a[220:223], 0
  s_add_u32 s58, s58, 4096
  v_accvgpr_read_b32 v192, a64
  v_accvgpr_read_b32 v193, a65
  v_mfma_f32_16x16x32_bf16 v[64:67], a[132:135], a[216:219], v[64:67]
  ds_read_b128 a[152:155], v1 offset:11264
  v_accvgpr_read_b32 v194, a66
  v_accvgpr_read_b32 v195, a67
  v_mfma_f32_16x16x32_bf16 v[64:67], a[136:139], a[212:215], v[64:67]
  s_waitcnt lgkmcnt(5)
  v_accvgpr_read_b32 v196, a80
  v_accvgpr_read_b32 v197, a81
  v_accvgpr_read_b32 v198, a82
  s_waitcnt vmcnt(52)
  v_mfma_f32_16x16x32_bf16 v[68:71], a[148:151], a[224:227], v[68:71]
  s_waitcnt lgkmcnt(4)
  ds_read_b128 a[172:175], v1 offset:2048
  v_accvgpr_read_b32 v199, a83
  s_waitcnt vmcnt(51)
  v_mfma_f32_16x16x32_bf16 v[68:71], a[144:147], a[228:231], v[68:71]
  s_waitcnt lgkmcnt(4)
  v_mul_f32 v192, v192, v12
  v_mul_f32 v193, v193, v12
  v_mul_f32 v194, v194, v12
  s_waitcnt vmcnt(50)
  v_mfma_f32_16x16x32_bf16 v[68:71], a[140:143], a[232:235], v[68:71]
  ds_read_b128 a[168:171], v1 offset:7168
  v_mul_f32 v195, v195, v12
  v_mul_f32 v196, v196, v12
  s_waitcnt vmcnt(47)
  v_mfma_f32_16x16x32_bf16 v[48:51], a[140:143], a[244:247], v[48:51]
  v_mul_f32 v197, v197, v12
  v_mul_f32 v198, v198, v12
  v_mul_f32 v199, v199, v12
  v_mfma_f32_16x16x32_bf16 v[48:51], a[144:147], a[240:243], v[48:51]
  ds_read_b128 a[164:167], v1 offset:12288
  v_cvt_pk_bf16_f32 v224, v192, v193
  v_cvt_pk_bf16_f32 v225, v194, v195
  v_mfma_f32_16x16x32_bf16 v[48:51], a[148:151], a[236:239], v[48:51]
  s_waitcnt lgkmcnt(5)
  v_cvt_pk_bf16_f32 v226, v196, v197
  v_cvt_pk_bf16_f32 v227, v198, v199
  buffer_store_dwordx4 v[224:227], v1, s[8:11], s58 offen offset:0 sc1
  v_mfma_f32_16x16x32_bf16 v[52:55], a[160:163], a[236:239], v[52:55]
  s_waitcnt lgkmcnt(4)
  ds_read_b128 a[128:131], v1 offset:3072
  v_accvgpr_read_b32 v200, a68
  v_accvgpr_read_b32 v201, a69
  v_mfma_f32_16x16x32_bf16 v[52:55], a[156:159], a[240:243], v[52:55]
  s_waitcnt lgkmcnt(4)
  v_accvgpr_read_b32 v202, a70
  v_accvgpr_read_b32 v203, a71
  v_accvgpr_read_b32 v204, a84
  v_mfma_f32_16x16x32_bf16 v[52:55], a[152:155], a[244:247], v[52:55]
  ds_read_b128 a[132:135], v1 offset:8192
  v_accvgpr_read_b32 v205, a85
  v_accvgpr_read_b32 v206, a86
  v_mfma_f32_16x16x32_bf16 v[72:75], a[152:155], a[232:235], v[72:75]
  v_accvgpr_read_b32 v207, a87
  v_mfma_f32_16x16x32_bf16 v[72:75], a[156:159], a[228:231], v[72:75]
  ds_read_b128 a[136:139], v1 offset:13312
  v_mul_f32 v200, v200, v14
  v_mul_f32 v201, v201, v14
  v_mul_f32 v202, v202, v14
  v_mfma_f32_16x16x32_bf16 v[72:75], a[160:163], a[224:227], v[72:75]
  s_waitcnt lgkmcnt(5)
  v_mul_f32 v203, v203, v14
  v_mul_f32 v204, v204, v14
  v_mfma_f32_16x16x32_bf16 v[76:79], a[172:175], a[224:227], v[76:79]
  s_waitcnt lgkmcnt(4)
  ds_read_b128 a[140:143], v1 offset:4096
  v_mul_f32 v205, v205, v14
  v_mul_f32 v206, v206, v14
  v_mul_f32 v207, v207, v14
  v_mfma_f32_16x16x32_bf16 v[76:79], a[168:171], a[228:231], v[76:79]
  s_waitcnt lgkmcnt(4)
  v_cvt_pk_bf16_f32 v228, v200, v201
  v_cvt_pk_bf16_f32 v229, v202, v203
  v_mfma_f32_16x16x32_bf16 v[76:79], a[164:167], a[232:235], v[76:79]
  ds_read_b128 a[144:147], v1 offset:9216
  v_cvt_pk_bf16_f32 v230, v204, v205
  v_cvt_pk_bf16_f32 v231, v206, v207
  buffer_store_dwordx4 v[228:231], v1, s[8:11], s58 offen offset:1024 sc1
  v_mfma_f32_16x16x32_bf16 v[56:59], a[164:167], a[244:247], v[56:59]
  v_accvgpr_read_b32 v208, a72
  v_accvgpr_read_b32 v209, a73
  v_mfma_f32_16x16x32_bf16 v[56:59], a[168:171], a[240:243], v[56:59]
  ds_read_b128 a[148:151], v1 offset:14336
  v_accvgpr_read_b32 v210, a74
  v_accvgpr_read_b32 v211, a75
  s_waitcnt vmcnt(45)
  v_accvgpr_read_b32 v212, a88
  v_mfma_f32_16x16x32_bf16 v[56:59], a[172:175], a[236:239], v[56:59]
  s_waitcnt lgkmcnt(5)
  s_barrier
  v_accvgpr_read_b32 v213, a89
  v_accvgpr_read_b32 v214, a90
  v_mfma_f32_16x16x32_bf16 v[60:63], a[128:131], a[236:239], v[60:63]
  s_waitcnt lgkmcnt(4)
  ds_read_b128 a[152:155], v1 offset:53248
  v_accvgpr_read_b32 v215, a91
  v_mul_f32 v208, v208, v16
  v_mfma_f32_16x16x32_bf16 v[60:63], a[132:135], a[240:243], v[60:63]
  s_waitcnt lgkmcnt(4)
  v_mul_f32 v209, v209, v16
  v_mul_f32 v210, v210, v16
  v_mfma_f32_16x16x32_bf16 v[60:63], a[136:139], a[244:247], v[60:63]
  ds_read_b128 a[156:159], v1 offset:58368
  v_mul_f32 v211, v211, v16
  v_mul_f32 v212, v212, v16
  v_mul_f32 v213, v213, v16
  v_mfma_f32_16x16x32_bf16 v[80:83], a[136:139], a[232:235], v[80:83]
  v_mul_f32 v214, v214, v16
  v_mul_f32 v215, v215, v16
  v_mfma_f32_16x16x32_bf16 v[80:83], a[132:135], a[228:231], v[80:83]
  ds_read_b128 a[160:163], v1 offset:63488
  v_cvt_pk_bf16_f32 v232, v208, v209
  v_cvt_pk_bf16_f32 v233, v210, v211
  v_cvt_pk_bf16_f32 v234, v212, v213
  v_mfma_f32_16x16x32_bf16 v[80:83], a[128:131], a[224:227], v[80:83]
  s_waitcnt lgkmcnt(5)
  v_cvt_pk_bf16_f32 v235, v214, v215
  buffer_load_dwordx4 a[192:195], v124, s[8:11], s64 offen sc1
  buffer_store_dwordx4 v[232:235], v1, s[8:11], s58 offen offset:2048 sc1
  v_mfma_f32_16x16x32_bf16 v[84:87], a[140:143], a[224:227], v[84:87]
  s_waitcnt lgkmcnt(4)
  ds_read_b128 a[164:167], v1 offset:54272
  v_accvgpr_read_b32 v216, a76
  v_accvgpr_read_b32 v217, a77
  v_accvgpr_read_b32 v218, a78
  v_mfma_f32_16x16x32_bf16 v[84:87], a[144:147], a[228:231], v[84:87]
  s_waitcnt lgkmcnt(4)
  v_accvgpr_read_b32 v219, a79
  v_accvgpr_read_b32 v220, a92
  v_mfma_f32_16x16x32_bf16 v[84:87], a[148:151], a[232:235], v[84:87]
  ds_read_b128 a[168:171], v1 offset:59392
  v_accvgpr_read_b32 v221, a93
  v_accvgpr_read_b32 v222, a94
  v_accvgpr_read_b32 v223, a95
  v_mfma_f32_16x16x32_bf16 v[64:67], a[148:151], a[244:247], v[64:67]
  v_mul_f32 v216, v216, v18
  v_mfma_f32_16x16x32_bf16 v[64:67], a[144:147], a[240:243], v[64:67]
  ds_read_b128 a[172:175], v1 offset:64512
  v_mul_f32 v217, v217, v18
  v_mul_f32 v218, v218, v18
  v_mul_f32 v219, v219, v18
  v_mfma_f32_16x16x32_bf16 v[64:67], a[140:143], a[236:239], v[64:67]
  s_waitcnt lgkmcnt(5)
  v_mul_f32 v220, v220, v18
  v_mul_f32 v221, v221, v18
  s_waitcnt vmcnt(46)
  v_mfma_f32_16x16x32_bf16 v[68:71], a[152:155], a[248:251], v[68:71]
  s_waitcnt lgkmcnt(4)
  ds_read_b128 a[136:139], v1 offset:55296
  v_mul_f32 v222, v222, v18
  v_mul_f32 v223, v223, v18
  s_waitcnt vmcnt(45)
  v_mfma_f32_16x16x32_bf16 v[68:71], a[156:159], a[252:255], v[68:71]
  s_waitcnt lgkmcnt(4)
  v_cvt_pk_bf16_f32 v236, v216, v217
  v_cvt_pk_bf16_f32 v237, v218, v219
  v_cvt_pk_bf16_f32 v238, v220, v221
  s_waitcnt vmcnt(44)
  v_mfma_f32_16x16x32_bf16 v[68:71], a[160:163], v[128:131], v[68:71]
  ds_read_b128 a[132:135], v1 offset:60416
  v_cvt_pk_bf16_f32 v239, v222, v223
  buffer_store_dwordx4 v[236:239], v1, s[8:11], s58 offen offset:3072 sc1
  s_waitcnt vmcnt(42)
  v_mfma_f32_16x16x32_bf16 v[48:51], a[160:163], v[140:143], v[48:51]
  s_add_u32 s58, s58, 4096
  v_accvgpr_read_b32 v192, a96
  v_accvgpr_read_b32 v193, a97
  v_mfma_f32_16x16x32_bf16 v[48:51], a[156:159], v[136:139], v[48:51]
  ds_read_b128 a[128:131], v2 offset:36864
  v_accvgpr_read_b32 v194, a98
  v_accvgpr_read_b32 v195, a99
  v_mfma_f32_16x16x32_bf16 v[48:51], a[152:155], v[132:135], v[48:51]
  s_waitcnt lgkmcnt(5)
  v_accvgpr_read_b32 v196, a112
  v_accvgpr_read_b32 v197, a113
  v_accvgpr_read_b32 v198, a114
  v_mfma_f32_16x16x32_bf16 v[52:55], a[164:167], v[132:135], v[52:55]
  s_waitcnt lgkmcnt(4)
  ds_read_b128 a[148:151], v1 offset:56320
  v_accvgpr_read_b32 v199, a115
  v_mfma_f32_16x16x32_bf16 v[52:55], a[168:171], v[136:139], v[52:55]
  s_waitcnt lgkmcnt(4)
  v_mul_f32 v192, v192, v12
  v_mul_f32 v193, v193, v12
  v_mul_f32 v194, v194, v12
  v_mfma_f32_16x16x32_bf16 v[52:55], a[172:175], v[140:143], v[52:55]
  ds_read_b128 a[144:147], v1 offset:61440
  v_mul_f32 v195, v195, v12
  v_mul_f32 v196, v196, v12
  v_mfma_f32_16x16x32_bf16 v[72:75], a[172:175], v[128:131], v[72:75]
  v_mul_f32 v197, v197, v12
  v_mul_f32 v198, v198, v12
  v_mul_f32 v199, v199, v12
  v_mfma_f32_16x16x32_bf16 v[72:75], a[168:171], a[252:255], v[72:75]
  ds_read_b128 a[140:143], v2 offset:37888
  v_cvt_pk_bf16_f32 v240, v192, v193
  v_cvt_pk_bf16_f32 v241, v194, v195
  v_mfma_f32_16x16x32_bf16 v[72:75], a[164:167], a[248:251], v[72:75]
  s_waitcnt lgkmcnt(5)
  v_cvt_pk_bf16_f32 v242, v196, v197
  v_cvt_pk_bf16_f32 v243, v198, v199
  buffer_store_dwordx4 v[240:243], v1, s[8:11], s58 offen offset:0 sc1
  v_mfma_f32_16x16x32_bf16 v[76:79], a[136:139], a[248:251], v[76:79]
  s_waitcnt lgkmcnt(4)
  ds_read_b128 a[160:163], v1 offset:57344
  v_accvgpr_read_b32 v200, a100
  v_accvgpr_read_b32 v201, a101
  v_mfma_f32_16x16x32_bf16 v[76:79], a[132:135], a[252:255], v[76:79]
  s_waitcnt lgkmcnt(4)
  v_accvgpr_read_b32 v202, a102
  v_accvgpr_read_b32 v203, a103
  v_accvgpr_read_b32 v204, a116
  v_mfma_f32_16x16x32_bf16 v[76:79], a[128:131], v[128:131], v[76:79]
  ds_read_b128 a[156:159], v1 offset:62464
  v_accvgpr_read_b32 v205, a117
  v_accvgpr_read_b32 v206, a118
  v_mfma_f32_16x16x32_bf16 v[56:59], a[128:131], v[140:143], v[56:59]
  v_accvgpr_read_b32 v207, a119
  v_mul_f32 v200, v200, v14
  v_mfma_f32_16x16x32_bf16 v[56:59], a[132:135], v[136:139], v[56:59]
  ds_read_b128 a[152:155], v2 offset:38912
  v_mul_f32 v201, v201, v14
  s_waitcnt vmcnt(6)
  v_mul_f32 v202, v202, v14
  v_mfma_f32_16x16x32_bf16 v[56:59], a[136:139], v[132:135], v[56:59]
  s_waitcnt lgkmcnt(5)
  s_barrier
  v_mul_f32 v203, v203, v14
  v_mul_f32 v204, v204, v14
  v_mul_f32 v205, v205, v14
  v_mfma_f32_16x16x32_bf16 v[60:63], a[148:151], v[132:135], v[60:63]
  s_waitcnt lgkmcnt(4)
  s_lshl_b32 s59, s2, 7
  ds_read_b128 a[172:175], v2 offset:40960
  v_mul_f32 v206, v206, v14
  s_add_u32 s59, s59, 0x300000
  v_mul_f32 v207, v207, v14
  buffer_store_dword v125, v123, s[8:11], s59 offen sc1
  v_mfma_f32_16x16x32_bf16 v[60:63], a[144:147], v[136:139], v[60:63]
  s_waitcnt lgkmcnt(4)
  v_cvt_pk_bf16_f32 v244, v200, v201
  v_cvt_pk_bf16_f32 v245, v202, v203
  v_mfma_f32_16x16x32_bf16 v[60:63], a[140:143], v[140:143], v[60:63]
  ds_read_b128 a[168:171], v2 offset:46080
  v_cvt_pk_bf16_f32 v246, v204, v205
  v_cvt_pk_bf16_f32 v247, v206, v207
  buffer_store_dwordx4 v[244:247], v1, s[8:11], s58 offen offset:1024 sc1
  v_mfma_f32_16x16x32_bf16 v[80:83], a[140:143], v[128:131], v[80:83]
  v_accvgpr_read_b32 v208, a104
  v_accvgpr_read_b32 v209, a105
  v_mfma_f32_16x16x32_bf16 v[80:83], a[144:147], a[252:255], v[80:83]
  ds_read_b128 a[164:167], v2 offset:51200
  v_accvgpr_read_b32 v210, a106
  v_accvgpr_read_b32 v211, a107
  v_accvgpr_read_b32 v212, a120
  v_mfma_f32_16x16x32_bf16 v[80:83], a[148:151], a[248:251], v[80:83]
  s_waitcnt lgkmcnt(5)
  v_accvgpr_read_b32 v213, a121
  v_accvgpr_read_b32 v214, a122
  v_mfma_f32_16x16x32_bf16 v[84:87], a[160:163], a[248:251], v[84:87]
  s_waitcnt lgkmcnt(4)
  ds_read_b128 a[128:131], v2 offset:41984
  v_accvgpr_read_b32 v215, a123
  v_mul_f32 v208, v208, v16
  v_mfma_f32_16x16x32_bf16 v[84:87], a[156:159], a[252:255], v[84:87]
  s_waitcnt lgkmcnt(4)
  v_mul_f32 v209, v209, v16
  v_mul_f32 v210, v210, v16
  v_mfma_f32_16x16x32_bf16 v[84:87], a[152:155], v[128:131], v[84:87]
  ds_read_b128 a[132:135], v2 offset:47104
  v_mul_f32 v211, v211, v16
  v_mul_f32 v212, v212, v16
  v_mul_f32 v213, v213, v16
  v_mfma_f32_16x16x32_bf16 v[64:67], a[152:155], v[140:143], v[64:67]
  v_mul_f32 v214, v214, v16
  v_mul_f32 v215, v215, v16
  v_mfma_f32_16x16x32_bf16 v[64:67], a[156:159], v[136:139], v[64:67]
  ds_read_b128 a[136:139], v2 offset:52224
  v_cvt_pk_bf16_f32 v248, v208, v209
  v_cvt_pk_bf16_f32 v249, v210, v211
  v_cvt_pk_bf16_f32 v250, v212, v213
  v_mfma_f32_16x16x32_bf16 v[64:67], a[160:163], v[132:135], v[64:67]
  s_waitcnt lgkmcnt(5)
  v_cvt_pk_bf16_f32 v251, v214, v215
  buffer_store_dwordx4 v[248:251], v1, s[8:11], s58 offen offset:2048 sc1
  v_mfma_f32_16x16x32_bf16 v[68:71], a[172:175], v[144:147], v[68:71]
  s_waitcnt lgkmcnt(4)
  ds_read_b128 a[140:143], v2 offset:43008
  v_accvgpr_read_b32 v216, a108
  v_accvgpr_read_b32 v217, a109
  v_accvgpr_read_b32 v218, a110
  v_mfma_f32_16x16x32_bf16 v[68:71], a[168:171], v[148:151], v[68:71]
  s_waitcnt lgkmcnt(4)
  v_accvgpr_read_b32 v219, a111
  v_accvgpr_read_b32 v220, a124
  v_mfma_f32_16x16x32_bf16 v[68:71], a[164:167], v[152:155], v[68:71]
  ds_read_b128 a[144:147], v2 offset:48128
  v_accvgpr_read_b32 v221, a125
  v_accvgpr_read_b32 v222, a126
  v_accvgpr_read_b32 v223, a127
  v_mfma_f32_16x16x32_bf16 v[48:51], a[164:167], v[164:167], v[48:51]
  v_mul_f32 v216, v216, v18
  v_mfma_f32_16x16x32_bf16 v[48:51], a[168:171], v[160:163], v[48:51]
  ds_read_b128 a[148:151], v2 offset:53248
  v_mul_f32 v217, v217, v18
  v_mul_f32 v218, v218, v18
  v_mul_f32 v219, v219, v18
  v_mfma_f32_16x16x32_bf16 v[48:51], a[172:175], v[156:159], v[48:51]
  s_waitcnt lgkmcnt(5)
  v_mul_f32 v220, v220, v18
  v_mul_f32 v221, v221, v18
  v_mfma_f32_16x16x32_bf16 v[52:55], a[128:131], v[156:159], v[52:55]
  s_waitcnt lgkmcnt(4)
  ds_read_b128 a[152:155], v2 offset:44032
  v_mul_f32 v222, v222, v18
  v_mul_f32 v223, v223, v18
  v_cvt_pk_bf16_f32 v252, v216, v217
  v_mfma_f32_16x16x32_bf16 v[52:55], a[132:135], v[160:163], v[52:55]
  s_waitcnt lgkmcnt(4)
  v_cvt_pk_bf16_f32 v253, v218, v219
  v_cvt_pk_bf16_f32 v254, v220, v221
  v_mfma_f32_16x16x32_bf16 v[52:55], a[136:139], v[164:167], v[52:55]
  ds_read_b128 a[156:159], v2 offset:49152
  v_cvt_pk_bf16_f32 v255, v222, v223
  buffer_store_dwordx4 v[252:255], v1, s[8:11], s58 offen offset:3072 sc1
  s_add_u32 s58, s58, 4096
  v_mfma_f32_16x16x32_bf16 v[72:75], a[136:139], v[152:155], v[72:75]
  v_mov_b32 v117, 0
  v_and_b32 v16, 15, v0
  v_mfma_f32_16x16x32_bf16 v[72:75], a[132:135], v[148:151], v[72:75]
  ds_read_b128 a[160:163], v2 offset:54272
  v_mul_u32_u24 v15, 1280, v16
  v_bfe_u32 v16, v0, 4, 2
  v_mfma_f32_16x16x32_bf16 v[72:75], a[128:131], v[144:147], v[72:75]
  s_waitcnt lgkmcnt(5)
  v_lshl_add_u32 v15, v16, 3, v15
  v_mov_b32 v17, s96
  v_mfma_f32_16x16x32_bf16 v[76:79], a[140:143], v[144:147], v[76:79]
  s_waitcnt lgkmcnt(4)
  ds_read_b128 a[164:167], v2 offset:45056
  v_and_b32 v17, 1, v17
  v_lshl_add_u32 v16, v17, 2, v16
  v_mfma_f32_16x16x32_bf16 v[76:79], a[144:147], v[148:151], v[76:79]
  s_waitcnt lgkmcnt(4)
  s_add_u32 s64, s64, 8192
  v_xor_b32 v17, 1, v17
  v_lshl_add_u32 v11, v17, 7, v15
  v_mfma_f32_16x16x32_bf16 v[76:79], a[148:151], v[152:155], v[76:79]
  ds_read_b128 a[168:171], v2 offset:50176
  buffer_load_dwordx4 a[196:199], v1, s[8:11], s64 offen sc1
  v_lshl_add_u32 v15, v16, 3, v15
  v_and_b32 v10, 6, v0
  v_mfma_f32_16x16x32_bf16 v[56:59], a[148:151], v[164:167], v[56:59]
  v_lshlrev_b32 v10, 7, v10
  v_mfma_f32_16x16x32_bf16 v[56:59], a[144:147], v[160:163], v[56:59]
  ds_read_b128 a[172:175], v2 offset:55296
  v_mfma_f32_16x16x32_bf16 v[56:59], a[140:143], v[156:159], v[56:59]
  s_waitcnt lgkmcnt(5)
  s_barrier
  v_mfma_f32_16x16x32_bf16 v[60:63], a[152:155], v[156:159], v[60:63]
  s_waitcnt lgkmcnt(4)
  ds_read_b128 a[136:139], v2 offset:57344
  v_mfma_f32_16x16x32_bf16 v[60:63], a[156:159], v[160:163], v[60:63]
  s_waitcnt lgkmcnt(4)
  v_mfma_f32_16x16x32_bf16 v[60:63], a[160:163], v[164:167], v[60:63]
  s_add_u32 m0, s68, 159744
  ds_read_b128 a[132:135], v2 offset:62464
  v_mfma_f32_16x16x32_bf16 v[80:83], a[160:163], v[152:155], v[80:83]
  buffer_load_dwordx4 v6, s[8:11], s66 offen lds
  v_mfma_f32_16x16x32_bf16 v[80:83], a[156:159], v[148:151], v[80:83]
  ds_read_b128 a[128:131], v3 offset:2048
  v_mfma_f32_16x16x32_bf16 v[80:83], a[152:155], v[144:147], v[80:83]
  s_waitcnt lgkmcnt(5)
  v_mfma_f32_16x16x32_bf16 v[84:87], a[164:167], v[144:147], v[84:87]
  s_waitcnt lgkmcnt(4)
  ds_read_b128 a[148:151], v2 offset:58368
  v_mfma_f32_16x16x32_bf16 v[84:87], a[168:171], v[148:151], v[84:87]
  s_waitcnt lgkmcnt(4)
  v_mfma_f32_16x16x32_bf16 v[84:87], a[172:175], v[152:155], v[84:87]
  ds_read_b128 a[144:147], v2 offset:63488
  v_mfma_f32_16x16x32_bf16 v[64:67], a[172:175], v[164:167], v[64:67]
  v_mfma_f32_16x16x32_bf16 v[64:67], a[168:171], v[160:163], v[64:67]
  s_add_u32 m0, s68, 16384
  ds_read_b128 a[140:143], v3 offset:3072
  v_mfma_f32_16x16x32_bf16 v[64:67], a[164:167], v[156:159], v[64:67]
  s_waitcnt lgkmcnt(5)
  buffer_load_dwordx4 v7, s[8:11], s66 offen lds
  v_mfma_f32_16x16x32_bf16 v[68:71], a[136:139], v[168:171], v[68:71]
  s_waitcnt lgkmcnt(4)
  ds_read_b128 a[160:163], v2 offset:59392
  v_mfma_f32_16x16x32_bf16 v[68:71], a[132:135], v[172:175], v[68:71]
  s_waitcnt lgkmcnt(4)
  v_mfma_f32_16x16x32_bf16 v[68:71], a[128:131], v[176:179], v[68:71]
  ds_read_b128 a[156:159], v2 offset:64512
  v_mfma_f32_16x16x32_bf16 v[48:51], a[128:131], v[188:191], v[48:51]
  v_mfma_f32_16x16x32_bf16 v[48:51], a[132:135], v[184:187], v[48:51]
  ds_read_b128 a[152:155], v3 offset:4096
  v_mfma_f32_16x16x32_bf16 v[48:51], a[136:139], v[180:183], v[48:51]
  s_waitcnt lgkmcnt(5)
  s_add_u32 m0, s68, 20480
  v_mfma_f32_16x16x32_bf16 v[52:55], a[148:151], v[180:183], v[52:55]
  s_waitcnt lgkmcnt(4)
  ds_read_b128 a[172:175], v2 offset:60416
  buffer_load_dwordx4 v8, s[8:11], s66 offen lds
  v_mfma_f32_16x16x32_bf16 v[52:55], a[144:147], v[184:187], v[52:55]
  s_waitcnt lgkmcnt(4)
  s_bfe_u32 s65, 0x5040706, s62
  v_mfma_f32_16x16x32_bf16 v[52:55], a[140:143], v[188:191], v[52:55]
  s_mul_i32 s65, s65, 12288
  ds_read_b128 a[168:171], v3 offset:0
  v_mfma_f32_16x16x32_bf16 v[72:75], a[140:143], v[176:179], v[72:75]
  s_add_u32 s64, s65, s83
  v_mfma_f32_16x16x32_bf16 v[72:75], a[144:147], v[172:175], v[72:75]
  ds_read_b128 a[164:167], v3 offset:5120
  buffer_load_dwordx4 a[0:3], v1, s[8:11], s64 offen sc1
  v_mfma_f32_16x16x32_bf16 v[72:75], a[148:151], v[168:171], v[72:75]
  s_waitcnt lgkmcnt(5)
  v_mfma_f32_16x16x32_bf16 v[76:79], a[160:163], v[168:171], v[76:79]
  s_waitcnt lgkmcnt(4)
  ds_read_b128 a[128:131], v2 offset:61440
  v_mfma_f32_16x16x32_bf16 v[76:79], a[156:159], v[172:175], v[76:79]
  s_waitcnt lgkmcnt(4)
  v_mfma_f32_16x16x32_bf16 v[76:79], a[152:155], v[176:179], v[76:79]
  ds_read_b128 a[132:135], v3 offset:1024
  v_mfma_f32_16x16x32_bf16 v[56:59], a[152:155], v[188:191], v[56:59]
  v_mfma_f32_16x16x32_bf16 v[56:59], a[156:159], v[184:187], v[56:59]
  ds_read_b128 a[136:139], v3 offset:6144
  v_mfma_f32_16x16x32_bf16 v[56:59], a[160:163], v[180:183], v[56:59]
  s_waitcnt lgkmcnt(5)
  s_barrier
  v_mfma_f32_16x16x32_bf16 v[60:63], a[172:175], v[180:183], v[60:63]
  s_waitcnt lgkmcnt(4)
  ds_read_b128 a[140:143], v3 offset:8192
  buffer_load_dwordx4 a[16:19], v124, s[8:11], s64 offen sc1
  v_mfma_f32_16x16x32_bf16 v[60:63], a[168:171], v[184:187], v[60:63]
  s_waitcnt lgkmcnt(4)
  v_mfma_f32_16x16x32_bf16 v[60:63], a[164:167], v[188:191], v[60:63]
  ds_read_b128 a[144:147], v3 offset:13312
  v_mfma_f32_16x16x32_bf16 v[80:83], a[164:167], v[176:179], v[80:83]
  v_mfma_f32_16x16x32_bf16 v[80:83], a[168:171], v[172:175], v[80:83]
  ds_read_b128 a[148:151], v3 offset:18432
  v_mfma_f32_16x16x32_bf16 v[80:83], a[172:175], v[168:171], v[80:83]
  s_waitcnt lgkmcnt(5)
  v_mfma_f32_16x16x32_bf16 v[84:87], a[128:131], v[168:171], v[84:87]
  s_waitcnt lgkmcnt(4)
  s_add_u32 s64, s64, 8192
  ds_read_b128 a[152:155], v3 offset:9216
  v_mfma_f32_16x16x32_bf16 v[84:87], a[132:135], v[172:175], v[84:87]
  s_waitcnt lgkmcnt(4)
  buffer_load_dwordx4 a[4:7], v1, s[8:11], s64 offen sc1
  v_mfma_f32_16x16x32_bf16 v[84:87], a[136:139], v[176:179], v[84:87]
  ds_read_b128 a[156:159], v3 offset:14336
  v_mfma_f32_16x16x32_bf16 v[64:67], a[136:139], v[188:191], v[64:67]
  s_add_u32 s64, s65, s85
  v_mfma_f32_16x16x32_bf16 v[64:67], a[132:135], v[184:187], v[64:67]
  ds_read_b128 a[160:163], v3 offset:19456
  buffer_load_dwordx4 a[20:23], v1, s[8:11], s64 offen sc1
  v_mfma_f32_16x16x32_bf16 v[64:67], a[128:131], v[180:183], v[64:67]
  s_waitcnt lgkmcnt(5)
  buffer_load_dwordx4 a[8:11], v124, s[8:11], s64 offen sc1
  v_mfma_f32_16x16x32_bf16 v[68:71], a[140:143], a[176:179], v[68:71]
  s_waitcnt lgkmcnt(4)
  s_add_u32 s64, s64, 8192
  ds_read_b128 a[164:167], v3 offset:10240
  buffer_load_dwordx4 a[24:27], v1, s[8:11], s64 offen sc1
  v_mfma_f32_16x16x32_bf16 v[68:71], a[144:147], a[180:183], v[68:71]
  s_waitcnt lgkmcnt(4)
  s_bfe_u32 s67, 0x6050407, s62
  s_mul_i32 s67, s67, 15360
  s_add_u32 s66, s67, s82
  s_add_u32 m0, s68, 24576
  v_mfma_f32_16x16x32_bf16 v[68:71], a[148:151], a[184:187], v[68:71]
  s_waitcnt vmcnt(9)
  ds_read_b128 a[168:171], v3 offset:15360
  buffer_load_dwordx4 v5, s[8:11], s66 offen lds
  v_mfma_f32_16x16x32_bf16 v[48:51], a[148:151], a[196:199], v[48:51]
  s_add_u32 m0, s68, 28672
  s_nop 0
  buffer_load_dwordx4 v6, s[8:11], s66 offen lds
  v_mfma_f32_16x16x32_bf16 v[48:51], a[144:147], a[192:195], v[48:51]
  s_add_u32 m0, s68, 65536
  ds_read_b128 a[172:175], v3 offset:20480
  buffer_load_dwordx4 v7, s[8:11], s66 offen lds
  v_mfma_f32_16x16x32_bf16 v[48:51], a[140:143], a[188:191], v[48:51]
  s_waitcnt lgkmcnt(5)
  s_add_u32 m0, s68, 69632
  v_mfma_f32_16x16x32_bf16 v[52:55], a[152:155], a[188:191], v[52:55]
  s_waitcnt lgkmcnt(4)
  ds_read_b128 a[136:139], v3 offset:11264
  buffer_load_dwordx4 v8, s[8:11], s66 offen lds
  v_mfma_f32_16x16x32_bf16 v[52:55], a[156:159], a[192:195], v[52:55]
  s_waitcnt lgkmcnt(4)
  s_bfe_u32 s65, 0x6050407, s62
  s_mul_i32 s65, s65, 12288
  v_mfma_f32_16x16x32_bf16 v[52:55], a[160:163], a[196:199], v[52:55]
  s_add_u32 s64, s65, s83
  ds_read_b128 a[132:135], v3 offset:16384
  v_mfma_f32_16x16x32_bf16 v[72:75], a[160:163], a[184:187], v[72:75]
  buffer_load_dwordx4 a[12:15], v1, s[8:11], s64 offen sc1
  v_mfma_f32_16x16x32_bf16 v[72:75], a[156:159], a[180:183], v[72:75]
  ds_read_b128 a[128:131], v3 offset:21504
  v_mfma_f32_16x16x32_bf16 v[72:75], a[152:155], a[176:179], v[72:75]
  s_waitcnt lgkmcnt(5)
  v_mfma_f32_16x16x32_bf16 v[76:79], a[164:167], a[176:179], v[76:79]
  s_waitcnt lgkmcnt(4)
  ds_read_b128 a[148:151], v3 offset:12288
  v_mfma_f32_16x16x32_bf16 v[76:79], a[168:171], a[180:183], v[76:79]
  s_waitcnt lgkmcnt(4)
  buffer_load_dwordx4 a[28:31], v124, s[8:11], s64 offen sc1
  v_mfma_f32_16x16x32_bf16 v[76:79], a[172:175], a[184:187], v[76:79]
  ds_read_b128 a[144:147], v3 offset:17408
  v_mfma_f32_16x16x32_bf16 v[56:59], a[172:175], a[196:199], v[56:59]
  s_waitcnt vmcnt(12)
  s_add_u32 s64, s64, 8192
  v_mfma_f32_16x16x32_bf16 v[56:59], a[168:171], a[192:195], v[56:59]
  ds_read_b128 a[140:143], v3 offset:22528
  buffer_load_dwordx4 a[32:35], v1, s[8:11], s64 offen sc1
  v_mfma_f32_16x16x32_bf16 v[56:59], a[164:167], a[188:191], v[56:59]
  s_waitcnt lgkmcnt(5)
  s_barrier
  v_mfma_f32_16x16x32_bf16 v[60:63], a[136:139], a[188:191], v[60:63]
  s_waitcnt lgkmcnt(4)
  s_lshl_b32 s59, s2, 7
  ds_read_b128 a[160:163], v3 offset:24576
  v_mfma_f32_16x16x32_bf16 v[60:63], a[132:135], a[192:195], v[60:63]
  s_waitcnt lgkmcnt(4)
  s_add_u32 s59, s59, 0x310000
  v_mfma_f32_16x16x32_bf16 v[60:63], a[128:131], a[196:199], v[60:63]
  ds_read_b128 a[156:159], v3 offset:29696
  buffer_store_dword v125, v123, s[8:11], s59 offen sc1
  v_mfma_f32_16x16x32_bf16 v[80:83], a[128:131], a[184:187], v[80:83]
  v_mfma_f32_16x16x32_bf16 v[80:83], a[132:135], a[180:183], v[80:83]
  s_add_u32 s64, s65, s85
  ds_read_b128 a[152:155], v1 offset:18432
  v_mfma_f32_16x16x32_bf16 v[80:83], a[136:139], a[176:179], v[80:83]
  s_waitcnt lgkmcnt(5)
  buffer_load_dwordx4 a[48:51], v1, s[8:11], s64 offen sc1
  v_mfma_f32_16x16x32_bf16 v[84:87], a[148:151], a[176:179], v[84:87]
  s_waitcnt lgkmcnt(4)
  ds_read_b128 a[172:175], v3 offset:25600
  v_mfma_f32_16x16x32_bf16 v[84:87], a[144:147], a[180:183], v[84:87]
  s_waitcnt lgkmcnt(4)
  v_mfma_f32_16x16x32_bf16 v[84:87], a[140:143], a[184:187], v[84:87]
  ds_read_b128 a[168:171], v3 offset:30720
  v_mfma_f32_16x16x32_bf16 v[64:67], a[140:143], a[196:199], v[64:67]
  buffer_load_dwordx4 a[36:39], v124, s[8:11], s64 offen sc1
  v_mfma_f32_16x16x32_bf16 v[64:67], a[144:147], a[192:195], v[64:67]
  s_add_u32 s64, s64, 8192
  ds_read_b128 a[164:167], v1 offset:19456
  buffer_load_dwordx4 a[52:55], v1, s[8:11], s64 offen sc1
  v_mfma_f32_16x16x32_bf16 v[64:67], a[148:151], a[188:191], v[64:67]
  s_waitcnt lgkmcnt(5)
  s_waitcnt vmcnt(16)
  s_bfe_u32 s67, 0x8080808, s62
  s_mul_i32 s67, s67, 15360
  v_mfma_f32_16x16x32_bf16 v[68:71], a[160:163], a[0:3], v[68:71]
  s_waitcnt lgkmcnt(4)
  s_waitcnt vmcnt(15)
  s_add_u32 s66, s67, s82
  ds_read_b128 a[128:131], v3 offset:26624
  v_mfma_f32_16x16x32_bf16 v[68:71], a[156:159], a[16:19], v[68:71]
  s_waitcnt lgkmcnt(4)
  s_waitcnt vmcnt(14)
  s_add_u32 m0, s68, 73728
  v_mfma_f32_16x16x32_bf16 v[68:71], a[152:155], a[4:7], v[68:71]
  s_waitcnt vmcnt(11)
  ds_read_b128 a[132:135], v3 offset:31744
  buffer_load_dwordx4 v5, s[8:11], s66 offen lds
  v_mfma_f32_16x16x32_bf16 v[48:51], a[152:155], a[24:27], v[48:51]
  v_mfma_f32_16x16x32_bf16 v[48:51], a[156:159], a[8:11], v[48:51]
  s_add_u32 m0, s68, 77824
  ds_read_b128 a[136:139], v1 offset:20480
  v_mfma_f32_16x16x32_bf16 v[48:51], a[160:163], a[20:23], v[48:51]
  s_waitcnt lgkmcnt(5)
  buffer_load_dwordx4 v6, s[8:11], s66 offen lds
  v_mfma_f32_16x16x32_bf16 v[52:55], a[172:175], a[20:23], v[52:55]
  s_waitcnt lgkmcnt(4)
  ds_read_b128 a[140:143], v3 offset:27648
  v_mfma_f32_16x16x32_bf16 v[52:55], a[168:171], a[8:11], v[52:55]
  s_waitcnt lgkmcnt(4)
  v_mfma_f32_16x16x32_bf16 v[52:55], a[164:167], a[24:27], v[52:55]
  s_add_u32 m0, s68, 86016
  ds_read_b128 a[144:147], v1 offset:16384
  v_mfma_f32_16x16x32_bf16 v[72:75], a[164:167], a[4:7], v[72:75]
  buffer_load_dwordx4 v7, s[8:11], s66 offen lds
  v_mfma_f32_16x16x32_bf16 v[72:75], a[168:171], a[16:19], v[72:75]
  ds_read_b128 a[148:151], v1 offset:21504
  v_mfma_f32_16x16x32_bf16 v[72:75], a[172:175], a[0:3], v[72:75]
  s_waitcnt lgkmcnt(5)
  s_add_u32 m0, s68, 90112
  v_mfma_f32_16x16x32_bf16 v[76:79], a[128:131], a[0:3], v[76:79]
  s_waitcnt lgkmcnt(4)
  ds_read_b128 a[152:155], v3 offset:28672
  buffer_load_dwordx4 v8, s[8:11], s66 offen lds
  v_mfma_f32_16x16x32_bf16 v[76:79], a[132:135], a[16:19], v[76:79]
  s_waitcnt lgkmcnt(4)
  s_bfe_u32 s65, 0x8080808, s62
  s_mul_i32 s65, s65, 12288
  v_mfma_f32_16x16x32_bf16 v[76:79], a[136:139], a[4:7], v[76:79]
  s_add_u32 s64, s65, s83
  ds_read_b128 a[156:159], v1 offset:17408
  v_mfma_f32_16x16x32_bf16 v[56:59], a[136:139], a[24:27], v[56:59]
  s_waitcnt vmcnt(11)
  buffer_load_dwordx4 a[40:43], v1, s[8:11], s64 offen sc1
  v_mfma_f32_16x16x32_bf16 v[56:59], a[132:135], a[8:11], v[56:59]
  ds_read_b128 a[160:163], v1 offset:22528
  v_mfma_f32_16x16x32_bf16 v[56:59], a[128:131], a[20:23], v[56:59]
  s_waitcnt lgkmcnt(5)
  s_barrier
  v_mfma_f32_16x16x32_bf16 v[60:63], a[140:143], a[20:23], v[60:63]
  s_waitcnt lgkmcnt(4)
  s_and_b32 s61, s2, 230
  s_lshl_b32 s61, s61, 7
  s_add_u32 s61, s61, 0x300000
  ds_read_b128 a[164:167], v1 offset:24576
  v_mfma_f32_16x16x32_bf16 v[60:63], a[144:147], a[8:11], v[60:63]
  s_waitcnt lgkmcnt(4)
  buffer_load_dword v126, v122, s[8:11], s61 offen sc1
  v_mfma_f32_16x16x32_bf16 v[60:63], a[148:151], a[24:27], v[60:63]
  ds_read_b128 a[168:171], v1 offset:29696
  v_mfma_f32_16x16x32_bf16 v[80:83], a[148:151], a[4:7], v[80:83]
  v_mfma_f32_16x16x32_bf16 v[80:83], a[144:147], a[16:19], v[80:83]
  ds_read_b128 a[172:175], v2 offset:2048
  buffer_load_dwordx4 a[56:59], v124, s[8:11], s64 offen sc1
  v_mfma_f32_16x16x32_bf16 v[80:83], a[140:143], a[0:3], v[80:83]
  s_waitcnt lgkmcnt(5)
  v_mfma_f32_16x16x32_bf16 v[84:87], a[152:155], a[0:3], v[84:87]
  s_waitcnt lgkmcnt(4)
  ds_read_b128 a[136:139], v1 offset:25600
  v_mfma_f32_16x16x32_bf16 v[84:87], a[156:159], a[16:19], v[84:87]
  s_waitcnt lgkmcnt(4)
  s_add_u32 s64, s64, 8192
  v_mfma_f32_16x16x32_bf16 v[84:87], a[160:163], a[4:7], v[84:87]
  ds_read_b128 a[132:135], v1 offset:30720
  buffer_load_dwordx4 a[44:47], v1, s[8:11], s64 offen sc1
  v_mfma_f32_16x16x32_bf16 v[64:67], a[160:163], a[24:27], v[64:67]
  s_add_u32 s64, s65, s85
  v_mfma_f32_16x16x32_bf16 v[64:67], a[156:159], a[8:11], v[64:67]
  ds_read_b128 a[128:131], v2 offset:3072
  buffer_load_dwordx4 a[60:63], v1, s[8:11], s64 offen sc1
  v_mfma_f32_16x16x32_bf16 v[64:67], a[152:155], a[20:23], v[64:67]
  s_waitcnt lgkmcnt(5)
  s_waitcnt vmcnt(15)
  buffer_load_dwordx4 a[200:203], v124, s[8:11], s64 offen sc1
  v_mfma_f32_16x16x32_bf16 v[68:71], a[164:167], a[12:15], v[68:71]
  s_waitcnt lgkmcnt(4)
  s_waitcnt vmcnt(15)
  s_add_u32 s64, s64, 8192
  ds_read_b128 a[148:151], v1 offset:26624
  buffer_load_dwordx4 a[204:207], v1, s[8:11], s64 offen sc1
  v_mfma_f32_16x16x32_bf16 v[68:71], a[168:171], a[28:31], v[68:71]
  s_waitcnt lgkmcnt(4)
  s_waitcnt vmcnt(15)
  s_bfe_u32 s67, 0x6040200, s62
  s_mul_i32 s67, s67, 20480
  s_add_u32 s66, s67, s81
  s_add_u32 m0, s68, 94208
  s_nop 0
  buffer_load_dwordx4 v112, s[8:11], s66 offen lds
  v_mfma_f32_16x16x32_bf16 v[68:71], a[172:175], a[32:35], v[68:71]
  s_waitcnt vmcnt(12)
  s_add_u32 m0, s68, 98304
  ds_read_b128 a[144:147], v1 offset:31744
  buffer_load_dwordx4 v113, s[8:11], s66 offen lds
  v_mfma_f32_16x16x32_bf16 v[48:51], a[172:175], a[52:55], v[48:51]
  s_add_u32 m0, s68, 81920
  s_nop 0
  buffer_load_dwordx4 v114, s[8:11], s66 offen lds
  v_mfma_f32_16x16x32_bf16 v[48:51], a[168:171], a[36:39], v[48:51]
  s_add_u32 m0, s68, 32768
  ds_read_b128 a[140:143], v2 offset:4096
  buffer_load_dwordx4 v115, s[8:11], s66 offen lds
  v_mfma_f32_16x16x32_bf16 v[48:51], a[164:167], a[48:51], v[48:51]
  s_waitcnt lgkmcnt(5)
  s_add_u32 m0, s68, 36864
  s_nop 0
  buffer_load_dwordx4 v116, s[8:11], s66 offen lds
  v_mfma_f32_16x16x32_bf16 v[52:55], a[136:139], a[48:51], v[52:55]
  s_waitcnt lgkmcnt(4)
  s_bfe_u32 s67, 0x60402, s62
  s_mul_i32 s67, s67, 20480
  ds_read_b128 a[160:163], v1 offset:27648
  v_mfma_f32_16x16x32_bf16 v[52:55], a[132:135], a[36:39], v[52:55]
  s_waitcnt lgkmcnt(4)
  s_add_u32 s66, s67, s81
  v_mfma_f32_16x16x32_bf16 v[52:55], a[128:131], a[52:55], v[52:55]
  s_add_u32 m0, s68, 40960
  ds_read_b128 a[156:159], v2 offset:0
  v_mfma_f32_16x16x32_bf16 v[72:75], a[128:131], a[32:35], v[72:75]
  buffer_load_dwordx4 v112, s[8:11], s66 offen lds
  v_mfma_f32_16x16x32_bf16 v[72:75], a[132:135], a[28:31], v[72:75]
  ds_read_b128 a[152:155], v2 offset:5120
  v_mfma_f32_16x16x32_bf16 v[72:75], a[136:139], a[12:15], v[72:75]
  s_waitcnt lgkmcnt(5)
  s_add_u32 m0, s68, 45056
  v_mfma_f32_16x16x32_bf16 v[76:79], a[148:151], a[12:15], v[76:79]
  s_waitcnt lgkmcnt(4)
  ds_read_b128 a[172:175], v1 offset:28672
  buffer_load_dwordx4 v113, s[8:11], s66 offen lds
  v_mfma_f32_16x16x32_bf16 v[76:79], a[144:147], a[28:31], v[76:79]
  s_waitcnt lgkmcnt(4)
  v_mfma_f32_16x16x32_bf16 v[76:79], a[140:143], a[32:35], v[76:79]
  ds_read_b128 a[168:171], v2 offset:1024
  v_mfma_f32_16x16x32_bf16 v[56:59], a[140:143], a[52:55], v[56:59]
  s_waitcnt vmcnt(14)
  s_add_u32 m0, s68, 49152
  v_mfma_f32_16x16x32_bf16 v[56:59], a[144:147], a[36:39], v[56:59]
  ds_read_b128 a[164:167], v2 offset:6144
  buffer_load_dwordx4 v114, s[8:11], s66 offen lds
  v_mfma_f32_16x16x32_bf16 v[56:59], a[148:151], a[48:51], v[56:59]
  s_waitcnt lgkmcnt(5)
  s_barrier
  v_mfma_f32_16x16x32_bf16 v[60:63], a[160:163], a[48:51], v[60:63]
  s_waitcnt lgkmcnt(4)
  s_add_u32 m0, s68, 0
  ds_read_b128 a[128:131], v2 offset:8192
  v_mfma_f32_16x16x32_bf16 v[60:63], a[156:159], a[36:39], v[60:63]
  s_waitcnt lgkmcnt(4)
  buffer_load_dwordx4 v115, s[8:11], s66 offen lds
  v_mfma_f32_16x16x32_bf16 v[60:63], a[152:155], a[52:55], v[60:63]
  ds_read_b128 a[132:135], v2 offset:13312
  v_mfma_f32_16x16x32_bf16 v[80:83], a[152:155], a[32:35], v[80:83]
  v_mfma_f32_16x16x32_bf16 v[80:83], a[156:159], a[28:31], v[80:83]
  s_add_u32 m0, s68, 4096
  ds_read_b128 a[136:139], v2 offset:22528
  v_mfma_f32_16x16x32_bf16 v[80:83], a[160:163], a[12:15], v[80:83]
  s_waitcnt lgkmcnt(5)
  buffer_load_dwordx4 v116, s[8:11], s66 offen lds
  v_mfma_f32_16x16x32_bf16 v[84:87], a[172:175], a[12:15], v[84:87]
  s_waitcnt lgkmcnt(4)
  s_bfe_u32 s67, 0x2000604, s62
  s_mul_i32 s67, s67, 20480
  s_add_u32 s66, s67, s81
  ds_read_b128 a[140:143], v2 offset:9216
  v_mfma_f32_16x16x32_bf16 v[84:87], a[168:171], a[28:31], v[84:87]
  s_waitcnt lgkmcnt(4)
  s_add_u32 m0, s68, 8192
  v_mfma_f32_16x16x32_bf16 v[84:87], a[164:167], a[32:35], v[84:87]
  ds_read_b128 a[144:147], v2 offset:14336
  buffer_load_dwordx4 v112, s[8:11], s66 offen lds
  v_mfma_f32_16x16x32_bf16 v[64:67], a[164:167], a[52:55], v[64:67]
  v_mfma_f32_16x16x32_bf16 v[64:67], a[168:171], a[36:39], v[64:67]
  ds_read_b128 a[148:151], v2 offset:23552
  v_mfma_f32_16x16x32_bf16 v[64:67], a[172:175], a[48:51], v[64:67]
  s_waitcnt lgkmcnt(5)
  s_waitcnt vmcnt(17)
  s_add_u32 m0, s68, 12288
  v_mfma_f32_16x16x32_bf16 v[68:71], a[128:131], a[40:43], v[68:71]
  s_waitcnt lgkmcnt(4)
  s_waitcnt vmcnt(15)
  ds_read_b128 a[152:155], v2 offset:10240
  buffer_load_dwordx4 v113, s[8:11], s66 offen lds
  v_cmp_ne_u32 vcc, v125, v126
  v_mfma_f32_16x16x32_bf16 v[68:71], a[132:135], a[56:59], v[68:71]
  s_waitcnt lgkmcnt(4)
  s_waitcnt vmcnt(15)
  v_mfma_f32_16x16x32_bf16 v[68:71], a[136:139], a[44:47], v[68:71]
  s_waitcnt vmcnt(12)
  s_cbranch_vccnz L_slow_o
L_back_o:
  ds_read_b128 a[156:159], v2 offset:15360
  v_mfma_f32_16x16x32_bf16 v[48:51], a[136:139], a[204:207], v[48:51]
  s_bfe_u32 s65, 0x6040200, s62
  s_lshl_b32 s65, s65, 13
  s_add_u32 s64, s65, s84
  buffer_load_dwordx4 a[208:211], v30, s[8:11], s64 offen sc1
  v_mfma_f32_16x16x32_bf16 v[48:51], a[132:135], a[200:203], v[48:51]
  ds_read_b128 a[160:163], v2 offset:24576
  buffer_load_dwordx4 a[220:223], v31, s[8:11], s64 offen sc1
  v_mfma_f32_16x16x32_bf16 v[48:51], a[128:131], a[60:63], v[48:51]
  s_waitcnt lgkmcnt(5)
  buffer_load_dwordx4 a[216:219], v28, s[8:11], s64 offen sc1
  v_mfma_f32_16x16x32_bf16 v[52:55], a[140:143], a[60:63], v[52:55]
  s_waitcnt lgkmcnt(4)
  ds_read_b128 a[164:167], v2 offset:11264
  buffer_load_dwordx4 a[212:215], v29, s[8:11], s64 offen sc1
  v_mfma_f32_16x16x32_bf16 v[52:55], a[144:147], a[200:203], v[52:55]
  s_waitcnt lgkmcnt(4)
  s_bfe_u32 s65, 0x60402, s62
  v_mfma_f32_16x16x32_bf16 v[52:55], a[148:151], a[204:207], v[52:55]
  s_lshl_b32 s65, s65, 13
  ds_read_b128 a[168:171], v2 offset:20480
  v_mfma_f32_16x16x32_bf16 v[72:75], a[148:151], a[44:47], v[72:75]
  s_add_u32 s64, s65, s84
  v_mfma_f32_16x16x32_bf16 v[72:75], a[144:147], a[56:59], v[72:75]
  ds_read_b128 a[172:175], v2 offset:25600
  buffer_load_dwordx4 a[64:67], v30, s[8:11], s64 offen sc1
  v_mfma_f32_16x16x32_bf16 v[72:75], a[140:143], a[40:43], v[72:75]
  s_waitcnt lgkmcnt(5)
  v_mfma_f32_16x16x32_bf16 v[76:79], a[152:155], a[40:43], v[76:79]
  s_waitcnt lgkmcnt(4)
  ds_read_b128 a[136:139], v2 offset:12288
  v_mfma_f32_16x16x32_bf16 v[76:79], a[156:159], a[56:59], v[76:79]
  s_waitcnt lgkmcnt(4)
  buffer_load_dwordx4 a[80:83], v31, s[8:11], s64 offen sc1
  v_mfma_f32_16x16x32_bf16 v[76:79], a[160:163], a[44:47], v[76:79]
  ds_read_b128 a[132:135], v2 offset:21504
  v_mfma_f32_16x16x32_bf16 v[56:59], a[160:163], a[204:207], v[56:59]
  s_waitcnt vmcnt(13)
  v_mfma_f32_16x16x32_bf16 v[56:59], a[156:159], a[200:203], v[56:59]
  ds_read_b128 a[128:131], v2 offset:26624
  v_mfma_f32_16x16x32_bf16 v[56:59], a[152:155], a[60:63], v[56:59]
  s_waitcnt lgkmcnt(5)
  s_barrier
  v_mfma_f32_16x16x32_bf16 v[60:63], a[164:167], a[60:63], v[60:63]
  s_waitcnt lgkmcnt(4)
  ds_read_b128 a[148:151], v2 offset:18432
  buffer_load_dwordx4 a[68:71], v28, s[8:11], s64 offen sc1
  v_mfma_f32_16x16x32_bf16 v[60:63], a[168:171], a[200:203], v[60:63]
  s_waitcnt lgkmcnt(4)
  v_mfma_f32_16x16x32_bf16 v[60:63], a[172:175], a[204:207], v[60:63]
  ds_read_b128 a[144:147], v1 offset:35840
  buffer_load_dwordx4 a[84:87], v29, s[8:11], s64 offen sc1
  v_mfma_f32_16x16x32_bf16 v[80:83], a[172:175], a[44:47], v[80:83]
  v_mfma_f32_16x16x32_bf16 v[80:83], a[168:171], a[56:59], v[80:83]
  ds_read_b128 a[140:143], v2 offset:28672
  v_mfma_f32_16x16x32_bf16 v[80:83], a[164:167], a[40:43], v[80:83]
  s_waitcnt lgkmcnt(5)
  s_add_u32 m0, s68, 53248
  v_mfma_f32_16x16x32_bf16 v[84:87], a[136:139], a[40:43], v[84:87]
  s_waitcnt lgkmcnt(4)
  ds_read_b128 a[160:163], v2 offset:33792
  buffer_load_dwordx4 v114, s[8:11], s66 offen lds
  v_mfma_f32_16x16x32_bf16 v[84:87], a[132:135], a[56:59], v[84:87]
  s_waitcnt lgkmcnt(4)
  v_mfma_f32_16x16x32_bf16 v[84:87], a[128:131], a[44:47], v[84:87]
  s_add_u32 m0, s68, 57344
  ds_read_b128 a[156:159], v2 offset:19456
  v_mfma_f32_16x16x32_bf16 v[64:67], a[128:131], a[204:207], v[64:67]
  buffer_load_dwordx4 v115, s[8:11], s66 offen lds
  v_mfma_f32_16x16x32_bf16 v[64:67], a[132:135], a[200:203], v[64:67]
  s_add_u32 m0, s68, 61440
  ds_read_b128 a[152:155], v1 offset:36864
  v_mfma_f32_16x16x32_bf16 v[64:67], a[136:139], a[60:63], v[64:67]
  s_waitcnt lgkmcnt(5)
  s_waitcnt vmcnt(9)
  buffer_load_dwordx4 v116, s[8:11], s66 offen lds
  v_mfma_f32_16x16x32_bf16 v[172:175], a[148:151], a[208:211], 0
  s_waitcnt lgkmcnt(4)
  s_waitcnt vmcnt(9)
  s_bfe_u32 s65, 0x2000604, s62
  s_lshl_b32 s65, s65, 13
  s_add_u32 s64, s65, s84
  ds_read_b128 a[172:175], v2 offset:29696
  v_mfma_f32_16x16x32_bf16 v[172:175], a[144:147], a[220:223], v[172:175]
  s_waitcnt vmcnt(8)
  buffer_load_dwordx4 a[72:75], v30, s[8:11], s64 offen sc1
  v_mfma_f32_16x16x32_bf16 v[168:171], a[148:151], a[216:219], 0
  s_waitcnt vmcnt(8)
  ds_read_b128 a[168:171], v2 offset:34816
  v_cvt_pk_bf16_f32 v68, v68, v69
  v_mfma_f32_16x16x32_bf16 v[168:171], a[144:147], a[212:215], v[168:171]
  s_waitcnt lgkmcnt(5)
  buffer_load_dwordx4 a[88:91], v31, s[8:11], s64 offen sc1
  v_mfma_f32_16x16x32_bf16 v[128:131], a[140:143], a[216:219], 0
  s_waitcnt lgkmcnt(4)
  s_mov_b32 s20, s24
  ds_read_b128 a[164:167], v1 offset:32768
  v_cvt_pk_bf16_f32 v69, v70, v71
  v_mfma_f32_16x16x32_bf16 v[128:131], a[160:163], a[212:215], v[128:131]
  s_mov_b32 s21, s25
  buffer_load_dwordx4 a[224:227], v28, s[8:11], s64 offen sc1
  v_mfma_f32_16x16x32_bf16 v[132:135], a[140:143], a[208:211], 0
  s_mov_b32 s22, 0x280000
  ds_read_b128 a[128:131], v1 offset:37888
  v_cvt_pk_bf16_f32 v70, v72, v73
  v_mfma_f32_16x16x32_bf16 v[132:135], a[160:163], a[220:223], v[132:135]
  s_waitcnt lgkmcnt(5)
  s_mov_b32 s23, 0x20000
  buffer_load_dwordx4 a[228:231], v29, s[8:11], s64 offen sc1
  v_mfma_f32_16x16x32_bf16 v[180:183], a[156:159], a[208:211], 0
  s_waitcnt lgkmcnt(4)
  s_mov_b32 s16, s42
  s_bfe_u32 s67, 0x4020006, s62
  s_mul_i32 s67, s67, 20480
  s_add_u32 s66, s67, s81
  s_add_u32 m0, s68, 102400
  ds_read_b128 a[132:135], v2 offset:30720
  v_cvt_pk_bf16_f32 v71, v74, v75
  v_mfma_f32_16x16x32_bf16 v[180:183], a[152:155], a[220:223], v[180:183]
  s_mov_b32 s17, s43
  buffer_load_dwordx4 v112, s[8:11], s66 offen lds
  v_mfma_f32_16x16x32_bf16 v[176:179], a[156:159], a[216:219], 0
  s_mov_b32 s18, 0x280000
  s_add_u32 m0, s68, 106496
  ds_read_b128 a[136:139], v2 offset:35840
  v_cvt_pk_bf16_f32 v76, v76, v77
  v_mfma_f32_16x16x32_bf16 v[176:179], a[152:155], a[212:215], v[176:179]
  s_waitcnt lgkmcnt(5)
  s_mov_b32 s19, 0x20000
  buffer_load_dwordx4 v113, s[8:11], s66 offen lds
  v_mfma_f32_16x16x32_bf16 v[136:139], a[172:175], a[216:219], 0
  s_waitcnt lgkmcnt(4)
  s_mov_b32 s71, 0xc2b17218
  s_add_u32 m0, s68, 110592
  ds_read_b128 a[148:151], v1 offset:33792
  v_cvt_pk_bf16_f32 v77, v78, v79
  v_mfma_f32_16x16x32_bf16 v[136:139], a[168:171], a[212:215], v[136:139]
  s_mov_b32 s89, 0x3c853526
  buffer_load_dwordx4 v114, s[8:11], s66 offen lds
  v_mfma_f32_16x16x32_bf16 v[140:143], a[172:175], a[208:211], 0
  s_mov_b32 s80, 0xffff0000
  ds_read_b128 a[144:147], v1 offset:38912
  v_cvt_pk_bf16_f32 v78, v80, v81
  v_mfma_f32_16x16x32_bf16 v[140:143], a[168:171], a[220:223], v[140:143]
  s_waitcnt lgkmcnt(5)
  s_mov_b32 s90, 0x8000
  v_cvt_pk_bf16_f32 v79, v82, v83
  v_cvt_pk_bf16_f32 v84, v84, v85
  v_mfma_f32_16x16x32_bf16 v[188:191], a[164:167], a[208:211], 0
  s_waitcnt lgkmcnt(4)
  s_add_u32 m0, s68, 114688
  ds_read_b128 a[140:143], v2 offset:31744
  v_cvt_pk_bf16_f32 v85, v86, v87
  v_mfma_f32_16x16x32_bf16 v[188:191], a[128:131], a[220:223], v[188:191]
  buffer_load_dwordx4 v115, s[8:11], s66 offen lds
  v_mfma_f32_16x16x32_bf16 v[184:187], a[164:167], a[216:219], 0
  ds_read_b128 a[160:163], v2 offset:16384
  v_mov_b32 v86, v84
  v_mfma_f32_16x16x32_bf16 v[184:187], a[128:131], a[212:215], v[184:187]
  s_waitcnt lgkmcnt(5)
  s_lshr_b32 s58, s88, 1
  v_mov_b32 v87, v85
  v_mfma_f32_16x16x32_bf16 v[144:147], a[132:135], a[216:219], 0
  s_waitcnt lgkmcnt(4)
  s_add_u32 s58, s58, 0x1c00000
  ds_read_b128 a[156:159], v1 offset:34816
  v_mfma_f32_16x16x32_bf16 v[144:147], a[136:139], a[212:215], v[144:147]
  buffer_store_dwordx4 v[68:71], v1, s[8:11], s58 offen offset:0 sc1
  v_mfma_f32_16x16x32_bf16 v[148:151], a[132:135], a[208:211], 0
  ds_read_b128 a[152:155], v1 offset:39936
  v_mfma_f32_16x16x32_bf16 v[148:151], a[136:139], a[220:223], v[148:151]
  s_waitcnt lgkmcnt(5)
  buffer_store_dwordx4 v[76:79], v1, s[8:11], s58 offen offset:1024 sc1
  v_mfma_f32_16x16x32_bf16 v[36:39], a[148:151], a[208:211], 0
  s_waitcnt lgkmcnt(4)
  ds_read_b128 a[172:175], v2 offset:32768
  v_mfma_f32_16x16x32_bf16 v[36:39], a[144:147], a[220:223], v[36:39]
  buffer_store_dwordx4 v[84:87], v1, s[8:11], s58 offen offset:2048 sc1
  v_mfma_f32_16x16x32_bf16 v[32:35], a[148:151], a[216:219], 0
  ds_read_b128 a[168:171], v2 offset:17408
  v_bfe_u32 v96, v0, 2, 2
  v_mfma_f32_16x16x32_bf16 v[32:35], a[144:147], a[212:215], v[32:35]
  s_waitcnt lgkmcnt(5)
  s_barrier
  v_mfma_f32_16x16x32_bf16 v[152:155], a[140:143], a[216:219], 0
  s_waitcnt lgkmcnt(4)
  ds_read_b128 a[164:167], v1 offset:51200
  v_bfe_u32 v97, v0, 4, 2
  v_mfma_f32_16x16x32_bf16 v[152:155], a[160:163], a[212:215], v[152:155]
  v_cmp_eq_u32 vcc, v96, v97
  v_and_b32 v96, 1, v0
  v_mfma_f32_16x16x32_bf16 v[156:159], a[140:143], a[208:211], 0
  ds_read_b128 a[128:131], v1 offset:3072
  v_lshlrev_b32 v96, 4, v96
  v_mfma_f32_16x16x32_bf16 v[156:159], a[160:163], a[220:223], v[156:159]
  s_waitcnt lgkmcnt(5)
  v_mov_b32 v97, 0x3f80
  v_lshlrev_b32 v96, v96, v97
  v_mfma_f32_16x16x32_bf16 v[44:47], a[156:159], a[208:211], 0
  s_waitcnt lgkmcnt(4)
  s_add_u32 m0, s68, 118784
  ds_read_b128 a[132:135], v1 offset:40960
  v_cndmask_b32 v96, 0, v96, vcc
  v_mfma_f32_16x16x32_bf16 v[44:47], a[152:155], a[220:223], v[44:47]
  buffer_load_dwordx4 v116, s[8:11], s66 offen lds
  v_mfma_f32_16x16x32_bf16 v[40:43], a[156:159], a[216:219], 0
  ds_read_b128 a[136:139], v1 offset:46080
  v_and_b32 v97, 2, v0
  v_mfma_f32_16x16x32_bf16 v[40:43], a[152:155], a[212:215], v[40:43]
  s_waitcnt lgkmcnt(5)
  v_cmp_eq_u32 vcc, 0, v97
  v_mov_b32 v90, 0
  v_mfma_f32_16x16x32_bf16 v[160:163], a[172:175], a[216:219], 0
  s_waitcnt lgkmcnt(4)
  ds_read_b128 a[148:151], v1 offset:52224
  v_mov_b32 v91, 0
  v_mfma_f32_16x16x32_bf16 v[160:163], a[168:171], a[212:215], v[160:163]
  v_cndmask_b32 v88, 0, v96, vcc
  v_sub_u32 v89, v96, v88
  v_mfma_f32_16x16x32_bf16 v[164:167], a[172:175], a[208:211], 0
  ds_read_b128 a[144:147], v1 offset:4096
  v_mov_b32 v92, 0
  v_mfma_f32_16x16x32_bf16 v[164:167], a[168:171], a[220:223], v[164:167]
  s_waitcnt lgkmcnt(5)
  s_waitcnt vmcnt(18)
  v_mov_b32 v93, 0
  v_mov_b32 v94, v88
  v_mfma_f32_16x16x32_bf16 v[172:175], a[164:167], a[64:67], v[172:175]
  s_waitcnt lgkmcnt(4)
  s_waitcnt vmcnt(17)
  s_bfe_u32 s65, 0x4020006, s62
  ds_read_b128 a[140:143], v1 offset:41984
  v_mov_b32 v95, v89
  v_mfma_f32_16x16x32_bf16 v[172:175], a[128:131], a[80:83], v[172:175]
  s_waitcnt vmcnt(16)
  s_lshl_b32 s65, s65, 13
  v_mfma_f32_16x16x32_bf16 v[168:171], a[164:167], a[68:71], v[168:171]
  s_waitcnt vmcnt(15)
  s_add_u32 s64, s65, s84
  ds_read_b128 a[160:163], v1 offset:47104
  v_mfma_f32_16x16x32_bf16 v[168:171], a[128:131], a[84:87], v[168:171]
  s_waitcnt lgkmcnt(5)
  buffer_load_dwordx4 a[232:235], v30, s[8:11], s64 offen sc1
  v_mfma_f32_16x16x32_bf16 v[128:131], a[132:135], a[68:71], v[128:131]
  s_waitcnt lgkmcnt(4)
  ds_read_b128 a[156:159], v1 offset:0
  v_mfma_f32_16x16x32_bf16 v[128:131], a[136:139], a[84:87], v[128:131]
  v_mfma_f32_16x16x32_bf16 v[132:135], a[132:135], a[64:67], v[132:135]
  ds_read_b128 a[152:155], v1 offset:5120
  v_mfma_f32_16x16x32_bf16 v[132:135], a[136:139], a[80:83], v[132:135]
  s_waitcnt lgkmcnt(5)
  buffer_load_dwordx4 a[244:247], v31, s[8:11], s64 offen sc1
  v_mfma_f32_16x16x32_bf16 v[180:183], a[148:151], a[64:67], v[180:183]
  s_waitcnt lgkmcnt(4)
  ds_read_b128 a[172:175], v1 offset:43008
  v_mfma_f32_16x16x32_bf16 v[180:183], a[144:147], a[80:83], v[180:183]
  v_mfma_f32_16x16x32_bf16 v[176:179], a[148:151], a[68:71], v[176:179]
  ds_read_b128 a[168:171], v1 offset:48128
  v_mfma_f32_16x16x32_bf16 v[176:179], a[144:147], a[84:87], v[176:179]
  s_waitcnt lgkmcnt(5)
  v_mfma_f32_16x16x32_bf16 v[136:139], a[140:143], a[68:71], v[136:139]
  s_waitcnt lgkmcnt(4)
  ds_read_b128 a[164:167], v1 offset:1024
  v_mfma_f32_16x16x32_bf16 v[136:139], a[160:163], a[84:87], v[136:139]
  buffer_load_dwordx4 a[76:79], v28, s[8:11], s64 offen sc1
  v_mfma_f32_16x16x32_bf16 v[140:143], a[140:143], a[64:67], v[140:143]
  ds_read_b128 a[128:131], v1 offset:6144
  v_mfma_f32_16x16x32_bf16 v[140:143], a[160:163], a[80:83], v[140:143]
  s_waitcnt lgkmcnt(5)
  v_mfma_f32_16x16x32_bf16 v[188:191], a[156:159], a[64:67], v[188:191]
  s_waitcnt lgkmcnt(4)
  ds_read_b128 a[132:135], v1 offset:44032
  v_mfma_f32_16x16x32_bf16 v[188:191], a[152:155], a[80:83], v[188:191]
  buffer_load_dwordx4 a[92:95], v29, s[8:11], s64 offen sc1
  v_mfma_f32_16x16x32_bf16 v[184:187], a[156:159], a[68:71], v[184:187]
  s_and_b32 s61, s2, 230
  ds_read_b128 a[136:139], v1 offset:49152
  v_mfma_f32_16x16x32_bf16 v[184:187], a[152:155], a[84:87], v[184:187]
  s_waitcnt lgkmcnt(5)
  s_lshl_b32 s61, s61, 7
  v_mfma_f32_16x16x32_bf16 v[144:147], a[172:175], a[68:71], v[144:147]
  s_waitcnt lgkmcnt(4)
  s_add_u32 s61, s61, 0x310000
  ds_read_b128 a[148:151], v1 offset:2048
  v_mfma_f32_16x16x32_bf16 v[144:147], a[168:171], a[84:87], v[144:147]
  buffer_load_dword v126, v122, s[8:11], s61 offen sc1
  v_mfma_f32_16x16x32_bf16 v[148:151], a[172:175], a[64:67], v[148:151]
  s_bfe_u32 s67, 0xe0c0a08, s62
  s_mul_i32 s67, s67, 20480
  ds_read_b128 a[144:147], v1 offset:7168
  v_mfma_f32_16x16x32_bf16 v[148:151], a[168:171], a[80:83], v[148:151]
  s_waitcnt lgkmcnt(5)
  s_add_u32 s66, s67, s81
  v_mfma_f32_16x16x32_bf16 v[36:39], a[164:167], a[64:67], v[36:39]
  s_waitcnt lgkmcnt(4)
  s_add_u32 m0, s68, 122880
  ds_read_b128 a[140:143], v1 offset:45056
  v_mfma_f32_16x16x32_bf16 v[36:39], a[128:131], a[80:83], v[36:39]
  s_waitcnt vmcnt(6)
  buffer_load_dwordx4 v112, s[8:11], s66 offen lds
  v_mfma_f32_16x16x32_bf16 v[32:35], a[164:167], a[68:71], v[32:35]
  ds_read_b128 a[160:163], v1 offset:50176
  v_mfma_f32_16x16x32_bf16 v[32:35], a[128:131], a[84:87], v[32:35]
  s_waitcnt lgkmcnt(5)
  s_barrier
  v_mfma_f32_16x16x32_bf16 v[152:155], a[132:135], a[68:71], v[152:155]
  s_waitcnt lgkmcnt(4)
  s_lshl_b32 s59, s2, 7
  s_add_u32 s59, s59, 0x308000
  ds_read_b128 a[156:159], v1 offset:55296
  v_mfma_f32_16x16x32_bf16 v[152:155], a[136:139], a[84:87], v[152:155]
  buffer_store_dword v125, v123, s[8:11], s59 offen sc1
  v_mfma_f32_16x16x32_bf16 v[156:159], a[132:135], a[64:67], v[156:159]
  ds_read_b128 a[152:155], v1 offset:60416
  v_mfma_f32_16x16x32_bf16 v[156:159], a[136:139], a[80:83], v[156:159]
  s_waitcnt lgkmcnt(5)
  v_mfma_f32_16x16x32_bf16 v[44:47], a[148:151], a[64:67], v[44:47]
  s_waitcnt lgkmcnt(4)
  s_add_u32 m0, s68, 126976
  ds_read_b128 a[172:175], v1 offset:8192
  v_mfma_f32_16x16x32_bf16 v[44:47], a[144:147], a[80:83], v[44:47]
  buffer_load_dwordx4 v113, s[8:11], s66 offen lds
  v_mfma_f32_16x16x32_bf16 v[40:43], a[148:151], a[68:71], v[40:43]
  ds_read_b128 a[168:171], v1 offset:13312
  v_mfma_f32_16x16x32_bf16 v[40:43], a[144:147], a[84:87], v[40:43]
  s_waitcnt lgkmcnt(5)
  v_mfma_f32_16x16x32_bf16 v[160:163], a[140:143], a[68:71], v[160:163]
  s_waitcnt lgkmcnt(4)
  ds_read_b128 a[164:167], v1 offset:56320
  v_mfma_f32_16x16x32_bf16 v[160:163], a[160:163], a[84:87], v[160:163]
  v_mfma_f32_16x16x32_bf16 v[164:167], a[140:143], a[64:67], v[164:167]
  s_add_u32 m0, s68, 131072
  ds_read_b128 a[128:131], v1 offset:61440
  v_mfma_f32_16x16x32_bf16 v[164:167], a[160:163], a[80:83], v[164:167]
  s_waitcnt lgkmcnt(5)
  buffer_load_dwordx4 v114, s[8:11], s66 offen lds
  v_mfma_f32_16x16x32_bf16 v[172:175], a[156:159], a[72:75], v[172:175]
  s_waitcnt lgkmcnt(4)
  ds_read_b128 a[132:135], v1 offset:9216
  v_mfma_f32_16x16x32_bf16 v[172:175], a[152:155], a[88:91], v[172:175]
  v_mfma_f32_16x16x32_bf16 v[168:171], a[156:159], a[224:227], v[168:171]
  s_add_u32 m0, s68, 135168
  ds_read_b128 a[136:139], v1 offset:14336
  v_mfma_f32_16x16x32_bf16 v[168:171], a[152:155], a[228:231], v[168:171]
  s_waitcnt lgkmcnt(5)
  buffer_load_dwordx4 v115, s[8:11], s66 offen lds
  v_mfma_f32_16x16x32_bf16 v[128:131], a[172:175], a[224:227], v[128:131]
  s_waitcnt lgkmcnt(4)
  ds_read_b128 a[148:151], v1 offset:57344
  v_mfma_f32_16x16x32_bf16 v[128:131], a[168:171], a[228:231], v[128:131]
  v_mfma_f32_16x16x32_bf16 v[132:135], a[172:175], a[72:75], v[132:135]
  s_add_u32 m0, s68, 139264
  ds_read_b128 a[144:147], v1 offset:62464
  v_mfma_f32_16x16x32_bf16 v[132:135], a[168:171], a[88:91], v[132:135]
  s_waitcnt lgkmcnt(5)
  buffer_load_dwordx4 v116, s[8:11], s66 offen lds
  v_mfma_f32_16x16x32_bf16 v[180:183], a[164:167], a[72:75], v[180:183]
  s_waitcnt lgkmcnt(4)
  s_bfe_u32 s65, 0xe0c0a08, s62
  ds_read_b128 a[140:143], v1 offset:10240
  v_mfma_f32_16x16x32_bf16 v[180:183], a[128:131], a[88:91], v[180:183]
  s_lshl_b32 s65, s65, 13
  v_mfma_f32_16x16x32_bf16 v[176:179], a[164:167], a[224:227], v[176:179]
  s_add_u32 s64, s65, s84
  ds_read_b128 a[160:163], v1 offset:15360
  v_mfma_f32_16x16x32_bf16 v[176:179], a[128:131], a[228:231], v[176:179]
  s_waitcnt lgkmcnt(5)
  buffer_load_dwordx4 a[240:243], v30, s[8:11], s64 offen sc1
  v_mfma_f32_16x16x32_bf16 v[136:139], a[132:135], a[224:227], v[136:139]
  s_waitcnt lgkmcnt(4)
  ds_read_b128 a[156:159], v1 offset:58368
  v_mfma_f32_16x16x32_bf16 v[136:139], a[136:139], a[228:231], v[136:139]
  v_mfma_f32_16x16x32_bf16 v[140:143], a[132:135], a[72:75], v[140:143]
  ds_read_b128 a[152:155], v1 offset:63488
  v_mfma_f32_16x16x32_bf16 v[140:143], a[136:139], a[88:91], v[140:143]
  s_waitcnt lgkmcnt(5)
  buffer_load_dwordx4 a[236:239], v31, s[8:11], s64 offen sc1
  v_mfma_f32_16x16x32_bf16 v[188:191], a[148:151], a[72:75], v[188:191]
  s_waitcnt lgkmcnt(4)
  ds_read_b128 a[172:175], v1 offset:11264
  v_mfma_f32_16x16x32_bf16 v[188:191], a[144:147], a[88:91], v[188:191]
  v_mfma_f32_16x16x32_bf16 v[184:187], a[148:151], a[224:227], v[184:187]
  ds_read_b128 a[168:171], v1 offset:53248
  v_mfma_f32_16x16x32_bf16 v[184:187], a[144:147], a[228:231], v[184:187]
  s_waitcnt lgkmcnt(5)
  v_mfma_f32_16x16x32_bf16 v[144:147], a[140:143], a[224:227], v[144:147]
  s_waitcnt lgkmcnt(4)
  ds_read_b128 a[164:167], v1 offset:59392
  v_mfma_f32_16x16x32_bf16 v[144:147], a[160:163], a[228:231], v[144:147]
  buffer_load_dwordx4 a[96:99], v28, s[8:11], s64 offen sc1
  v_mfma_f32_16x16x32_bf16 v[148:151], a[140:143], a[72:75], v[148:151]
  ds_read_b128 a[128:131], v1 offset:64512
  v_mfma_f32_16x16x32_bf16 v[148:151], a[160:163], a[88:91], v[148:151]
  s_waitcnt lgkmcnt(5)
  v_mfma_f32_16x16x32_bf16 v[36:39], a[156:159], a[72:75], v[36:39]
  s_waitcnt lgkmcnt(4)
  ds_read_b128 a[132:135], v1 offset:12288
  v_mfma_f32_16x16x32_bf16 v[36:39], a[152:155], a[88:91], v[36:39]
  s_waitcnt vmcnt(14)
  buffer_load_dwordx4 a[112:115], v29, s[8:11], s64 offen sc1
  v_mfma_f32_16x16x32_bf16 v[32:35], a[156:159], a[224:227], v[32:35]
  ds_read_b128 a[136:139], v1 offset:54272
  v_mfma_f32_16x16x32_bf16 v[32:35], a[152:155], a[228:231], v[32:35]
  s_waitcnt lgkmcnt(5)
  s_barrier
  v_mfma_f32_16x16x32_bf16 v[152:155], a[172:175], a[224:227], v[152:155]
  s_waitcnt lgkmcnt(4)
  s_bfe_u32 s67, 0x80e0c0a, s62
  s_mul_i32 s67, s67, 20480
  s_add_u32 s66, s67, s81
  s_add_u32 m0, s68, 143360
  ds_read_b128 a[148:151], v2 offset:47104
  v_mfma_f32_16x16x32_bf16 v[152:155], a[168:171], a[228:231], v[152:155]
  buffer_load_dwordx4 v112, s[8:11], s66 offen lds
  v_mfma_f32_16x16x32_bf16 v[156:159], a[172:175], a[72:75], v[156:159]
  ds_read_b128 a[144:147], v2 offset:52224
  v_mfma_f32_16x16x32_bf16 v[156:159], a[168:171], a[88:91], v[156:159]
  s_waitcnt lgkmcnt(5)
  v_mfma_f32_16x16x32_bf16 v[44:47], a[164:167], a[72:75], v[44:47]
  s_waitcnt lgkmcnt(4)
  s_add_u32 m0, s68, 147456
  ds_read_b128 a[140:143], v2 offset:36864
  v_mfma_f32_16x16x32_bf16 v[44:47], a[128:131], a[88:91], v[44:47]
  buffer_load_dwordx4 v113, s[8:11], s66 offen lds
  v_mfma_f32_16x16x32_bf16 v[40:43], a[164:167], a[224:227], v[40:43]
  ds_read_b128 a[160:163], v2 offset:41984
  v_mfma_f32_16x16x32_bf16 v[40:43], a[128:131], a[228:231], v[40:43]
  s_waitcnt lgkmcnt(5)
  v_mfma_f32_16x16x32_bf16 v[160:163], a[132:135], a[224:227], v[160:163]
  s_waitcnt lgkmcnt(4)
  s_add_u32 m0, s68, 151552
  ds_read_b128 a[156:159], v2 offset:48128
  v_mfma_f32_16x16x32_bf16 v[160:163], a[136:139], a[228:231], v[160:163]
  buffer_load_dwordx4 v114, s[8:11], s66 offen lds
  v_mfma_f32_16x16x32_bf16 v[164:167], a[132:135], a[72:75], v[164:167]
  ds_read_b128 a[152:155], v2 offset:53248
  v_mfma_f32_16x16x32_bf16 v[164:167], a[136:139], a[88:91], v[164:167]
  s_waitcnt lgkmcnt(5)
  s_waitcnt vmcnt(17)
  v_mfma_f32_16x16x32_bf16 v[172:175], a[148:151], a[232:235], v[172:175]
  s_waitcnt lgkmcnt(4)
  s_waitcnt vmcnt(16)
  s_waitcnt vmcnt(13)
  ds_read_b128 a[172:175], v2 offset:37888
  v_cmp_ne_u32 vcc, v125, v126
  v_mfma_f32_16x16x32_bf16 v[172:175], a[144:147], a[244:247], v[172:175]
  v_mfma_f32_16x16x32_bf16 v[168:171], a[148:151], a[76:79], v[168:171]
  s_cbranch_vccnz L_slow_q
L_back_q:
  ds_read_b128 a[168:171], v2 offset:43008
  v_mfma_f32_16x16x32_bf16 v[168:171], a[144:147], a[92:95], v[168:171]
  s_waitcnt lgkmcnt(5)
  s_add_u32 m0, s68, 16384
  s_nop 0
  buffer_load_dwordx4 v115, s[8:11], s66 offen lds
  v_mfma_f32_16x16x32_bf16 v[128:131], a[140:143], a[76:79], v[128:131]
  s_waitcnt lgkmcnt(4)
  ds_read_b128 a[164:167], v2 offset:49152
  v_mfma_f32_16x16x32_bf16 v[128:131], a[160:163], a[92:95], v[128:131]
  v_mfma_f32_16x16x32_bf16 v[132:135], a[140:143], a[232:235], v[132:135]
  s_add_u32 m0, s68, 20480
  ds_read_b128 a[128:131], v2 offset:54272
  v_mfma_f32_16x16x32_bf16 v[132:135], a[160:163], a[244:247], v[132:135]
  s_waitcnt lgkmcnt(5)
  buffer_load_dwordx4 v116, s[8:11], s66 offen lds
  v_mfma_f32_16x16x32_bf16 v[180:183], a[156:159], a[232:235], v[180:183]
  s_waitcnt lgkmcnt(4)
  s_bfe_u32 s65, 0x80e0c0a, s62
  ds_read_b128 a[132:135], v2 offset:38912
  v_mfma_f32_16x16x32_bf16 v[180:183], a[152:155], a[244:247], v[180:183]
  s_lshl_b32 s65, s65, 13
  v_mfma_f32_16x16x32_bf16 v[176:179], a[156:159], a[76:79], v[176:179]
  s_add_u32 s64, s65, s84
  ds_read_b128 a[136:139], v2 offset:44032
  v_mfma_f32_16x16x32_bf16 v[176:179], a[152:155], a[92:95], v[176:179]
  s_waitcnt lgkmcnt(5)
  buffer_load_dwordx4 a[100:103], v30, s[8:11], s64 offen sc1
  v_mfma_f32_16x16x32_bf16 v[136:139], a[172:175], a[76:79], v[136:139]
  s_waitcnt lgkmcnt(4)
  ds_read_b128 a[148:151], v2 offset:50176
  v_mfma_f32_16x16x32_bf16 v[136:139], a[168:171], a[92:95], v[136:139]
  v_mfma_f32_16x16x32_bf16 v[140:143], a[172:175], a[232:235], v[140:143]
  ds_read_b128 a[144:147], v2 offset:55296
  v_mfma_f32_16x16x32_bf16 v[140:143], a[168:171], a[244:247], v[140:143]
  s_waitcnt lgkmcnt(5)
  buffer_load_dwordx4 a[116:119], v31, s[8:11], s64 offen sc1
  v_mfma_f32_16x16x32_bf16 v[188:191], a[164:167], a[232:235], v[188:191]
  s_waitcnt lgkmcnt(4)
  ds_read_b128 a[140:143], v2 offset:39936
  v_mfma_f32_16x16x32_bf16 v[188:191], a[128:131], a[244:247], v[188:191]
  v_mfma_f32_16x16x32_bf16 v[184:187], a[164:167], a[76:79], v[184:187]
  ds_read_b128 a[160:163], v2 offset:45056
  v_mfma_f32_16x16x32_bf16 v[184:187], a[128:131], a[92:95], v[184:187]
  s_waitcnt lgkmcnt(5)
  buffer_load_dwordx4 a[248:251], v28, s[8:11], s64 offen sc1
  v_mfma_f32_16x16x32_bf16 v[144:147], a[132:135], a[76:79], v[144:147]
  s_waitcnt lgkmcnt(4)
  ds_read_b128 a[156:159], v2 offset:51200
  v_mfma_f32_16x16x32_bf16 v[144:147], a[136:139], a[92:95], v[144:147]
  v_mfma_f32_16x16x32_bf16 v[148:151], a[132:135], a[232:235], v[148:151]
  ds_read_b128 a[152:155], v2 offset:56320
  v_mfma_f32_16x16x32_bf16 v[148:151], a[136:139], a[244:247], v[148:151]
  s_waitcnt lgkmcnt(5)
  buffer_load_dwordx4 a[104:107], v29, s[8:11], s64 offen sc1
  v_mfma_f32_16x16x32_bf16 v[36:39], a[148:151], a[232:235], v[36:39]
  s_waitcnt lgkmcnt(4)
  ds_read_b128 a[172:175], v2 offset:40960
  v_mfma_f32_16x16x32_bf16 v[36:39], a[144:147], a[244:247], v[36:39]
  s_waitcnt vmcnt(13)
  v_mfma_f32_16x16x32_bf16 v[32:35], a[148:151], a[76:79], v[32:35]
  ds_read_b128 a[168:171], v2 offset:46080
  v_mfma_f32_16x16x32_bf16 v[32:35], a[144:147], a[92:95], v[32:35]
  s_waitcnt lgkmcnt(5)
  s_barrier
  v_mfma_f32_16x16x32_bf16 v[152:155], a[140:143], a[76:79], v[152:155]
  s_waitcnt lgkmcnt(4)
  ds_read_b128 a[164:167], v3 offset:2048
  v_mfma_f32_16x16x32_bf16 v[152:155], a[160:163], a[92:95], v[152:155]
  buffer_load_dwordx4 v[100:103], v15, s[20:23], s100 offen offset:0
  v_mfma_f32_16x16x32_bf16 v[156:159], a[140:143], a[232:235], v[156:159]
  ds_read_b128 a[128:131], v3 offset:7168
  v_mfma_f32_16x16x32_bf16 v[156:159], a[160:163], a[244:247], v[156:159]
  s_waitcnt lgkmcnt(5)
  v_mfma_f32_16x16x32_bf16 v[44:47], a[156:159], a[232:235], v[44:47]
  s_waitcnt lgkmcnt(4)
  ds_read_b128 a[132:135], v2 offset:57344
  v_mfma_f32_16x16x32_bf16 v[44:47], a[152:155], a[244:247], v[44:47]
  buffer_load_dwordx4 v[104:107], v15, s[20:23], s100 offen offset:64
  v_mfma_f32_16x16x32_bf16 v[40:43], a[156:159], a[76:79], v[40:43]
  ds_read_b128 a[136:139], v2 offset:62464
  v_mfma_f32_16x16x32_bf16 v[40:43], a[152:155], a[92:95], v[40:43]
  s_waitcnt lgkmcnt(5)
  v_mfma_f32_16x16x32_bf16 v[160:163], a[172:175], a[76:79], v[160:163]
  s_waitcnt lgkmcnt(4)
  ds_read_b128 a[148:151], v3 offset:3072
  v_mfma_f32_16x16x32_bf16 v[160:163], a[168:171], a[92:95], v[160:163]
  buffer_load_dwordx2 v[108:109], v11, s[20:23], s100 offen offset:0
  v_mfma_f32_16x16x32_bf16 v[164:167], a[172:175], a[232:235], v[164:167]
  s_bfe_u32 s67, 0xa080e0c, s62
  s_mul_i32 s67, s67, 20480
  ds_read_b128 a[144:147], v3 offset:8192
  v_mfma_f32_16x16x32_bf16 v[164:167], a[168:171], a[244:247], v[164:167]
  s_waitcnt lgkmcnt(5)
  s_waitcnt vmcnt(15)
  s_add_u32 s66, s67, s81
  v_mfma_f32_16x16x32_bf16 v[172:175], a[164:167], a[240:243], v[172:175]
  s_waitcnt lgkmcnt(4)
  s_waitcnt vmcnt(14)
  s_add_u32 m0, s68, 155648
  ds_read_b128 a[140:143], v2 offset:58368
  v_mfma_f32_16x16x32_bf16 v[172:175], a[128:131], a[236:239], v[172:175]
  s_waitcnt vmcnt(13)
  buffer_load_dwordx4 v112, s[8:11], s66 offen lds
  v_mfma_f32_16x16x32_bf16 v[168:171], a[164:167], a[96:99], v[168:171]
  s_waitcnt vmcnt(13)
  ds_read_b128 a[160:163], v2 offset:63488
  v_mfma_f32_16x16x32_bf16 v[168:171], a[128:131], a[112:115], v[168:171]
  s_waitcnt lgkmcnt(5)
  v_mfma_f32_16x16x32_bf16 v[128:131], a[132:135], a[96:99], v[128:131]
  s_waitcnt lgkmcnt(4)
  s_add_u32 m0, s68, 159744
  ds_read_b128 a[156:159], v3 offset:4096
  v_mfma_f32_16x16x32_bf16 v[128:131], a[136:139], a[112:115], v[128:131]
  buffer_load_dwordx4 v113, s[8:11], s66 offen lds
  v_mfma_f32_16x16x32_bf16 v[132:135], a[132:135], a[240:243], v[132:135]
  ds_read_b128 a[152:155], v3 offset:9216
  v_mfma_f32_16x16x32_bf16 v[132:135], a[136:139], a[236:239], v[132:135]
  s_waitcnt lgkmcnt(5)
  v_mfma_f32_16x16x32_bf16 v[180:183], a[148:151], a[240:243], v[180:183]
  s_waitcnt lgkmcnt(4)
  ds_read_b128 a[172:175], v2 offset:59392
  v_mfma_f32_16x16x32_bf16 v[180:183], a[144:147], a[236:239], v[180:183]
  v_mfma_f32_16x16x32_bf16 v[176:179], a[148:151], a[96:99], v[176:179]
  s_add_u32 m0, s68, 24576
  ds_read_b128 a[168:171], v2 offset:64512
  v_mfma_f32_16x16x32_bf16 v[176:179], a[144:147], a[112:115], v[176:179]
  s_waitcnt lgkmcnt(5)
  buffer_load_dwordx4 v114, s[8:11], s66 offen lds
  v_mfma_f32_16x16x32_bf16 v[136:139], a[140:143], a[96:99], v[136:139]
  s_waitcnt lgkmcnt(4)
  ds_read_b128 a[164:167], v3 offset:5120
  v_mfma_f32_16x16x32_bf16 v[136:139], a[160:163], a[112:115], v[136:139]
  v_mfma_f32_16x16x32_bf16 v[140:143], a[140:143], a[240:243], v[140:143]
  s_add_u32 m0, s68, 28672
  ds_read_b128 a[128:131], v3 offset:10240
  v_mfma_f32_16x16x32_bf16 v[140:143], a[160:163], a[236:239], v[140:143]
  s_waitcnt lgkmcnt(5)
  buffer_load_dwordx4 v115, s[8:11], s66 offen lds
  v_mfma_f32_16x16x32_bf16 v[188:191], a[156:159], a[240:243], v[188:191]
  s_waitcnt lgkmcnt(4)
  ds_read_b128 a[132:135], v2 offset:60416
  v_mfma_f32_16x16x32_bf16 v[188:191], a[152:155], a[236:239], v[188:191]
  v_mfma_f32_16x16x32_bf16 v[184:187], a[156:159], a[96:99], v[184:187]
  s_add_u32 m0, s68, 65536
  ds_read_b128 a[136:139], v3 offset:0
  v_mfma_f32_16x16x32_bf16 v[184:187], a[152:155], a[112:115], v[184:187]
  s_waitcnt lgkmcnt(5)
  buffer_load_dwordx4 v116, s[8:11], s66 offen lds
  v_mfma_f32_16x16x32_bf16 v[144:147], a[172:175], a[96:99], v[144:147]
  s_waitcnt lgkmcnt(4)
  s_bfe_u32 s65, 0xa080e0c, s62
  ds_read_b128 a[148:151], v3 offset:6144
  v_mfma_f32_16x16x32_bf16 v[144:147], a[168:171], a[112:115], v[144:147]
  s_lshl_b32 s65, s65, 13
  v_mfma_f32_16x16x32_bf16 v[148:151], a[172:175], a[240:243], v[148:151]
  s_add_u32 s64, s65, s84
  ds_read_b128 a[144:147], v3 offset:11264
  v_mfma_f32_16x16x32_bf16 v[148:151], a[168:171], a[236:239], v[148:151]
  s_waitcnt lgkmcnt(5)
  buffer_load_dwordx4 a[120:123], v30, s[8:11], s64 offen sc1
  v_mfma_f32_16x16x32_bf16 v[36:39], a[164:167], a[240:243], v[36:39]
  s_waitcnt lgkmcnt(4)
  ds_read_b128 a[140:143], v2 offset:61440
  v_mfma_f32_16x16x32_bf16 v[36:39], a[128:131], a[236:239], v[36:39]
  s_waitcnt vmcnt(13)
  v_mfma_f32_16x16x32_bf16 v[32:35], a[164:167], a[96:99], v[32:35]
  ds_read_b128 a[160:163], v3 offset:1024
  v_mfma_f32_16x16x32_bf16 v[32:35], a[128:131], a[112:115], v[32:35]
  s_waitcnt lgkmcnt(5)
  s_barrier
  v_mfma_f32_16x16x32_bf16 v[152:155], a[132:135], a[96:99], v[152:155]
  s_waitcnt lgkmcnt(4)
  ds_read_b128 a[156:159], v3 offset:22528
  v_mfma_f32_16x16x32_bf16 v[152:155], a[136:139], a[112:115], v[152:155]
  buffer_load_dwordx4 a[252:255], v31, s[8:11], s64 offen sc1
  v_mfma_f32_16x16x32_bf16 v[156:159], a[132:135], a[240:243], v[156:159]
  ds_read_b128 a[152:155], v1 offset:19456
  v_mfma_f32_16x16x32_bf16 v[156:159], a[136:139], a[236:239], v[156:159]
  s_waitcnt lgkmcnt(5)
  v_mfma_f32_16x16x32_bf16 v[44:47], a[148:151], a[240:243], v[44:47]
  s_waitcnt lgkmcnt(4)
  ds_read_b128 a[172:175], v3 offset:12288
  v_mfma_f32_16x16x32_bf16 v[44:47], a[144:147], a[236:239], v[44:47]
  buffer_load_dwordx4 a[108:111], v28, s[8:11], s64 offen sc1
  v_mfma_f32_16x16x32_bf16 v[40:43], a[148:151], a[96:99], v[40:43]
  ds_read_b128 a[168:171], v3 offset:17408
  v_mfma_f32_16x16x32_bf16 v[40:43], a[144:147], a[112:115], v[40:43]
  s_waitcnt lgkmcnt(5)
  buffer_load_dwordx4 a[124:127], v29, s[8:11], s64 offen sc1
  v_mfma_f32_16x16x32_bf16 v[160:163], a[140:143], a[96:99], v[160:163]
  s_waitcnt lgkmcnt(4)
  ds_read_b128 a[164:167], v3 offset:23552
  v_mfma_f32_16x16x32_bf16 v[160:163], a[160:163], a[112:115], v[160:163]
  v_mfma_f32_16x16x32_bf16 v[164:167], a[140:143], a[240:243], v[164:167]
  s_xor_b32 s61, s2, 4
  ds_read_b128 a[128:131], v1 offset:20480
  v_mfma_f32_16x16x32_bf16 v[164:167], a[160:163], a[236:239], v[164:167]
  s_waitcnt lgkmcnt(5)
  s_waitcnt vmcnt(15)
  s_lshl_b32 s61, s61, 7
  v_mfma_f32_16x16x32_bf16 v[172:175], a[156:159], a[100:103], v[172:175]
  s_waitcnt lgkmcnt(4)
  s_waitcnt vmcnt(14)
  s_add_u32 s61, s61, 0x308000
  ds_read_b128 a[132:135], v3 offset:13312
  v_mfma_f32_16x16x32_bf16 v[172:175], a[152:155], a[116:119], v[172:175]
  s_waitcnt vmcnt(13)
  buffer_load_dword v126, v117, s[8:11], s61 offen sc1
  v_mfma_f32_16x16x32_bf16 v[168:171], a[156:159], a[248:251], v[168:171]
  s_waitcnt vmcnt(13)
  s_bfe_u32 s67, 0xc0a080e, s62
  s_mul_i32 s67, s67, 20480
  ds_read_b128 a[136:139], v3 offset:18432
  v_mfma_f32_16x16x32_bf16 v[168:171], a[152:155], a[104:107], v[168:171]
  s_waitcnt lgkmcnt(5)
  s_add_u32 s66, s67, s81
  v_mfma_f32_16x16x32_bf16 v[128:131], a[172:175], a[248:251], v[128:131]
  s_waitcnt lgkmcnt(4)
  s_add_u32 m0, s68, 69632
  ds_read_b128 a[148:151], v1 offset:16384
  v_mfma_f32_16x16x32_bf16 v[128:131], a[168:171], a[104:107], v[128:131]
  buffer_load_dwordx4 v112, s[8:11], s66 offen lds
  v_mfma_f32_16x16x32_bf16 v[132:135], a[172:175], a[100:103], v[132:135]
  ds_read_b128 a[144:147], v1 offset:21504
  v_mfma_f32_16x16x32_bf16 v[132:135], a[168:171], a[116:119], v[132:135]
  s_waitcnt lgkmcnt(5)
  v_mfma_f32_16x16x32_bf16 v[180:183], a[164:167], a[100:103], v[180:183]
  s_waitcnt lgkmcnt(4)
  s_add_u32 m0, s68, 73728
  ds_read_b128 a[140:143], v3 offset:14336
  v_mfma_f32_16x16x32_bf16 v[180:183], a[128:131], a[116:119], v[180:183]
  buffer_load_dwordx4 v113, s[8:11], s66 offen lds
  v_mfma_f32_16x16x32_bf16 v[176:179], a[164:167], a[248:251], v[176:179]
  ds_read_b128 a[160:163], v3 offset:19456
  v_mfma_f32_16x16x32_bf16 v[176:179], a[128:131], a[104:107], v[176:179]
  s_waitcnt lgkmcnt(5)
  v_mfma_f32_16x16x32_bf16 v[136:139], a[132:135], a[248:251], v[136:139]
  s_waitcnt lgkmcnt(4)
  s_add_u32 m0, s68, 77824
  ds_read_b128 a[156:159], v1 offset:17408
  v_mfma_f32_16x16x32_bf16 v[136:139], a[136:139], a[104:107], v[136:139]
  buffer_load_dwordx4 v114, s[8:11], s66 offen lds
  v_mfma_f32_16x16x32_bf16 v[140:143], a[132:135], a[100:103], v[140:143]
  ds_read_b128 a[152:155], v1 offset:22528
  v_mfma_f32_16x16x32_bf16 v[140:143], a[136:139], a[116:119], v[140:143]
  s_waitcnt lgkmcnt(5)
  v_mfma_f32_16x16x32_bf16 v[188:191], a[148:151], a[100:103], v[188:191]
  s_waitcnt lgkmcnt(4)
  s_add_u32 m0, s68, 86016
  ds_read_b128 a[172:175], v3 offset:15360
  v_mfma_f32_16x16x32_bf16 v[188:191], a[144:147], a[116:119], v[188:191]
  buffer_load_dwordx4 v115, s[8:11], s66 offen lds
  v_mfma_f32_16x16x32_bf16 v[184:187], a[148:151], a[248:251], v[184:187]
  s_add_u32 m0, s68, 90112
  ds_read_b128 a[168:171], v3 offset:20480
  v_mfma_f32_16x16x32_bf16 v[184:187], a[144:147], a[104:107], v[184:187]
  s_waitcnt lgkmcnt(5)
  buffer_load_dwordx4 v116, s[8:11], s66 offen lds
  v_mfma_f32_16x16x32_bf16 v[144:147], a[140:143], a[248:251], v[144:147]
  s_waitcnt lgkmcnt(4)
  ds_read_b128 a[164:167], v1 offset:18432
  v_mfma_f32_16x16x32_bf16 v[144:147], a[160:163], a[104:107], v[144:147]
  v_mfma_f32_16x16x32_bf16 v[148:151], a[140:143], a[100:103], v[148:151]
  s_bfe_u32 s65, 0xc0a080e, s62
  ds_read_b128 a[128:131], v1 offset:23552
  v_mfma_f32_16x16x32_bf16 v[148:151], a[160:163], a[116:119], v[148:151]
  s_waitcnt lgkmcnt(5)
  s_lshl_b32 s65, s65, 13
  v_mfma_f32_16x16x32_bf16 v[36:39], a[156:159], a[100:103], v[36:39]
  s_waitcnt lgkmcnt(4)
  s_add_u32 s64, s65, s84
  ds_read_b128 a[132:135], v3 offset:16384
  v_mfma_f32_16x16x32_bf16 v[36:39], a[152:155], a[116:119], v[36:39]
  s_waitcnt vmcnt(10)
  buffer_load_dwordx4 a[176:179], v30, s[8:11], s64 offen sc1
  v_mfma_f32_16x16x32_bf16 v[32:35], a[156:159], a[248:251], v[32:35]
  ds_read_b128 a[136:139], v3 offset:21504
  v_mfma_f32_16x16x32_bf16 v[32:35], a[152:155], a[104:107], v[32:35]
  s_waitcnt lgkmcnt(5)
  s_barrier
  v_mfma_f32_16x16x32_bf16 v[152:155], a[172:175], a[248:251], v[152:155]
  s_waitcnt lgkmcnt(4)
  ds_read_b128 a[148:151], v1 offset:26624
  v_mfma_f32_16x16x32_bf16 v[152:155], a[168:171], a[104:107], v[152:155]
  buffer_load_dwordx4 a[180:183], v31, s[8:11], s64 offen sc1
  v_mfma_f32_16x16x32_bf16 v[156:159], a[172:175], a[100:103], v[156:159]
  ds_read_b128 a[144:147], v1 offset:31744
  v_mfma_f32_16x16x32_bf16 v[156:159], a[168:171], a[116:119], v[156:159]
  s_waitcnt lgkmcnt(5)
  buffer_load_dwordx4 a[184:187], v28, s[8:11], s64 offen sc1
  v_mfma_f32_16x16x32_bf16 v[44:47], a[164:167], a[100:103], v[44:47]
  s_waitcnt lgkmcnt(4)
  ds_read_b128 a[140:143], v3 offset:24576
  v_mfma_f32_16x16x32_bf16 v[44:47], a[128:131], a[116:119], v[44:47]
  buffer_load_dwordx4 a[196:199], v29, s[8:11], s64 offen sc1
  v_mfma_f32_16x16x32_bf16 v[40:43], a[164:167], a[248:251], v[40:43]
  ds_read_b128 a[160:163], v3 offset:29696
  v_mfma_f32_16x16x32_bf16 v[40:43], a[128:131], a[104:107], v[40:43]
  s_waitcnt lgkmcnt(5)
  s_bfe_u32 s67, 0x7050301, s62
  v_mfma_f32_16x16x32_bf16 v[160:163], a[132:135], a[248:251], v[160:163]
  s_waitcnt lgkmcnt(4)
  s_mul_i32 s67, s67, 20480
  ds_read_b128 a[156:159], v1 offset:27648
  v_mfma_f32_16x16x32_bf16 v[160:163], a[136:139], a[104:107], v[160:163]
  s_add_u32 s66, s67, s81
  v_mfma_f32_16x16x32_bf16 v[164:167], a[132:135], a[100:103], v[164:167]
  s_add_u32 m0, s68, 32768
  ds_read_b128 a[152:155], v2 offset:0
  v_mfma_f32_16x16x32_bf16 v[164:167], a[136:139], a[116:119], v[164:167]
  s_waitcnt lgkmcnt(5)
  s_waitcnt vmcnt(13)
  buffer_load_dwordx4 v112, s[8:11], s66 offen lds
  v_mfma_f32_16x16x32_bf16 v[172:175], a[148:151], a[120:123], v[172:175]
  s_waitcnt lgkmcnt(4)
  s_waitcnt vmcnt(13)
  ds_read_b128 a[172:175], v3 offset:25600
  v_mfma_f32_16x16x32_bf16 v[172:175], a[144:147], a[252:255], v[172:175]
  s_waitcnt vmcnt(12)
  v_mfma_f32_16x16x32_bf16 v[168:171], a[148:151], a[108:111], v[168:171]
  s_waitcnt vmcnt(11)
  s_add_u32 m0, s68, 36864
  ds_read_b128 a[168:171], v3 offset:30720
  v_mfma_f32_16x16x32_bf16 v[168:171], a[144:147], a[124:127], v[168:171]
  s_waitcnt lgkmcnt(5)
  buffer_load_dwordx4 v113, s[8:11], s66 offen lds
  v_mfma_f32_16x16x32_bf16 v[128:131], a[140:143], a[108:111], v[128:131]
  s_waitcnt lgkmcnt(4)
  ds_read_b128 a[164:167], v1 offset:28672
  v_mfma_f32_16x16x32_bf16 v[128:131], a[160:163], a[124:127], v[128:131]
  v_mfma_f32_16x16x32_bf16 v[132:135], a[140:143], a[120:123], v[132:135]
  s_add_u32 m0, s68, 81920
  ds_read_b128 a[128:131], v2 offset:1024
  v_mfma_f32_16x16x32_bf16 v[132:135], a[160:163], a[252:255], v[132:135]
  s_waitcnt lgkmcnt(5)
  buffer_load_dwordx4 v114, s[8:11], s66 offen lds
  v_mfma_f32_16x16x32_bf16 v[180:183], a[156:159], a[120:123], v[180:183]
  s_waitcnt lgkmcnt(4)
  ds_read_b128 a[132:135], v3 offset:26624
  v_mfma_f32_16x16x32_bf16 v[180:183], a[152:155], a[252:255], v[180:183]
  v_mfma_f32_16x16x32_bf16 v[176:179], a[156:159], a[108:111], v[176:179]
  s_add_u32 m0, s68, 94208
  ds_read_b128 a[136:139], v3 offset:31744
  v_mfma_f32_16x16x32_bf16 v[176:179], a[152:155], a[124:127], v[176:179]
  s_waitcnt lgkmcnt(5)
  buffer_load_dwordx4 v115, s[8:11], s66 offen lds
  v_mfma_f32_16x16x32_bf16 v[136:139], a[172:175], a[108:111], v[136:139]
  s_waitcnt lgkmcnt(4)
  ds_read_b128 a[148:151], v1 offset:29696
  v_mfma_f32_16x16x32_bf16 v[136:139], a[168:171], a[124:127], v[136:139]
  v_mfma_f32_16x16x32_bf16 v[140:143], a[172:175], a[120:123], v[140:143]
  s_add_u32 m0, s68, 98304
  ds_read_b128 a[144:147], v2 offset:2048
  v_mfma_f32_16x16x32_bf16 v[140:143], a[168:171], a[252:255], v[140:143]
  s_waitcnt lgkmcnt(5)
  buffer_load_dwordx4 v116, s[8:11], s66 offen lds
  v_mfma_f32_16x16x32_bf16 v[188:191], a[164:167], a[120:123], v[188:191]
  s_waitcnt lgkmcnt(4)
  ds_read_b128 a[140:143], v3 offset:27648
  v_mfma_f32_16x16x32_bf16 v[188:191], a[128:131], a[252:255], v[188:191]
  v_mfma_f32_16x16x32_bf16 v[184:187], a[164:167], a[108:111], v[184:187]
  s_bfe_u32 s65, 0x7050301, s62
  ds_read_b128 a[160:163], v1 offset:24576
  v_mfma_f32_16x16x32_bf16 v[184:187], a[128:131], a[124:127], v[184:187]
  s_waitcnt lgkmcnt(5)
  s_lshl_b32 s65, s65, 13
  v_mfma_f32_16x16x32_bf16 v[144:147], a[132:135], a[108:111], v[144:147]
  s_waitcnt lgkmcnt(4)
  s_waitcnt vmcnt(14)
  s_add_u32 s64, s65, s84
  ds_read_b128 a[156:159], v1 offset:30720
  v_cmp_ne_u32 vcc, v125, v126
  v_mfma_f32_16x16x32_bf16 v[144:147], a[136:139], a[124:127], v[144:147]
  buffer_load_dwordx4 a[192:195], v30, s[8:11], s64 offen sc1
  v_mfma_f32_16x16x32_bf16 v[148:151], a[132:135], a[120:123], v[148:151]
  s_cbranch_vccnz L_slow_g
L_back_g:
  ds_read_b128 a[152:155], v2 offset:3072
  v_mfma_f32_16x16x32_bf16 v[148:151], a[136:139], a[252:255], v[148:151]
  s_waitcnt lgkmcnt(5)
  v_mfma_f32_16x16x32_bf16 v[36:39], a[148:151], a[120:123], v[36:39]
  s_waitcnt lgkmcnt(4)
  s_xor_b32 s58, s58, 0x10000
  ds_read_b128 a[172:175], v3 offset:28672
  v_mfma_f32_16x16x32_bf16 v[36:39], a[144:147], a[252:255], v[36:39]
  s_waitcnt vmcnt(10)
  buffer_load_dwordx4 v[192:195], v1, s[8:11], s58 offen offset:0 sc1
  v_mfma_f32_16x16x32_bf16 v[32:35], a[148:151], a[108:111], v[32:35]
  ds_read_b128 a[168:171], v1 offset:25600
  v_mfma_f32_16x16x32_bf16 v[32:35], a[144:147], a[124:127], v[32:35]
  s_waitcnt lgkmcnt(5)
  s_barrier
  v_mfma_f32_16x16x32_bf16 v[152:155], a[140:143], a[108:111], v[152:155]
  s_waitcnt lgkmcnt(4)
  ds_read_b128 a[164:167], v2 offset:14336
  v_mfma_f32_16x16x32_bf16 v[152:155], a[160:163], a[124:127], v[152:155]
  buffer_load_dwordx4 v[196:199], v1, s[8:11], s58 offen offset:1024 sc1
  v_mfma_f32_16x16x32_bf16 v[156:159], a[140:143], a[120:123], v[156:159]
  ds_read_b128 a[128:131], v2 offset:23552
  v_mfma_f32_16x16x32_bf16 v[156:159], a[160:163], a[252:255], v[156:159]
  s_waitcnt lgkmcnt(5)
  buffer_load_dwordx4 v[200:203], v1, s[8:11], s58 offen offset:2048 sc1
  v_mfma_f32_16x16x32_bf16 v[44:47], a[156:159], a[120:123], v[44:47]
  s_waitcnt lgkmcnt(4)
  ds_read_b128 a[132:135], v2 offset:4096
  v_mfma_f32_16x16x32_bf16 v[44:47], a[152:155], a[252:255], v[44:47]
  buffer_load_dwordx4 a[188:191], v31, s[8:11], s64 offen sc1
  v_mfma_f32_16x16x32_bf16 v[40:43], a[156:159], a[108:111], v[40:43]
  ds_read_b128 a[136:139], v2 offset:9216
  v_mfma_f32_16x16x32_bf16 v[40:43], a[152:155], a[124:127], v[40:43]
  s_waitcnt lgkmcnt(5)
  buffer_load_dwordx4 a[0:3], v28, s[8:11], s64 offen sc1
  v_mfma_f32_16x16x32_bf16 v[160:163], a[172:175], a[108:111], v[160:163]
  s_waitcnt lgkmcnt(4)
  ds_read_b128 a[148:151], v2 offset:15360
  v_mfma_f32_16x16x32_bf16 v[160:163], a[168:171], a[124:127], v[160:163]
  buffer_load_dwordx4 a[16:19], v29, s[8:11], s64 offen sc1
  v_mfma_f32_16x16x32_bf16 v[164:167], a[172:175], a[120:123], v[164:167]
  ds_read_b128 a[144:147], v2 offset:24576
  v_mfma_f32_16x16x32_bf16 v[164:167], a[168:171], a[252:255], v[164:167]
  s_waitcnt lgkmcnt(5)
  s_waitcnt vmcnt(15)
  s_bfe_u32 s67, 0x1070503, s62
  v_mfma_f32_16x16x32_bf16 v[172:175], a[164:167], a[176:179], v[172:175]
  s_waitcnt lgkmcnt(4)
  s_waitcnt vmcnt(14)
  s_mul_i32 s67, s67, 20480
  ds_read_b128 a[140:143], v2 offset:5120
  v_mfma_f32_16x16x32_bf16 v[172:175], a[128:131], a[180:183], v[172:175]
  s_waitcnt vmcnt(13)
  s_add_u32 s66, s67, s81
  v_lshlrev_b32 v228, 16, v100
  v_and_b32 v229, s80, v100
  v_mfma_f32_16x16x32_bf16 v[168:171], a[164:167], a[184:187], v[168:171]
  s_waitcnt vmcnt(12)
  s_add_u32 m0, s68, 0
  ds_read_b128 a[160:163], v2 offset:10240
  v_lshlrev_b32 v230, 16, v101
  v_mfma_f32_16x16x32_bf16 v[168:171], a[128:131], a[196:199], v[168:171]
  s_waitcnt lgkmcnt(5)
  buffer_load_dwordx4 v112, s[8:11], s66 offen lds
  v_mfma_f32_16x16x32_bf16 v[128:131], a[132:135], a[184:187], v[128:131]
  s_waitcnt lgkmcnt(4)
  ds_read_b128 a[156:159], v2 offset:20480
  v_and_b32 v231, s80, v101
  v_mfma_f32_16x16x32_bf16 v[128:131], a[136:139], a[196:199], v[128:131]
  v_lshlrev_b32 v232, 16, v102
  v_and_b32 v233, s80, v102
  v_mfma_f32_16x16x32_bf16 v[132:135], a[132:135], a[176:179], v[132:135]
  s_add_u32 m0, s68, 4096
  ds_read_b128 a[152:155], v2 offset:25600
  v_lshlrev_b32 v234, 16, v103
  v_mfma_f32_16x16x32_bf16 v[132:135], a[136:139], a[180:183], v[132:135]
  s_waitcnt lgkmcnt(5)
  buffer_load_dwordx4 v113, s[8:11], s66 offen lds
  v_mfma_f32_16x16x32_bf16 v[180:183], a[148:151], a[176:179], v[180:183]
  s_waitcnt lgkmcnt(4)
  ds_read_b128 a[172:175], v2 offset:6144
  v_and_b32 v235, s80, v103
  v_mfma_f32_16x16x32_bf16 v[180:183], a[144:147], a[180:183], v[180:183]
  v_lshlrev_b32 v236, 16, v104
  v_and_b32 v237, s80, v104
  v_mfma_f32_16x16x32_bf16 v[176:179], a[148:151], a[184:187], v[176:179]
  s_add_u32 m0, s68, 40960
  ds_read_b128 a[168:171], v2 offset:11264
  v_lshlrev_b32 v238, 16, v105
  v_mfma_f32_16x16x32_bf16 v[176:179], a[144:147], a[196:199], v[176:179]
  s_waitcnt lgkmcnt(5)
  buffer_load_dwordx4 v114, s[8:11], s66 offen lds
  v_mfma_f32_16x16x32_bf16 v[136:139], a[140:143], a[184:187], v[136:139]
  s_waitcnt lgkmcnt(4)
  ds_read_b128 a[164:167], v2 offset:21504
  v_and_b32 v239, s80, v105
  v_mfma_f32_16x16x32_bf16 v[136:139], a[160:163], a[196:199], v[136:139]
  v_lshlrev_b32 v240, 16, v106
  v_and_b32 v241, s80, v106
  v_mfma_f32_16x16x32_bf16 v[140:143], a[140:143], a[176:179], v[140:143]
  s_add_u32 m0, s68, 45056
  ds_read_b128 a[128:131], v2 offset:26624
  v_lshlrev_b32 v242, 16, v107
  v_mfma_f32_16x16x32_bf16 v[140:143], a[160:163], a[180:183], v[140:143]
  s_waitcnt lgkmcnt(5)
  buffer_load_dwordx4 v115, s[8:11], s66 offen lds
  v_mfma_f32_16x16x32_bf16 v[188:191], a[156:159], a[176:179], v[188:191]
  s_waitcnt lgkmcnt(4)
  ds_read_b128 a[132:135], v2 offset:7168
  v_and_b32 v243, s80, v107
  v_mfma_f32_16x16x32_bf16 v[188:191], a[152:155], a[180:183], v[188:191]
  v_lshlrev_b32 v244, 16, v108
  v_and_b32 v245, s80, v108
  v_mfma_f32_16x16x32_bf16 v[184:187], a[156:159], a[184:187], v[184:187]
  s_add_u32 m0, s68, 49152
  ds_read_b128 a[136:139], v2 offset:12288
  v_lshlrev_b32 v246, 16, v109
  v_mfma_f32_16x16x32_bf16 v[184:187], a[152:155], a[196:199], v[184:187]
  s_waitcnt lgkmcnt(5)
  buffer_load_dwordx4 v116, s[8:11], s66 offen lds
  v_mfma_f32_16x16x32_bf16 v[144:147], a[172:175], a[184:187], v[144:147]
  s_waitcnt lgkmcnt(4)
  ds_read_b128 a[148:151], v2 offset:22528
  v_and_b32 v247, s80, v109
  v_mfma_f32_16x16x32_bf16 v[144:147], a[168:171], a[196:199], v[144:147]
  v_mfma_f32_16x16x32_bf16 v[148:151], a[172:175], a[176:179], v[148:151]
  s_bfe_u32 s65, 0x1070503, s62
  ds_read_b128 a[144:147], v2 offset:27648
  v_mfma_f32_16x16x32_bf16 v[148:151], a[168:171], a[180:183], v[148:151]
  s_waitcnt lgkmcnt(5)
  s_lshl_b32 s65, s65, 13
  v_mfma_f32_16x16x32_bf16 v[36:39], a[164:167], a[176:179], v[36:39]
  s_waitcnt lgkmcnt(4)
  s_add_u32 s64, s65, s84
  ds_read_b128 a[140:143], v2 offset:8192
  v_mfma_f32_16x16x32_bf16 v[36:39], a[128:131], a[180:183], v[36:39]
  s_waitcnt vmcnt(12)
  buffer_load_dwordx4 a[4:7], v30, s[8:11], s64 offen sc1
  v_mfma_f32_16x16x32_bf16 v[32:35], a[164:167], a[184:187], v[32:35]
  ds_read_b128 a[160:163], v2 offset:13312
  v_mfma_f32_16x16x32_bf16 v[32:35], a[128:131], a[196:199], v[32:35]
  s_waitcnt lgkmcnt(5)
  s_barrier
  v_mfma_f32_16x16x32_bf16 v[152:155], a[132:135], a[184:187], v[152:155]
  s_waitcnt lgkmcnt(4)
  ds_read_b128 a[156:159], v2 offset:18432
  v_mfma_f32_16x16x32_bf16 v[152:155], a[136:139], a[196:199], v[152:155]
  buffer_load_dwordx4 a[24:27], v31, s[8:11], s64 offen sc1
  v_mfma_f32_16x16x32_bf16 v[156:159], a[132:135], a[176:179], v[156:159]
  ds_read_b128 a[152:155], v2 offset:31744
  v_mfma_f32_16x16x32_bf16 v[156:159], a[136:139], a[180:183], v[156:159]
  s_waitcnt lgkmcnt(5)
  v_mfma_f32_16x16x32_bf16 v[44:47], a[148:151], a[176:179], v[44:47]
  s_waitcnt lgkmcnt(4)
  ds_read_b128 a[172:175], v1 offset:32768
  v_mfma_f32_16x16x32_bf16 v[44:47], a[144:147], a[180:183], v[44:47]
  buffer_load_dwordx4 a[8:11], v28, s[8:11], s64 offen sc1
  v_mfma_f32_16x16x32_bf16 v[40:43], a[148:151], a[184:187], v[40:43]
  ds_read_b128 a[168:171], v1 offset:37888
  v_mfma_f32_16x16x32_bf16 v[40:43], a[144:147], a[196:199], v[40:43]
  s_waitcnt lgkmcnt(5)
  v_mfma_f32_16x16x32_bf16 v[160:163], a[140:143], a[184:187], v[160:163]
  s_waitcnt lgkmcnt(4)
  ds_read_b128 a[164:167], v2 offset:19456
  v_mfma_f32_16x16x32_bf16 v[160:163], a[160:163], a[196:199], v[160:163]
  buffer_load_dwordx4 a[20:23], v29, s[8:11], s64 offen sc1
  v_mfma_f32_16x16x32_bf16 v[164:167], a[140:143], a[176:179], v[164:167]
  s_bfe_u32 s67, 0x3010705, s62
  s_mul_i32 s67, s67, 20480
  ds_read_b128 a[128:131], v2 offset:32768
  v_mfma_f32_16x16x32_bf16 v[164:167], a[160:163], a[180:183], v[164:167]
  s_waitcnt lgkmcnt(5)
  s_waitcnt vmcnt(15)
  s_add_u32 s66, s67, s81
  v_mfma_f32_16x16x32_bf16 v[172:175], a[156:159], a[192:195], v[172:175]
  s_waitcnt lgkmcnt(4)
  s_waitcnt vmcnt(11)
  s_add_u32 m0, s68, 8192
  ds_read_b128 a[132:135], v1 offset:33792
  v_mfma_f32_16x16x32_bf16 v[172:175], a[152:155], a[188:191], v[172:175]
  s_waitcnt vmcnt(10)
  buffer_load_dwordx4 v112, s[8:11], s66 offen lds
  v_mfma_f32_16x16x32_bf16 v[168:171], a[156:159], a[0:3], v[168:171]
  s_waitcnt vmcnt(10)
  s_add_u32 m0, s68, 12288
  ds_read_b128 a[136:139], v1 offset:38912
  v_mfma_f32_16x16x32_bf16 v[168:171], a[152:155], a[16:19], v[168:171]
  s_waitcnt lgkmcnt(5)
  buffer_load_dwordx4 v113, s[8:11], s66 offen lds
  v_mfma_f32_16x16x32_bf16 v[128:131], a[172:175], a[0:3], v[128:131]
  s_waitcnt lgkmcnt(4)
  s_add_u32 m0, s68, 53248
  ds_read_b128 a[148:151], v2 offset:28672
  v_mfma_f32_16x16x32_bf16 v[128:131], a[168:171], a[16:19], v[128:131]
  buffer_load_dwordx4 v114, s[8:11], s66 offen lds
  v_mfma_f32_16x16x32_bf16 v[132:135], a[172:175], a[192:195], v[132:135]
  s_add_u32 m0, s68, 57344
  ds_read_b128 a[144:147], v2 offset:33792
  v_mfma_f32_16x16x32_bf16 v[132:135], a[168:171], a[188:191], v[132:135]
  s_waitcnt lgkmcnt(5)
  buffer_load_dwordx4 v115, s[8:11], s66 offen lds
  v_mfma_f32_16x16x32_bf16 v[180:183], a[164:167], a[192:195], v[180:183]
  s_waitcnt lgkmcnt(4)
  ds_read_b128 a[140:143], v1 offset:34816
  v_mfma_f32_16x16x32_bf16 v[180:183], a[128:131], a[188:191], v[180:183]
  v_mfma_f32_16x16x32_bf16 v[176:179], a[164:167], a[0:3], v[176:179]
  s_add_u32 m0, s68, 61440
  ds_read_b128 a[160:163], v1 offset:39936
  v_mfma_f32_16x16x32_bf16 v[176:179], a[128:131], a[16:19], v[176:179]
  s_waitcnt lgkmcnt(5)
  buffer_load_dwordx4 v116, s[8:11], s66 offen lds
  v_mfma_f32_16x16x32_bf16 v[136:139], a[132:135], a[0:3], v[136:139]
  s_waitcnt lgkmcnt(4)
  ds_read_b128 a[156:159], v2 offset:29696
  v_mfma_f32_16x16x32_bf16 v[136:139], a[136:139], a[16:19], v[136:139]
  v_mfma_f32_16x16x32_bf16 v[140:143], a[132:135], a[192:195], v[140:143]
  s_bfe_u32 s65, 0x3010705, s62
  ds_read_b128 a[152:155], v2 offset:34816
  v_mfma_f32_16x16x32_bf16 v[140:143], a[136:139], a[188:191], v[140:143]
  s_waitcnt lgkmcnt(5)
  s_lshl_b32 s65, s65, 13
  v_mfma_f32_16x16x32_bf16 v[188:191], a[148:151], a[192:195], v[188:191]
  s_waitcnt lgkmcnt(4)
  s_add_u32 s64, s65, s84
  ds_read_b128 a[172:175], v1 offset:35840
  v_mfma_f32_16x16x32_bf16 v[188:191], a[144:147], a[188:191], v[188:191]
  buffer_load_dwordx4 a[12:15], v30, s[8:11], s64 offen sc1
  v_mfma_f32_16x16x32_bf16 v[184:187], a[148:151], a[0:3], v[184:187]
  ds_read_b128 a[168:171], v2 offset:16384
  v_mfma_f32_16x16x32_bf16 v[184:187], a[144:147], a[16:19], v[184:187]
  s_waitcnt lgkmcnt(5)
  v_mfma_f32_16x16x32_bf16 v[144:147], a[140:143], a[0:3], v[144:147]
  s_waitcnt lgkmcnt(4)
  ds_read_b128 a[164:167], v2 offset:30720
  v_mfma_f32_16x16x32_bf16 v[144:147], a[160:163], a[16:19], v[144:147]
  buffer_load_dwordx4 a[28:31], v31, s[8:11], s64 offen sc1
  v_mfma_f32_16x16x32_bf16 v[148:151], a[140:143], a[192:195], v[148:151]
  ds_read_b128 a[128:131], v2 offset:35840
  v_mfma_f32_16x16x32_bf16 v[148:151], a[160:163], a[188:191], v[148:151]
  s_waitcnt lgkmcnt(5)
  v_mfma_f32_16x16x32_bf16 v[36:39], a[156:159], a[192:195], v[36:39]
  s_waitcnt lgkmcnt(4)
  ds_read_b128 a[132:135], v1 offset:36864
  v_mfma_f32_16x16x32_bf16 v[36:39], a[152:155], a[188:191], v[36:39]
  buffer_load_dwordx4 a[32:35], v28, s[8:11], s64 offen sc1
  v_mfma_f32_16x16x32_bf16 v[32:35], a[156:159], a[0:3], v[32:35]
  ds_read_b128 a[136:139], v2 offset:17408
  v_mfma_f32_16x16x32_bf16 v[32:35], a[152:155], a[16:19], v[32:35]
  s_waitcnt lgkmcnt(5)
  v_mfma_f32_16x16x32_bf16 v[152:155], a[172:175], a[0:3], v[152:155]
  s_waitcnt lgkmcnt(4)
  v_mfma_f32_16x16x32_bf16 v[152:155], a[168:171], a[16:19], v[152:155]
  buffer_load_dwordx4 a[52:55], v29, s[8:11], s64 offen sc1
  v_mfma_f32_16x16x32_bf16 v[156:159], a[172:175], a[192:195], v[156:159]
  s_waitcnt vmcnt(13)
  v_mfma_f32_16x16x32_bf16 v[156:159], a[168:171], a[188:191], v[156:159]
  s_waitcnt lgkmcnt(3)
  v_mfma_f32_16x16x32_bf16 v[44:47], a[164:167], a[192:195], v[44:47]
  s_waitcnt lgkmcnt(2)
  s_barrier
  v_mfma_f32_16x16x32_bf16 v[44:47], a[128:131], a[188:191], v[44:47]
  s_bfe_u32 s67, 0x5030107, s62
  s_mul_i32 s67, s67, 20480
  s_add_u32 s66, s67, s81
  s_add_u32 m0, s68, 102400
  ds_read_b128 a[148:151], v1 offset:43008
  v_mfma_f32_16x16x32_bf16 v[40:43], a[164:167], a[0:3], v[40:43]
  buffer_load_dwordx4 v112, s[8:11], s66 offen lds
  v_mfma_f32_16x16x32_bf16 v[40:43], a[128:131], a[16:19], v[40:43]
  s_waitcnt lgkmcnt(2)
  ds_read_b128 a[144:147], v1 offset:48128
  v_mfma_f32_16x16x32_bf16 v[160:163], a[132:135], a[0:3], v[160:163]
  s_waitcnt lgkmcnt(2)
  v_mfma_f32_16x16x32_bf16 v[160:163], a[136:139], a[16:19], v[160:163]
  s_add_u32 m0, s68, 106496
  ds_read_b128 a[140:143], v1 offset:0
  v_mfma_f32_16x16x32_bf16 v[164:167], a[132:135], a[192:195], v[164:167]
  buffer_load_dwordx4 v113, s[8:11], s66 offen lds
  v_mfma_f32_16x16x32_bf16 v[164:167], a[136:139], a[188:191], v[164:167]
  s_mov_b32 s90, 0x8000
  ds_read_b128 a[160:163], v1 offset:5120
  v_mfma_f32_16x16x32_bf16 v[48:51], v[88:91], v[192:195], v[48:51]
  v_mfma_f32_16x16x32_bf16 v[52:55], v[92:95], v[192:195], v[52:55]
  s_add_u32 m0, s68, 110592
  ds_read_b128 a[156:159], v1 offset:44032
  v_mfma_f32_16x16x32_bf16 v[56:59], v[88:91], v[196:199], v[56:59]
  buffer_load_dwordx4 v114, s[8:11], s66 offen lds
  v_mfma_f32_16x16x32_bf16 v[60:63], v[92:95], v[196:199], v[60:63]
  ds_read_b128 a[152:155], v1 offset:49152
  v_mfma_f32_16x16x32_bf16 v[64:67], v[88:91], v[200:203], v[64:67]
  s_waitcnt lgkmcnt(5)
  s_waitcnt vmcnt(15)
  v_mfma_f32_16x16x32_bf16 v[172:175], a[148:151], a[4:7], v[172:175]
  s_waitcnt lgkmcnt(4)
  s_waitcnt vmcnt(14)
  s_add_u32 m0, s68, 114688
  ds_read_b128 a[172:175], v1 offset:1024
  v_mfma_f32_16x16x32_bf16 v[172:175], a[144:147], a[24:27], v[172:175]
  s_waitcnt vmcnt(13)
  buffer_load_dwordx4 v115, s[8:11], s66 offen lds
  v_mfma_f32_16x16x32_bf16 v[168:171], a[148:151], a[8:11], v[168:171]
  s_waitcnt vmcnt(13)
  ds_read_b128 a[168:171], v1 offset:6144
  v_mfma_f32_16x16x32_bf16 v[168:171], a[144:147], a[20:23], v[168:171]
  s_waitcnt lgkmcnt(5)
  v_mul_f32 v68, s71, v48
  v_mul_f32 v69, s71, v49
  v_mfma_f32_16x16x32_bf16 v[128:131], a[140:143], a[8:11], v[128:131]
  s_waitcnt lgkmcnt(4)
  ds_read_b128 a[164:167], v1 offset:45056
  v_mul_f32 v70, s71, v50
  v_mfma_f32_16x16x32_bf16 v[128:131], a[160:163], a[20:23], v[128:131]
  v_mul_f32 v71, s71, v51
  v_mul_f32 v72, s71, v52
  v_mfma_f32_16x16x32_bf16 v[132:135], a[140:143], a[4:7], v[132:135]
  s_add_u32 m0, s68, 118784
  ds_read_b128 a[128:131], v1 offset:50176
  v_mul_f32 v73, s71, v53
  v_mfma_f32_16x16x32_bf16 v[132:135], a[160:163], a[24:27], v[132:135]
  s_waitcnt lgkmcnt(5)
  buffer_load_dwordx4 v116, s[8:11], s66 offen lds
  v_mfma_f32_16x16x32_bf16 v[180:183], a[156:159], a[4:7], v[180:183]
  s_waitcnt lgkmcnt(4)
  s_bfe_u32 s65, 0x5030107, s62
  ds_read_b128 a[132:135], v1 offset:2048
  v_mul_f32 v74, s71, v54
  v_mfma_f32_16x16x32_bf16 v[180:183], a[152:155], a[24:27], v[180:183]
  s_lshl_b32 s65, s65, 13
  v_mul_f32 v75, s71, v55
  v_mul_f32 v76, s71, v56
  v_mfma_f32_16x16x32_bf16 v[176:179], a[156:159], a[8:11], v[176:179]
  s_add_u32 s64, s65, s84
  ds_read_b128 a[136:139], v1 offset:7168
  v_mul_f32 v77, s71, v57
  v_mfma_f32_16x16x32_bf16 v[176:179], a[152:155], a[20:23], v[176:179]
  s_waitcnt lgkmcnt(5)
  buffer_load_dwordx4 a[36:39], v30, s[8:11], s64 offen sc1
  v_mfma_f32_16x16x32_bf16 v[136:139], a[172:175], a[8:11], v[136:139]
  s_waitcnt lgkmcnt(4)
  ds_read_b128 a[148:151], v1 offset:46080
  v_mul_f32 v78, s71, v58
  v_mfma_f32_16x16x32_bf16 v[136:139], a[168:171], a[20:23], v[136:139]
  v_mul_f32 v79, s71, v59
  v_mul_f32 v80, s71, v60
  v_mfma_f32_16x16x32_bf16 v[140:143], a[172:175], a[4:7], v[140:143]
  ds_read_b128 a[144:147], v1 offset:51200
  v_mul_f32 v81, s71, v61
  v_mfma_f32_16x16x32_bf16 v[140:143], a[168:171], a[24:27], v[140:143]
  s_waitcnt lgkmcnt(5)
  buffer_load_dwordx4 a[48:51], v31, s[8:11], s64 offen sc1
  v_mfma_f32_16x16x32_bf16 v[188:191], a[164:167], a[4:7], v[188:191]
  s_waitcnt lgkmcnt(4)
  ds_read_b128 a[140:143], v1 offset:3072
  v_mul_f32 v82, s71, v62
  v_mfma_f32_16x16x32_bf16 v[188:191], a[128:131], a[24:27], v[188:191]
  v_mul_f32 v83, s71, v63
  v_mul_f32 v84, s71, v64
  v_mfma_f32_16x16x32_bf16 v[184:187], a[164:167], a[8:11], v[184:187]
  ds_read_b128 a[160:163], v1 offset:40960
  v_mul_f32 v85, s71, v65
  v_mfma_f32_16x16x32_bf16 v[184:187], a[128:131], a[20:23], v[184:187]
  s_waitcnt lgkmcnt(5)
  buffer_load_dwordx4 a[40:43], v28, s[8:11], s64 offen sc1
  v_mfma_f32_16x16x32_bf16 v[144:147], a[132:135], a[8:11], v[144:147]
  s_waitcnt lgkmcnt(4)
  ds_read_b128 a[156:159], v1 offset:47104
  v_mul_f32 v86, s71, v66
  v_mfma_f32_16x16x32_bf16 v[144:147], a[136:139], a[20:23], v[144:147]
  v_mul_f32 v87, s71, v67
  v_mfma_f32_16x16x32_bf16 v[148:151], a[132:135], a[4:7], v[148:151]
  ds_read_b128 a[152:155], v1 offset:52224
  v_mfma_f32_16x16x32_bf16 v[148:151], a[136:139], a[24:27], v[148:151]
  s_waitcnt lgkmcnt(5)
  buffer_load_dwordx4 a[56:59], v29, s[8:11], s64 offen sc1
  v_mfma_f32_16x16x32_bf16 v[36:39], a[148:151], a[4:7], v[36:39]
  s_waitcnt lgkmcnt(4)
  s_bfe_u32 s67, 0xf0d0b09, s62
  s_mul_i32 s67, s67, 20480
  ds_read_b128 a[172:175], v1 offset:4096
  v_mfma_f32_16x16x32_bf16 v[36:39], a[144:147], a[24:27], v[36:39]
  s_add_u32 s66, s67, s81
  v_exp_f32 v68, v68
  v_mfma_f32_16x16x32_bf16 v[32:35], a[148:151], a[8:11], v[32:35]
  s_add_u32 m0, s68, 122880
  ds_read_b128 a[168:171], v1 offset:41984
  v_mfma_f32_16x16x32_bf16 v[32:35], a[144:147], a[20:23], v[32:35]
  s_waitcnt lgkmcnt(5)
  s_waitcnt vmcnt(13)
  buffer_load_dwordx4 v112, s[8:11], s66 offen lds
  v_mfma_f32_16x16x32_bf16 v[152:155], a[140:143], a[8:11], v[152:155]
  s_waitcnt lgkmcnt(4)
  v_exp_f32 v69, v69
  v_mfma_f32_16x16x32_bf16 v[152:155], a[160:163], a[20:23], v[152:155]
  s_barrier
  v_mfma_f32_16x16x32_bf16 v[156:159], a[140:143], a[4:7], v[156:159]
  ds_read_b128 a[164:167], v1 offset:55296
  v_mfma_f32_16x16x32_bf16 v[156:159], a[160:163], a[24:27], v[156:159]
  s_waitcnt lgkmcnt(4)
  s_add_u32 m0, s68, 126976
  ds_read_b128 a[128:131], v1 offset:60416
  v_mfma_f32_16x16x32_bf16 v[44:47], a[156:159], a[4:7], v[44:47]
  s_waitcnt lgkmcnt(4)
  buffer_load_dwordx4 v113, s[8:11], s66 offen lds
  v_mfma_f32_16x16x32_bf16 v[44:47], a[152:155], a[24:27], v[44:47]
  v_exp_f32 v70, v70
  v_mfma_f32_16x16x32_bf16 v[40:43], a[156:159], a[8:11], v[40:43]
  ds_read_b128 a[132:135], v1 offset:8192
  v_mfma_f32_16x16x32_bf16 v[40:43], a[152:155], a[20:23], v[40:43]
  s_waitcnt lgkmcnt(4)
  ds_read_b128 a[136:139], v1 offset:13312
  v_mfma_f32_16x16x32_bf16 v[160:163], a[172:175], a[8:11], v[160:163]
  s_waitcnt lgkmcnt(4)
  ds_read_b128 a[148:151], v1 offset:56320
  v_mfma_f32_16x16x32_bf16 v[160:163], a[168:171], a[20:23], v[160:163]
  s_add_u32 m0, s68, 131072
  ds_read_b128 a[144:147], v1 offset:61440
  v_mfma_f32_16x16x32_bf16 v[164:167], a[172:175], a[4:7], v[164:167]
  buffer_load_dwordx4 v114, s[8:11], s66 offen lds
  v_mfma_f32_16x16x32_bf16 v[164:167], a[168:171], a[24:27], v[164:167]
  s_waitcnt lgkmcnt(5)
  s_waitcnt vmcnt(15)
  s_and_b32 s61, s2, 0xf9
  s_lshl_b32 s61, s61, 7
  v_exp_f32 v71, v71
  v_mfma_f32_16x16x32_bf16 v[172:175], a[164:167], a[12:15], v[172:175]
  s_waitcnt lgkmcnt(4)
  s_waitcnt vmcnt(14)
  s_add_u32 s61, s61, 0x300000
  ds_read_b128 a[140:143], v1 offset:9216
  v_exp_f32 v72, v72
  v_mfma_f32_16x16x32_bf16 v[172:175], a[128:131], a[28:31], v[172:175]
  s_waitcnt vmcnt(13)
  ds_read_b128 a[160:163], v1 offset:14336
  buffer_load_dword v126, v10, s[8:11], s61 offen sc1
  v_exp_f32 v73, v73
  v_mfma_f32_16x16x32_bf16 v[168:171], a[164:167], a[32:35], v[168:171]
  s_waitcnt vmcnt(13)
  s_add_u32 m0, s68, 135168
  ds_read_b128 a[156:159], v1 offset:57344
  buffer_load_dwordx4 v115, s[8:11], s66 offen lds
  v_exp_f32 v74, v74
  v_mfma_f32_16x16x32_bf16 v[168:171], a[128:131], a[52:55], v[168:171]
  s_waitcnt lgkmcnt(6)
  s_add_u32 m0, s68, 139264
  ds_read_b128 a[152:155], v1 offset:62464
  buffer_load_dwordx4 v116, s[8:11], s66 offen lds
  v_exp_f32 v75, v75
  v_mfma_f32_16x16x32_bf16 v[132:135], a[132:135], a[12:15], v[132:135]
  s_waitcnt lgkmcnt(6)
  s_bfe_u32 s65, 0xf0d0b09, s62
  v_exp_f32 v76, v76
  v_mfma_f32_16x16x32_bf16 v[132:135], a[136:139], a[28:31], v[132:135]
  s_waitcnt lgkmcnt(5)
  s_lshl_b32 s65, s65, 13
  v_exp_f32 v77, v77
  v_mfma_f32_16x16x32_bf16 v[180:183], a[148:151], a[12:15], v[180:183]
  s_waitcnt lgkmcnt(4)
  s_add_u32 s64, s65, s84
  ds_read_b128 a[172:175], v1 offset:10240
  v_exp_f32 v78, v78
  v_mfma_f32_16x16x32_bf16 v[180:183], a[144:147], a[28:31], v[180:183]
  ds_read_b128 a[168:171], v1 offset:15360
  buffer_load_dwordx4 a[44:47], v30, s[8:11], s64 offen sc1
  v_exp_f32 v79, v79
  v_mfma_f32_16x16x32_bf16 v[176:179], a[148:151], a[32:35], v[176:179]
  ds_read_b128 a[164:167], v1 offset:58368
  v_exp_f32 v80, v80
  v_mfma_f32_16x16x32_bf16 v[176:179], a[144:147], a[52:55], v[176:179]
  s_waitcnt lgkmcnt(6)
  ds_read_b128 a[128:131], v1 offset:63488
  v_exp_f32 v81, v81
  v_mfma_f32_16x16x32_bf16 v[140:143], a[140:143], a[12:15], v[140:143]
  s_waitcnt lgkmcnt(6)
  buffer_load_dwordx4 a[204:207], v31, s[8:11], s64 offen sc1
  v_exp_f32 v82, v82
  v_mfma_f32_16x16x32_bf16 v[140:143], a[160:163], a[28:31], v[140:143]
  s_waitcnt lgkmcnt(5)
  v_exp_f32 v83, v83
  v_mfma_f32_16x16x32_bf16 v[188:191], a[156:159], a[12:15], v[188:191]
  s_waitcnt lgkmcnt(4)
  ds_read_b128 a[132:135], v1 offset:11264
  buffer_load_dwordx4 a[200:203], v28, s[8:11], s64 offen sc1
  v_exp_f32 v84, v84
  v_mfma_f32_16x16x32_bf16 v[188:191], a[152:155], a[28:31], v[188:191]
  ds_read_b128 a[136:139], v1 offset:53248
  buffer_load_dwordx4 a[60:63], v29, s[8:11], s64 offen sc1
  v_exp_f32 v85, v85
  v_mfma_f32_16x16x32_bf16 v[184:187], a[156:159], a[32:35], v[184:187]
  s_bfe_u32 s67, 0x90f0d0b, s62
  s_mul_i32 s67, s67, 20480
  ds_read_b128 a[148:151], v1 offset:59392
  v_exp_f32 v86, v86
  v_mfma_f32_16x16x32_bf16 v[184:187], a[152:155], a[52:55], v[184:187]
  s_waitcnt lgkmcnt(6)
  s_add_u32 s66, s67, s81
  ds_read_b128 a[144:147], v1 offset:64512
  v_exp_f32 v87, v87
  v_mfma_f32_16x16x32_bf16 v[148:151], a[172:175], a[12:15], v[148:151]
  s_waitcnt lgkmcnt(6)
  s_add_u32 m0, s68, 16384
  v_fma_f32 v68, v68, s89, s89
  v_fma_f32 v69, v69, s89, s89
  v_mfma_f32_16x16x32_bf16 v[148:151], a[168:171], a[28:31], v[148:151]
  s_waitcnt lgkmcnt(5)
  s_waitcnt vmcnt(14)
  buffer_load_dwordx4 v112, s[8:11], s66 offen lds
  v_fma_f32 v70, v70, s89, s89
  v_fma_f32 v71, v71, s89, s89
  v_mfma_f32_16x16x32_bf16 v[36:39], a[164:167], a[12:15], v[36:39]
  s_waitcnt lgkmcnt(4)
  ds_read_b128 a[140:143], v1 offset:12288
  v_fma_f32 v72, v72, s89, s89
  v_fma_f32 v73, v73, s89, s89
  v_mfma_f32_16x16x32_bf16 v[36:39], a[128:131], a[28:31], v[36:39]
  s_barrier
  ds_read_b128 a[160:163], v1 offset:54272
  v_mfma_f32_16x16x32_bf16 v[32:35], a[164:167], a[32:35], v[32:35]
  s_add_u32 m0, s68, 20480
  ds_read_b128 a[156:159], v2 offset:47104
  buffer_load_dwordx4 v113, s[8:11], s66 offen lds
  v_fma_f32 v74, v74, s89, s89
  v_fma_f32 v75, v75, s89, s89
  v_mfma_f32_16x16x32_bf16 v[32:35], a[128:131], a[52:55], v[32:35]
  s_waitcnt lgkmcnt(6)
  ds_read_b128 a[152:155], v2 offset:52224
  v_fma_f32 v76, v76, s89, s89
  v_fma_f32 v77, v77, s89, s89
  v_mfma_f32_16x16x32_bf16 v[156:159], a[132:135], a[12:15], v[156:159]
  s_waitcnt lgkmcnt(6)
  v_fma_f32 v78, v78, s89, s89
  v_fma_f32 v79, v79, s89, s89
  v_mfma_f32_16x16x32_bf16 v[156:159], a[136:139], a[28:31], v[156:159]
  s_waitcnt lgkmcnt(5)
  s_add_u32 m0, s68, 143360
  v_fma_f32 v80, v80, s89, s89
  v_fma_f32 v81, v81, s89, s89
  v_mfma_f32_16x16x32_bf16 v[44:47], a[148:151], a[12:15], v[44:47]
  s_waitcnt lgkmcnt(4)
  ds_read_b128 a[172:175], v2 offset:36864
  buffer_load_dwordx4 v114, s[8:11], s66 offen lds
  v_fma_f32 v82, v82, s89, s89
  v_fma_f32 v83, v83, s89, s89
  v_mfma_f32_16x16x32_bf16 v[44:47], a[144:147], a[28:31], v[44:47]
  ds_read_b128 a[168:171], v2 offset:41984
  v_fma_f32 v84, v84, s89, s89
  v_fma_f32 v85, v85, s89, s89
  v_mfma_f32_16x16x32_bf16 v[40:43], a[148:151], a[32:35], v[40:43]
  s_add_u32 m0, s68, 147456
  ds_read_b128 a[164:167], v2 offset:48128
  v_fma_f32 v86, v86, s89, s89
  v_fma_f32 v87, v87, s89, s89
  v_mfma_f32_16x16x32_bf16 v[40:43], a[144:147], a[52:55], v[40:43]
  s_waitcnt lgkmcnt(6)
  ds_read_b128 a[128:131], v2 offset:53248
  buffer_load_dwordx4 v115, s[8:11], s66 offen lds
  v_rcp_f32 v68, v68
  v_mfma_f32_16x16x32_bf16 v[164:167], a[140:143], a[12:15], v[164:167]
  s_waitcnt lgkmcnt(6)
  v_rcp_f32 v69, v69
  v_mfma_f32_16x16x32_bf16 v[164:167], a[160:163], a[28:31], v[164:167]
  s_waitcnt lgkmcnt(5)
  s_waitcnt vmcnt(17)
  v_rcp_f32 v70, v70
  v_mfma_f32_16x16x32_bf16 v[172:175], a[156:159], a[36:39], v[172:175]
  s_waitcnt lgkmcnt(4)
  s_waitcnt vmcnt(16)
  s_add_u32 m0, s68, 151552
  ds_read_b128 a[132:135], v2 offset:37888
  v_rcp_f32 v71, v71
  v_mfma_f32_16x16x32_bf16 v[172:175], a[152:155], a[48:51], v[172:175]
  s_waitcnt vmcnt(15)
  ds_read_b128 a[136:139], v2 offset:43008
  buffer_load_dwordx4 v116, s[8:11], s66 offen lds
  v_rcp_f32 v72, v72
  v_mfma_f32_16x16x32_bf16 v[168:171], a[156:159], a[40:43], v[168:171]
  s_waitcnt vmcnt(15)
  s_bfe_u32 s65, 0x90f0d0b, s62
  s_lshl_b32 s65, s65, 13
  ds_read_b128 a[148:151], v2 offset:49152
  v_rcp_f32 v73, v73
  v_mfma_f32_16x16x32_bf16 v[168:171], a[152:155], a[56:59], v[168:171]
  s_waitcnt lgkmcnt(6)
  s_add_u32 s64, s65, s84
  ds_read_b128 a[144:147], v2 offset:54272
  v_rcp_f32 v74, v74
  v_mfma_f32_16x16x32_bf16 v[132:135], a[172:175], a[36:39], v[132:135]
  s_waitcnt lgkmcnt(6)
  buffer_load_dwordx4 a[216:219], v30, s[8:11], s64 offen sc1
  v_rcp_f32 v75, v75
  v_mfma_f32_16x16x32_bf16 v[132:135], a[168:171], a[48:51], v[132:135]
  s_waitcnt lgkmcnt(5)
  v_rcp_f32 v76, v76
  v_mfma_f32_16x16x32_bf16 v[180:183], a[164:167], a[36:39], v[180:183]
  s_waitcnt lgkmcnt(4)
  ds_read_b128 a[140:143], v2 offset:38912
  v_rcp_f32 v77, v77
  v_mfma_f32_16x16x32_bf16 v[180:183], a[128:131], a[48:51], v[180:183]
  ds_read_b128 a[160:163], v2 offset:44032
  v_rcp_f32 v78, v78
  v_mfma_f32_16x16x32_bf16 v[176:179], a[164:167], a[40:43], v[176:179]
  ds_read_b128 a[156:159], v2 offset:50176
  buffer_load_dwordx4 a[212:215], v31, s[8:11], s64 offen sc1
  v_rcp_f32 v79, v79
  v_mfma_f32_16x16x32_bf16 v[176:179], a[128:131], a[56:59], v[176:179]
  s_waitcnt lgkmcnt(6)
  ds_read_b128 a[152:155], v2 offset:55296
  v_rcp_f32 v80, v80
  v_mfma_f32_16x16x32_bf16 v[140:143], a[132:135], a[36:39], v[140:143]
  s_waitcnt lgkmcnt(6)
  v_rcp_f32 v81, v81
  v_mfma_f32_16x16x32_bf16 v[140:143], a[136:139], a[48:51], v[140:143]
  s_waitcnt lgkmcnt(5)
  buffer_load_dwordx4 a[208:211], v28, s[8:11], s64 offen sc1
  v_rcp_f32 v82, v82
  v_mfma_f32_16x16x32_bf16 v[188:191], a[148:151], a[36:39], v[188:191]
  s_waitcnt lgkmcnt(4)
  ds_read_b128 a[172:175], v2 offset:39936
  buffer_load_dwordx4 a[220:223], v29, s[8:11], s64 offen sc1
  v_rcp_f32 v83, v83
  v_mfma_f32_16x16x32_bf16 v[188:191], a[144:147], a[48:51], v[188:191]
  s_bfe_u32 s67, 0xb090f0d, s62
  s_mul_i32 s67, s67, 20480
  ds_read_b128 a[168:171], v2 offset:45056
  v_rcp_f32 v84, v84
  v_mfma_f32_16x16x32_bf16 v[184:187], a[148:151], a[40:43], v[184:187]
  s_add_u32 s66, s67, s81
  ds_read_b128 a[164:167], v2 offset:51200
  v_rcp_f32 v85, v85
  v_mfma_f32_16x16x32_bf16 v[184:187], a[144:147], a[56:59], v[184:187]
  s_waitcnt lgkmcnt(6)
  s_add_u32 m0, s68, 24576
  ds_read_b128 a[128:131], v2 offset:56320
  v_rcp_f32 v86, v86
  v_mfma_f32_16x16x32_bf16 v[148:151], a[140:143], a[36:39], v[148:151]
  s_waitcnt lgkmcnt(6)
  buffer_load_dwordx4 v112, s[8:11], s66 offen lds
  v_rcp_f32 v87, v87
  v_mfma_f32_16x16x32_bf16 v[148:151], a[160:163], a[48:51], v[148:151]
  s_waitcnt lgkmcnt(5)
  s_waitcnt vmcnt(14)
  v_mul_f32 v48, v48, v68
  v_mul_f32 v49, v49, v69
  v_mfma_f32_16x16x32_bf16 v[36:39], a[156:159], a[36:39], v[36:39]
  s_waitcnt lgkmcnt(4)
  ds_read_b128 a[132:135], v2 offset:40960
  v_mul_f32 v50, v50, v70
  v_mul_f32 v51, v51, v71
  v_mfma_f32_16x16x32_bf16 v[36:39], a[152:155], a[48:51], v[36:39]
  s_barrier
  ds_read_b128 a[136:139], v2 offset:46080
  v_mfma_f32_16x16x32_bf16 v[32:35], a[156:159], a[40:43], v[32:35]
  s_add_u32 m0, s68, 28672
  ds_read_b128 a[148:151], v3 offset:2048
  buffer_load_dwordx4 v113, s[8:11], s66 offen lds
  v_mul_f32 v52, v52, v72
  v_mul_f32 v53, v53, v73
  v_mfma_f32_16x16x32_bf16 v[32:35], a[152:155], a[56:59], v[32:35]
  s_waitcnt lgkmcnt(6)
  ds_read_b128 a[144:147], v3 offset:7168
  v_mul_f32 v54, v54, v74
  v_mul_f32 v55, v55, v75
  v_mfma_f32_16x16x32_bf16 v[156:159], a[172:175], a[36:39], v[156:159]
  s_waitcnt lgkmcnt(6)
  s_add_u32 m0, s68, 65536
  v_mul_f32 v56, v56, v76
  v_mul_f32 v57, v57, v77
  v_mfma_f32_16x16x32_bf16 v[156:159], a[168:171], a[48:51], v[156:159]
  s_waitcnt lgkmcnt(5)
  buffer_load_dwordx4 v114, s[8:11], s66 offen lds
  v_mul_f32 v58, v58, v78
  v_mul_f32 v59, v59, v79
  v_mfma_f32_16x16x32_bf16 v[44:47], a[164:167], a[36:39], v[44:47]
  s_waitcnt lgkmcnt(4)
  ds_read_b128 a[140:143], v2 offset:57344
  v_mul_f32 v60, v60, v80
  v_mul_f32 v61, v61, v81
  v_mfma_f32_16x16x32_bf16 v[44:47], a[128:131], a[48:51], v[44:47]
  s_add_u32 m0, s68, 155648
  ds_read_b128 a[160:163], v2 offset:62464
  v_mul_f32 v62, v62, v82
  v_mul_f32 v63, v63, v83
  v_mfma_f32_16x16x32_bf16 v[40:43], a[164:167], a[40:43], v[40:43]
  ds_read_b128 a[156:159], v3 offset:3072
  buffer_load_dwordx4 v115, s[8:11], s66 offen lds
  v_mul_f32 v64, v64, v84
  v_mul_f32 v65, v65, v85
  v_mfma_f32_16x16x32_bf16 v[40:43], a[128:131], a[56:59], v[40:43]
  s_waitcnt lgkmcnt(6)
  ds_read_b128 a[152:155], v3 offset:8192
  v_mul_f32 v66, v66, v86
  v_mul_f32 v67, v67, v87
  v_mfma_f32_16x16x32_bf16 v[164:167], a[132:135], a[36:39], v[164:167]
  s_waitcnt lgkmcnt(6)
  v_mfma_f32_16x16x32_bf16 v[164:167], a[136:139], a[48:51], v[164:167]
  s_waitcnt lgkmcnt(5)
  s_waitcnt vmcnt(16)
  s_add_u32 m0, s68, 159744
  v_mfma_f32_16x16x32_bf16 v[172:175], a[148:151], a[44:47], v[172:175]
  s_waitcnt lgkmcnt(4)
  s_waitcnt vmcnt(15)
  ds_read_b128 a[172:175], v2 offset:58368
  buffer_load_dwordx4 v116, s[8:11], s66 offen lds
  v_cmp_ne_u32 vcc, v125, v126
  v_mfma_f32_16x16x32_bf16 v[172:175], a[144:147], a[204:207], v[172:175]
  s_waitcnt vmcnt(15)
  s_bfe_u32 s67, 0xd0b090f, s62
  s_mul_i32 s67, s67, 20480
  s_add_u32 s66, s67, s81
  s_add_u32 m0, s68, 32768
  ds_read_b128 a[168:171], v2 offset:63488
  buffer_load_dwordx4 v112, s[8:11], s66 offen lds
  v_mfma_f32_16x16x32_bf16 v[168:171], a[148:151], a[200:203], v[168:171]
  s_waitcnt vmcnt(15)
  s_cbranch_vccnz L_slow_m
L_back_m:
  s_mov_b32 s90, 0x8000
  ds_read_b128 a[164:167], v3 offset:4096
  v_mfma_f32_16x16x32_bf16 v[168:171], a[144:147], a[60:63], v[168:171]
  s_waitcnt lgkmcnt(6)
  s_add_u32 m0, s68, 69632
  ds_read_b128 a[128:131], v3 offset:9216
  buffer_load_dwordx4 v113, s[8:11], s66 offen lds
  v_mfma_f32_16x16x32_bf16 v[132:135], a[140:143], a[44:47], v[132:135]
  s_waitcnt lgkmcnt(6)
  s_add_u32 m0, s68, 73728
  s_nop 0
  buffer_load_dwordx4 v114, s[8:11], s66 offen lds
  v_mfma_f32_16x16x32_bf16 v[132:135], a[160:163], a[204:207], v[132:135]
  s_waitcnt lgkmcnt(5)
  s_add_u32 m0, s68, 77824
  s_nop 0
  buffer_load_dwordx4 v115, s[8:11], s66 offen lds
  v_mfma_f32_16x16x32_bf16 v[180:183], a[156:159], a[44:47], v[180:183]
  s_waitcnt lgkmcnt(4)
  s_add_u32 m0, s68, 86016
  ds_read_b128 a[132:135], v2 offset:59392
  buffer_load_dwordx4 v116, s[8:11], s66 offen lds
  v_mfma_f32_16x16x32_bf16 v[180:183], a[152:155], a[204:207], v[180:183]
  s_bfe_u32 s65, 0xb090f0d, s62
  ds_read_b128 a[136:139], v2 offset:64512
  v_mfma_f32_16x16x32_bf16 v[176:179], a[156:159], a[200:203], v[176:179]
  s_lshl_b32 s65, s65, 13
  ds_read_b128 a[148:151], v3 offset:5120
  v_mfma_f32_16x16x32_bf16 v[176:179], a[152:155], a[60:63], v[176:179]
  s_waitcnt lgkmcnt(6)
  s_add_u32 s64, s65, s84
  ds_read_b128 a[144:147], v3 offset:10240
  v_mfma_f32_16x16x32_bf16 v[140:143], a[172:175], a[44:47], v[140:143]
  s_waitcnt lgkmcnt(6)
  buffer_load_dwordx4 a[68:71], v30, s[8:11], s64 offen sc1
  v_mfma_f32_16x16x32_bf16 v[140:143], a[168:171], a[204:207], v[140:143]
  s_waitcnt lgkmcnt(5)
  v_mfma_f32_16x16x32_bf16 v[188:191], a[164:167], a[44:47], v[188:191]
  s_waitcnt lgkmcnt(4)
  ds_read_b128 a[140:143], v2 offset:60416
  v_mfma_f32_16x16x32_bf16 v[188:191], a[128:131], a[204:207], v[188:191]
  ds_read_b128 a[160:163], v3 offset:0
  buffer_load_dwordx4 a[84:87], v31, s[8:11], s64 offen sc1
  v_mfma_f32_16x16x32_bf16 v[184:187], a[164:167], a[200:203], v[184:187]
  ds_read_b128 a[156:159], v3 offset:6144
  v_mfma_f32_16x16x32_bf16 v[184:187], a[128:131], a[60:63], v[184:187]
  s_waitcnt lgkmcnt(6)
  ds_read_b128 a[152:155], v3 offset:11264
  v_mfma_f32_16x16x32_bf16 v[148:151], a[132:135], a[44:47], v[148:151]
  s_waitcnt lgkmcnt(6)
  v_mfma_f32_16x16x32_bf16 v[148:151], a[136:139], a[204:207], v[148:151]
  s_waitcnt lgkmcnt(5)
  s_waitcnt vmcnt(16)
  buffer_load_dwordx4 a[64:67], v28, s[8:11], s64 offen sc1
  v_mfma_f32_16x16x32_bf16 v[36:39], a[148:151], a[44:47], v[36:39]
  s_waitcnt lgkmcnt(4)
  ds_read_b128 a[172:175], v2 offset:61440
  buffer_load_dwordx4 a[80:83], v29, s[8:11], s64 offen sc1
  v_mfma_f32_16x16x32_bf16 v[36:39], a[144:147], a[204:207], v[36:39]
  s_barrier
  ds_read_b128 a[168:171], v3 offset:1024
  v_mfma_f32_16x16x32_bf16 v[32:35], a[148:151], a[200:203], v[32:35]
  s_bfe_u32 s65, 0xd0b090f, s62
  s_lshl_b32 s65, s65, 13
  s_add_u32 s64, s65, s84
  ds_read_b128 a[164:167], v3 offset:14336
  buffer_load_dwordx4 a[224:227], v30, s[8:11], s64 offen sc1
  v_mfma_f32_16x16x32_bf16 v[32:35], a[144:147], a[60:63], v[32:35]
  s_waitcnt lgkmcnt(6)
  ds_read_b128 a[128:131], v3 offset:19456
  buffer_load_dwordx4 a[228:231], v31, s[8:11], s64 offen sc1
  v_mfma_f32_16x16x32_bf16 v[156:159], a[140:143], a[44:47], v[156:159]
  s_waitcnt lgkmcnt(6)
  buffer_load_dwordx4 a[72:75], v28, s[8:11], s64 offen sc1
  v_mfma_f32_16x16x32_bf16 v[156:159], a[160:163], a[204:207], v[156:159]
  s_waitcnt lgkmcnt(5)
  buffer_load_dwordx4 a[88:91], v29, s[8:11], s64 offen sc1
  v_mfma_f32_16x16x32_bf16 v[44:47], a[156:159], a[44:47], v[44:47]
  s_waitcnt lgkmcnt(4)
  ds_read_b128 a[132:135], v1 offset:16384
  v_mfma_f32_16x16x32_bf16 v[44:47], a[152:155], a[204:207], v[44:47]
  ds_read_b128 a[136:139], v1 offset:21504
  v_mfma_f32_16x16x32_bf16 v[40:43], a[156:159], a[200:203], v[40:43]
  ds_read_b128 a[148:151], v3 offset:15360
  v_mfma_f32_16x16x32_bf16 v[40:43], a[152:155], a[60:63], v[40:43]
  s_waitcnt lgkmcnt(6)
  ds_read_b128 a[144:147], v3 offset:20480
  v_mfma_f32_16x16x32_bf16 v[164:167], a[172:175], a[44:47], v[164:167]
  s_waitcnt lgkmcnt(6)
  v_mfma_f32_16x16x32_bf16 v[164:167], a[168:171], a[204:207], v[164:167]
  s_waitcnt lgkmcnt(5)
  s_waitcnt vmcnt(21)
  v_mfma_f32_16x16x32_bf16 v[172:175], a[164:167], a[216:219], v[172:175]
  s_waitcnt lgkmcnt(4)
  s_waitcnt vmcnt(20)
  ds_read_b128 a[140:143], v1 offset:17408
  v_mfma_f32_16x16x32_bf16 v[172:175], a[128:131], a[212:215], v[172:175]
  s_waitcnt vmcnt(19)
  ds_read_b128 a[160:163], v1 offset:22528
  v_mfma_f32_16x16x32_bf16 v[168:171], a[164:167], a[208:211], v[168:171]
  s_waitcnt vmcnt(18)
  ds_read_b128 a[156:159], v3 offset:16384
  v_mfma_f32_16x16x32_bf16 v[168:171], a[128:131], a[220:223], v[168:171]
  s_waitcnt lgkmcnt(6)
  ds_read_b128 a[152:155], v3 offset:21504
  v_mfma_f32_16x16x32_bf16 v[132:135], a[132:135], a[216:219], v[132:135]
  s_waitcnt lgkmcnt(6)
  v_mfma_f32_16x16x32_bf16 v[132:135], a[136:139], a[212:215], v[132:135]
  s_waitcnt lgkmcnt(5)
  v_mfma_f32_16x16x32_bf16 v[180:183], a[148:151], a[216:219], v[180:183]
  s_waitcnt lgkmcnt(4)
  ds_read_b128 a[172:175], v1 offset:18432
  v_mfma_f32_16x16x32_bf16 v[180:183], a[144:147], a[212:215], v[180:183]
  ds_read_b128 a[168:171], v1 offset:23552
  v_mfma_f32_16x16x32_bf16 v[176:179], a[148:151], a[208:211], v[176:179]
  ds_read_b128 a[164:167], v3 offset:17408
  v_mfma_f32_16x16x32_bf16 v[176:179], a[144:147], a[220:223], v[176:179]
  s_waitcnt lgkmcnt(6)
  ds_read_b128 a[128:131], v3 offset:22528
  v_mfma_f32_16x16x32_bf16 v[140:143], a[140:143], a[216:219], v[140:143]
  s_waitcnt lgkmcnt(6)
  v_mfma_f32_16x16x32_bf16 v[140:143], a[160:163], a[212:215], v[140:143]
  s_waitcnt lgkmcnt(5)
  v_mfma_f32_16x16x32_bf16 v[188:191], a[156:159], a[216:219], v[188:191]
  s_waitcnt lgkmcnt(4)
  ds_read_b128 a[132:135], v1 offset:19456
  v_mfma_f32_16x16x32_bf16 v[188:191], a[152:155], a[212:215], v[188:191]
  ds_read_b128 a[136:139], v3 offset:12288
  v_mfma_f32_16x16x32_bf16 v[184:187], a[156:159], a[208:211], v[184:187]
  ds_read_b128 a[148:151], v3 offset:18432
  v_mfma_f32_16x16x32_bf16 v[184:187], a[152:155], a[220:223], v[184:187]
  s_waitcnt lgkmcnt(6)
  ds_read_b128 a[144:147], v3 offset:23552
  v_mfma_f32_16x16x32_bf16 v[148:151], a[172:175], a[216:219], v[148:151]
  s_waitcnt lgkmcnt(6)
  s_waitcnt vmcnt(8)
  v_mfma_f32_16x16x32_bf16 v[148:151], a[168:171], a[212:215], v[148:151]
  s_waitcnt lgkmcnt(5)
  v_mfma_f32_16x16x32_bf16 v[36:39], a[164:167], a[216:219], v[36:39]
  s_waitcnt lgkmcnt(4)
  s_barrier
  ds_read_b128 a[140:143], v1 offset:20480
  v_mfma_f32_16x16x32_bf16 v[36:39], a[128:131], a[212:215], v[36:39]
  ds_read_b128 a[160:163], v3 offset:13312
  ds_read_b128 a[156:159], v2 offset:2048
  v_mfma_f32_16x16x32_bf16 v[32:35], a[164:167], a[208:211], v[32:35]
  ds_read_b128 a[152:155], v3 offset:27648
  v_mfma_f32_16x16x32_bf16 v[32:35], a[128:131], a[220:223], v[32:35]
  s_waitcnt lgkmcnt(7)
  v_mfma_f32_16x16x32_bf16 v[156:159], a[132:135], a[216:219], v[156:159]
  s_waitcnt lgkmcnt(6)
  ds_read_b128 a[172:175], v2 offset:10240
  v_mfma_f32_16x16x32_bf16 v[156:159], a[136:139], a[212:215], v[156:159]
  s_waitcnt lgkmcnt(6)
  v_mfma_f32_16x16x32_bf16 v[44:47], a[148:151], a[216:219], v[44:47]
  s_waitcnt lgkmcnt(5)
  ds_read_b128 a[168:171], v2 offset:15360
  v_mfma_f32_16x16x32_bf16 v[44:47], a[144:147], a[212:215], v[44:47]
  v_mfma_f32_16x16x32_bf16 v[40:43], a[148:151], a[208:211], v[40:43]
  ds_read_b128 a[164:167], v2 offset:3072
  v_mfma_f32_16x16x32_bf16 v[40:43], a[144:147], a[220:223], v[40:43]
  s_waitcnt lgkmcnt(6)
  v_mfma_f32_16x16x32_bf16 v[164:167], a[140:143], a[216:219], v[164:167]
  s_waitcnt lgkmcnt(5)
  ds_read_b128 a[128:131], v3 offset:28672
  v_mfma_f32_16x16x32_bf16 v[164:167], a[160:163], a[212:215], v[164:167]
  s_waitcnt lgkmcnt(5)
  s_waitcnt vmcnt(5)
  v_mfma_f32_16x16x32_bf16 v[168:171], a[156:159], a[64:67], v[168:171]
  s_waitcnt lgkmcnt(4)
  s_waitcnt vmcnt(4)
  ds_read_b128 a[132:135], v2 offset:11264
  v_mfma_f32_16x16x32_bf16 v[168:171], a[152:155], a[80:83], v[168:171]
  s_waitcnt lgkmcnt(4)
  s_waitcnt vmcnt(1)
  v_mfma_f32_16x16x32_bf16 v[168:171], a[172:175], a[72:75], v[168:171]
  s_waitcnt lgkmcnt(3)
  s_waitcnt vmcnt(0)
  ds_read_b128 a[136:139], v2 offset:20480
  v_mfma_f32_16x16x32_bf16 v[168:171], a[168:171], a[88:91], v[168:171]
  v_mfma_f32_16x16x32_bf16 v[172:175], a[168:171], a[228:231], v[172:175]
  ds_read_b128 a[148:151], v3 offset:24576
  v_mfma_f32_16x16x32_bf16 v[172:175], a[172:175], a[224:227], v[172:175]
  v_mfma_f32_16x16x32_bf16 v[172:175], a[152:155], a[84:87], v[172:175]
  ds_read_b128 a[144:147], v3 offset:29696
  v_mfma_f32_16x16x32_bf16 v[172:175], a[156:159], a[68:71], v[172:175]
  s_waitcnt lgkmcnt(5)
  v_mfma_f32_16x16x32_bf16 v[180:183], a[164:167], a[68:71], v[180:183]
  s_waitcnt lgkmcnt(4)
  ds_read_b128 a[140:143], v2 offset:12288
  v_mfma_f32_16x16x32_bf16 v[180:183], a[128:131], a[84:87], v[180:183]
  s_waitcnt lgkmcnt(4)
  v_mfma_f32_16x16x32_bf16 v[180:183], a[132:135], a[224:227], v[180:183]
  s_waitcnt lgkmcnt(3)
  ds_read_b128 a[160:163], v2 offset:21504
  v_mfma_f32_16x16x32_bf16 v[180:183], a[136:139], a[228:231], v[180:183]
  v_mfma_f32_16x16x32_bf16 v[176:179], a[136:139], a[88:91], v[176:179]
  ds_read_b128 a[168:171], v3 offset:25600
  v_mfma_f32_16x16x32_bf16 v[176:179], a[132:135], a[72:75], v[176:179]
  v_mfma_f32_16x16x32_bf16 v[176:179], a[128:131], a[80:83], v[176:179]
  ds_read_b128 a[172:175], v3 offset:30720
  v_cvt_pk_bf16_f32 v172, v172, v173
  v_cvt_pk_bf16_f32 v173, v174, v175
  v_mfma_f32_16x16x32_bf16 v[176:179], a[164:167], a[64:67], v[176:179]
  s_waitcnt lgkmcnt(5)
  v_cvt_pk_bf16_f32 v174, v180, v181
  v_cvt_pk_bf16_f32 v175, v182, v183
  v_mfma_f32_16x16x32_bf16 v[184:187], a[148:151], a[64:67], v[184:187]
  s_waitcnt lgkmcnt(4)
  ds_read_b128 a[152:155], v2 offset:13312
  buffer_store_dwordx4 v[172:175], v124, s[8:11], s88 offen offset:0 sc1
  v_mfma_f32_16x16x32_bf16 v[184:187], a[144:147], a[80:83], v[184:187]
  s_waitcnt lgkmcnt(4)
  v_mfma_f32_16x16x32_bf16 v[184:187], a[140:143], a[72:75], v[184:187]
  s_waitcnt lgkmcnt(3)
  ds_read_b128 a[156:159], v2 offset:22528
  v_cvt_pk_bf16_f32 v168, v168, v169
  v_cvt_pk_bf16_f32 v169, v170, v171
  v_mfma_f32_16x16x32_bf16 v[184:187], a[160:163], a[88:91], v[184:187]
  v_cvt_pk_bf16_f32 v170, v176, v177
  v_cvt_pk_bf16_f32 v171, v178, v179
  v_mfma_f32_16x16x32_bf16 v[188:191], a[160:163], a[228:231], v[188:191]
  ds_read_b128 a[136:139], v3 offset:26624
  buffer_store_dwordx4 v[168:171], v1, s[8:11], s88 offen offset:0 sc1
  v_mfma_f32_16x16x32_bf16 v[188:191], a[140:143], a[224:227], v[188:191]
  v_mfma_f32_16x16x32_bf16 v[188:191], a[144:147], a[84:87], v[188:191]
  ds_read_b128 a[132:135], v3 offset:31744
  v_mfma_f32_16x16x32_bf16 v[188:191], a[148:151], a[68:71], v[188:191]
  s_waitcnt lgkmcnt(5)
  v_mfma_f32_16x16x32_bf16 v[36:39], a[168:171], a[68:71], v[36:39]
  s_waitcnt lgkmcnt(4)
  ds_read_b128 a[128:131], v2 offset:14336
  v_mfma_f32_16x16x32_bf16 v[36:39], a[172:175], a[84:87], v[36:39]
  s_waitcnt lgkmcnt(4)
  v_mfma_f32_16x16x32_bf16 v[36:39], a[152:155], a[224:227], v[36:39]
  s_waitcnt lgkmcnt(3)
  ds_read_b128 a[164:167], v2 offset:23552
  v_mfma_f32_16x16x32_bf16 v[36:39], a[156:159], a[228:231], v[36:39]
  v_mfma_f32_16x16x32_bf16 v[32:35], a[156:159], a[88:91], v[32:35]
  ds_read_b128 a[160:163], v1 offset:28672
  v_mfma_f32_16x16x32_bf16 v[32:35], a[152:155], a[72:75], v[32:35]
  v_mfma_f32_16x16x32_bf16 v[32:35], a[172:175], a[80:83], v[32:35]
  ds_read_b128 a[140:143], v2 offset:1024
  v_cvt_pk_bf16_f32 v188, v188, v189
  v_cvt_pk_bf16_f32 v189, v190, v191
  v_mfma_f32_16x16x32_bf16 v[32:35], a[168:171], a[64:67], v[32:35]
  s_waitcnt lgkmcnt(5)
  v_cvt_pk_bf16_f32 v190, v36, v37
  v_cvt_pk_bf16_f32 v191, v38, v39
  v_mfma_f32_16x16x32_bf16 v[40:43], a[136:139], a[64:67], v[40:43]
  s_waitcnt lgkmcnt(4)
  ds_read_b128 a[144:147], v2 offset:4096
  buffer_store_dwordx4 v[188:191], v124, s[8:11], s88 offen offset:1024 sc1
  v_mfma_f32_16x16x32_bf16 v[40:43], a[132:135], a[80:83], v[40:43]
  s_waitcnt lgkmcnt(4)
  v_mfma_f32_16x16x32_bf16 v[40:43], a[128:131], a[72:75], v[40:43]
  s_waitcnt lgkmcnt(3)
  ds_read_b128 a[148:151], v2 offset:9216
  ds_read_b128 a[156:159], v2 offset:5120
  v_cvt_pk_bf16_f32 v184, v184, v185
  v_cvt_pk_bf16_f32 v185, v186, v187
  v_mfma_f32_16x16x32_bf16 v[40:43], a[164:167], a[88:91], v[40:43]
  ds_read_b128 a[152:155], v1 offset:32768
  v_cvt_pk_bf16_f32 v186, v32, v33
  v_cvt_pk_bf16_f32 v187, v34, v35
  v_mfma_f32_16x16x32_bf16 v[44:47], a[164:167], a[228:231], v[44:47]
  ds_read_b128 a[172:175], v1 offset:29696
  buffer_store_dwordx4 v[184:187], v1, s[8:11], s88 offen offset:1024 sc1
  v_mfma_f32_16x16x32_bf16 v[44:47], a[128:131], a[224:227], v[44:47]
  v_mfma_f32_16x16x32_bf16 v[44:47], a[132:135], a[84:87], v[44:47]
  ds_read_b128 a[168:171], v1 offset:24576
  ds_read_b128 a[164:167], v1 offset:25600
  v_mfma_f32_16x16x32_bf16 v[44:47], a[136:139], a[68:71], v[44:47]
  s_waitcnt lgkmcnt(8)
  ds_read_b128 a[128:131], v1 offset:30720
  v_mfma_f32_16x16x32_bf16 v[164:167], a[160:163], a[68:71], v[164:167]
  s_waitcnt lgkmcnt(8)
  ds_read_b128 a[132:135], v1 offset:33792
  v_mfma_f32_16x16x32_bf16 v[164:167], a[140:143], a[84:87], v[164:167]
  s_waitcnt lgkmcnt(8)
  v_mfma_f32_16x16x32_bf16 v[164:167], a[144:147], a[224:227], v[164:167]
  s_waitcnt lgkmcnt(7)
  ds_read_b128 a[136:139], v2 offset:6144
  ds_read_b128 a[160:163], v2 offset:7168
  v_cvt_pk_bf16_f32 v40, v40, v41
  v_cvt_pk_bf16_f32 v41, v42, v43
  v_mfma_f32_16x16x32_bf16 v[164:167], a[148:151], a[228:231], v[164:167]
  s_waitcnt lgkmcnt(8)
  ds_read_b128 a[140:143], v1 offset:34816
  v_cvt_pk_bf16_f32 v42, v44, v45
  v_cvt_pk_bf16_f32 v43, v46, v47
  v_mfma_f32_16x16x32_bf16 v[132:135], a[156:159], a[228:231], v[132:135]
  s_waitcnt lgkmcnt(8)
  ds_read_b128 a[144:147], v1 offset:31744
  buffer_store_dwordx4 v[40:43], v124, s[8:11], s88 offen offset:3072 sc1
  v_mfma_f32_16x16x32_bf16 v[132:135], a[152:155], a[224:227], v[132:135]
  s_waitcnt lgkmcnt(8)
  v_mfma_f32_16x16x32_bf16 v[132:135], a[172:175], a[84:87], v[132:135]
  s_waitcnt lgkmcnt(7)
  ds_read_b128 a[148:151], v1 offset:26624
  ds_read_b128 a[156:159], v1 offset:27648
  v_cvt_pk_bf16_f32 v164, v164, v165
  v_cvt_pk_bf16_f32 v165, v166, v167
  v_mfma_f32_16x16x32_bf16 v[132:135], a[168:171], a[68:71], v[132:135]
  s_waitcnt lgkmcnt(8)
  ds_read_b128 a[152:155], v2 offset:0
  v_mov_b32 v166, v164
  v_mov_b32 v167, v165
  v_mfma_f32_16x16x32_bf16 v[140:143], a[164:167], a[68:71], v[140:143]
  s_waitcnt lgkmcnt(8)
  ds_read_b128 a[172:175], v1 offset:35840
  buffer_store_dwordx4 v[164:167], v124, s[8:11], s88 offen offset:2048 sc1
  v_mfma_f32_16x16x32_bf16 v[140:143], a[128:131], a[84:87], v[140:143]
  s_waitcnt lgkmcnt(8)
  v_mfma_f32_16x16x32_bf16 v[140:143], a[132:135], a[224:227], v[140:143]
  s_waitcnt lgkmcnt(7)
  ds_read_b128 a[168:171], v2 offset:8192
  ds_read_b128 a[164:167], v1 offset:8192
  v_mfma_f32_16x16x32_bf16 v[140:143], a[136:139], a[228:231], v[140:143]
  s_waitcnt lgkmcnt(8)
  ds_read_b128 a[128:131], v1 offset:13312
  v_mfma_f32_16x16x32_bf16 v[148:151], a[160:163], a[228:231], v[148:151]
  s_waitcnt lgkmcnt(8)
  ds_read_b128 a[132:135], v2 offset:36864
  v_mfma_f32_16x16x32_bf16 v[148:151], a[140:143], a[224:227], v[148:151]
  s_waitcnt lgkmcnt(8)
  ds_read_b128 a[136:139], v2 offset:41984
  v_mfma_f32_16x16x32_bf16 v[148:151], a[144:147], a[84:87], v[148:151]
  s_waitcnt lgkmcnt(8)
  ds_read_b128 a[160:163], v2 offset:57344
  v_cvt_pk_bf16_f32 v132, v132, v133
  v_cvt_pk_bf16_f32 v133, v134, v135
  v_mfma_f32_16x16x32_bf16 v[148:151], a[148:151], a[68:71], v[148:151]
  s_waitcnt lgkmcnt(8)
  ds_read_b128 a[140:143], v2 offset:62464
  v_cvt_pk_bf16_f32 v134, v140, v141
  v_cvt_pk_bf16_f32 v135, v142, v143
  v_mfma_f32_16x16x32_bf16 v[156:159], a[156:159], a[68:71], v[156:159]
  s_waitcnt lgkmcnt(8)
  ds_read_b128 a[144:147], v1 offset:16384
  buffer_store_dwordx4 v[132:135], v1, s[8:11], s88 offen offset:2048 sc1
  v_mfma_f32_16x16x32_bf16 v[156:159], a[152:155], a[84:87], v[156:159]
  s_waitcnt lgkmcnt(8)
  ds_read_b128 a[148:151], v1 offset:21504
  v_mfma_f32_16x16x32_bf16 v[156:159], a[172:175], a[224:227], v[156:159]
  s_waitcnt lgkmcnt(8)
  ds_read_b128 a[156:159], v1 offset:24576
  v_mfma_f32_16x16x32_bf16 v[156:159], a[168:171], a[228:231], v[156:159]
  s_waitcnt lgkmcnt(8)
  ds_read_b128 a[152:155], v1 offset:29696
  v_mfma_f32_16x16x32_bf16 v[128:131], a[164:167], a[32:35], v[128:131]
  s_waitcnt lgkmcnt(8)
  ds_read_b128 a[172:175], v1 offset:32768
  v_mfma_f32_16x16x32_bf16 v[128:131], a[128:131], a[52:55], v[128:131]
  s_waitcnt lgkmcnt(8)
  ds_read_b128 a[168:171], v2 offset:5120
  v_mfma_f32_16x16x32_bf16 v[128:131], a[132:135], a[40:43], v[128:131]
  s_waitcnt lgkmcnt(8)
  ds_read_b128 a[164:167], v1 offset:9216
  v_cvt_pk_bf16_f32 v148, v148, v149
  v_cvt_pk_bf16_f32 v149, v150, v151
  v_mfma_f32_16x16x32_bf16 v[128:131], a[136:139], a[56:59], v[128:131]
  s_waitcnt lgkmcnt(8)
  ds_read_b128 a[128:131], v1 offset:14336
  v_cvt_pk_bf16_f32 v150, v156, v157
  v_cvt_pk_bf16_f32 v151, v158, v159
  v_mfma_f32_16x16x32_bf16 v[128:131], a[160:163], a[200:203], v[128:131]
  s_waitcnt lgkmcnt(8)
  ds_read_b128 a[132:135], v2 offset:37888
  buffer_store_dwordx4 v[148:151], v1, s[8:11], s88 offen offset:3072 sc1
  v_mfma_f32_16x16x32_bf16 v[128:131], a[140:143], a[60:63], v[128:131]
  s_waitcnt lgkmcnt(8)
  ds_read_b128 a[136:139], v2 offset:43008
  v_mfma_f32_16x16x32_bf16 v[128:131], a[144:147], a[208:211], v[128:131]
  s_waitcnt lgkmcnt(8)
  ds_read_b128 a[160:163], v2 offset:58368
  v_mfma_f32_16x16x32_bf16 v[128:131], a[148:151], a[220:223], v[128:131]
  s_waitcnt lgkmcnt(8)
  ds_read_b128 a[140:143], v2 offset:63488
  v_mfma_f32_16x16x32_bf16 v[128:131], a[156:159], a[64:67], v[128:131]
  s_waitcnt lgkmcnt(8)
  ds_read_b128 a[144:147], v1 offset:17408
  v_mfma_f32_16x16x32_bf16 v[128:131], a[152:155], a[80:83], v[128:131]
  s_waitcnt lgkmcnt(8)
  ds_read_b128 a[148:151], v1 offset:22528
  v_mfma_f32_16x16x32_bf16 v[128:131], a[172:175], a[72:75], v[128:131]
  s_waitcnt lgkmcnt(8)
  ds_read_b128 a[156:159], v1 offset:25600
  v_mfma_f32_16x16x32_bf16 v[128:131], a[168:171], a[88:91], v[128:131]
  s_waitcnt lgkmcnt(8)
  ds_read_b128 a[152:155], v1 offset:30720
  v_mfma_f32_16x16x32_bf16 v[136:139], a[164:167], a[32:35], v[136:139]
  s_waitcnt lgkmcnt(8)
  ds_read_b128 a[172:175], v1 offset:33792
  v_mfma_f32_16x16x32_bf16 v[136:139], a[128:131], a[52:55], v[136:139]
  s_waitcnt lgkmcnt(8)
  ds_read_b128 a[168:171], v2 offset:6144
  v_mfma_f32_16x16x32_bf16 v[136:139], a[132:135], a[40:43], v[136:139]
  s_waitcnt lgkmcnt(8)
  ds_read_b128 a[164:167], v1 offset:10240
  v_mfma_f32_16x16x32_bf16 v[136:139], a[136:139], a[56:59], v[136:139]
  s_waitcnt lgkmcnt(8)
  ds_read_b128 a[128:131], v1 offset:15360
  v_mfma_f32_16x16x32_bf16 v[136:139], a[160:163], a[200:203], v[136:139]
  s_waitcnt lgkmcnt(8)
  ds_read_b128 a[132:135], v2 offset:38912
  v_mfma_f32_16x16x32_bf16 v[136:139], a[140:143], a[60:63], v[136:139]
  s_waitcnt lgkmcnt(8)
  ds_read_b128 a[136:139], v2 offset:44032
  v_mfma_f32_16x16x32_bf16 v[136:139], a[144:147], a[208:211], v[136:139]
  s_waitcnt lgkmcnt(8)
  ds_read_b128 a[160:163], v2 offset:59392
  v_mfma_f32_16x16x32_bf16 v[136:139], a[148:151], a[220:223], v[136:139]
  s_waitcnt lgkmcnt(8)
  ds_read_b128 a[140:143], v2 offset:64512
  v_mfma_f32_16x16x32_bf16 v[136:139], a[156:159], a[64:67], v[136:139]
  s_waitcnt lgkmcnt(8)
  ds_read_b128 a[144:147], v1 offset:18432
  v_mfma_f32_16x16x32_bf16 v[136:139], a[152:155], a[80:83], v[136:139]
  s_waitcnt lgkmcnt(8)
  ds_read_b128 a[148:151], v1 offset:23552
  v_mfma_f32_16x16x32_bf16 v[136:139], a[172:175], a[72:75], v[136:139]
  s_waitcnt lgkmcnt(8)
  ds_read_b128 a[156:159], v1 offset:26624
  v_mfma_f32_16x16x32_bf16 v[136:139], a[168:171], a[88:91], v[136:139]
  s_waitcnt lgkmcnt(8)
  ds_read_b128 a[152:155], v1 offset:31744
  v_mfma_f32_16x16x32_bf16 v[144:147], a[164:167], a[32:35], v[144:147]
  s_waitcnt lgkmcnt(8)
  ds_read_b128 a[172:175], v1 offset:34816
  v_mfma_f32_16x16x32_bf16 v[144:147], a[128:131], a[52:55], v[144:147]
  s_waitcnt lgkmcnt(8)
  ds_read_b128 a[168:171], v2 offset:7168
  v_mfma_f32_16x16x32_bf16 v[144:147], a[132:135], a[40:43], v[144:147]
  s_waitcnt lgkmcnt(8)
  ds_read_b128 a[164:167], v1 offset:11264
  v_mfma_f32_16x16x32_bf16 v[144:147], a[136:139], a[56:59], v[144:147]
  s_waitcnt lgkmcnt(8)
  ds_read_b128 a[128:131], v1 offset:53248
  v_mfma_f32_16x16x32_bf16 v[144:147], a[160:163], a[200:203], v[144:147]
  s_waitcnt lgkmcnt(8)
  ds_read_b128 a[132:135], v2 offset:39936
  v_mfma_f32_16x16x32_bf16 v[144:147], a[140:143], a[60:63], v[144:147]
  s_waitcnt lgkmcnt(8)
  ds_read_b128 a[136:139], v2 offset:45056
  v_mfma_f32_16x16x32_bf16 v[144:147], a[144:147], a[208:211], v[144:147]
  s_waitcnt lgkmcnt(8)
  ds_read_b128 a[160:163], v2 offset:60416
  v_mfma_f32_16x16x32_bf16 v[144:147], a[148:151], a[220:223], v[144:147]
  s_waitcnt lgkmcnt(8)
  ds_read_b128 a[140:143], v3 offset:0
  v_mfma_f32_16x16x32_bf16 v[144:147], a[156:159], a[64:67], v[144:147]
  s_waitcnt lgkmcnt(8)
  ds_read_b128 a[144:147], v1 offset:19456
  v_mfma_f32_16x16x32_bf16 v[144:147], a[152:155], a[80:83], v[144:147]
  s_waitcnt lgkmcnt(8)
  ds_read_b128 a[148:151], v3 offset:12288
  v_mfma_f32_16x16x32_bf16 v[144:147], a[172:175], a[72:75], v[144:147]
  s_waitcnt lgkmcnt(8)
  ds_read_b128 a[156:159], v1 offset:27648
  v_mfma_f32_16x16x32_bf16 v[144:147], a[168:171], a[88:91], v[144:147]
  s_waitcnt lgkmcnt(8)
  ds_read_b128 a[152:155], v2 offset:0
  v_mfma_f32_16x16x32_bf16 v[152:155], a[164:167], a[32:35], v[152:155]
  s_waitcnt lgkmcnt(8)
  ds_read_b128 a[172:175], v1 offset:35840
  v_mfma_f32_16x16x32_bf16 v[152:155], a[128:131], a[52:55], v[152:155]
  s_waitcnt lgkmcnt(8)
  ds_read_b128 a[168:171], v2 offset:8192
  v_mfma_f32_16x16x32_bf16 v[152:155], a[132:135], a[40:43], v[152:155]
  s_waitcnt lgkmcnt(8)
  ds_read_b128 a[164:167], v1 offset:12288
  v_mfma_f32_16x16x32_bf16 v[152:155], a[136:139], a[56:59], v[152:155]
  s_waitcnt lgkmcnt(8)
  s_xor_b32 s58, s88, 0x10000
  ds_read_b128 a[128:131], v1 offset:54272
  v_mfma_f32_16x16x32_bf16 v[152:155], a[160:163], a[200:203], v[152:155]
  s_waitcnt lgkmcnt(8)
  ds_read_b128 a[132:135], v2 offset:40960
  buffer_load_dwordx4 v[192:195], v1, s[8:11], s58 offen offset:0 sc1
  v_mfma_f32_16x16x32_bf16 v[152:155], a[140:143], a[60:63], v[152:155]
  s_waitcnt lgkmcnt(8)
  ds_read_b128 a[136:139], v2 offset:46080
  buffer_load_dwordx4 v[196:199], v1, s[8:11], s58 offen offset:1024 sc1
  v_mfma_f32_16x16x32_bf16 v[152:155], a[144:147], a[208:211], v[152:155]
  s_waitcnt lgkmcnt(8)
  ds_read_b128 a[160:163], v2 offset:61440
  buffer_load_dwordx4 v[200:203], v124, s[8:11], s58 offen offset:3072 sc1
  v_mfma_f32_16x16x32_bf16 v[152:155], a[148:151], a[220:223], v[152:155]
  s_waitcnt lgkmcnt(8)
  s_xor_b32 s58, s88, 0x30000
  ds_read_b128 a[140:143], v3 offset:1024
  buffer_load_dwordx4 v[216:219], v124, s[8:11], s58 offen offset:0 sc1
  v_mfma_f32_16x16x32_bf16 v[152:155], a[156:159], a[64:67], v[152:155]
  s_waitcnt lgkmcnt(8)
  ds_read_b128 a[144:147], v1 offset:20480
  buffer_load_dwordx4 v[220:223], v124, s[8:11], s58 offen offset:1024 sc1
  v_mfma_f32_16x16x32_bf16 v[152:155], a[152:155], a[80:83], v[152:155]
  s_waitcnt lgkmcnt(8)
  ds_read_b128 a[148:151], v3 offset:13312
  buffer_load_dwordx4 v[224:227], v124, s[8:11], s58 offen offset:3072 sc1
  v_mfma_f32_16x16x32_bf16 v[152:155], a[172:175], a[72:75], v[152:155]
  s_waitcnt lgkmcnt(8)
  s_xor_b32 s58, s88, 0x20000
  ds_read_b128 a[156:159], v1 offset:28672
  buffer_load_dwordx4 v[204:207], v1, s[8:11], s58 offen offset:2048 sc1
  v_mfma_f32_16x16x32_bf16 v[152:155], a[168:171], a[88:91], v[152:155]
  s_waitcnt lgkmcnt(8)
  ds_read_b128 a[152:155], v2 offset:1024
  buffer_load_dwordx4 v[208:211], v1, s[8:11], s58 offen offset:3072 sc1
  v_mfma_f32_16x16x32_bf16 v[160:163], a[164:167], a[32:35], v[160:163]
  s_waitcnt lgkmcnt(8)
  ds_read_b128 a[172:175], v2 offset:4096
  buffer_load_dwordx4 v[212:215], v124, s[8:11], s58 offen offset:2048 sc1
  v_mfma_f32_16x16x32_bf16 v[160:163], a[128:131], a[52:55], v[160:163]
  s_waitcnt lgkmcnt(8)
  ds_read_b128 a[168:171], v2 offset:9216
  v_mfma_f32_16x16x32_bf16 v[160:163], a[132:135], a[40:43], v[160:163]
  s_waitcnt lgkmcnt(8)
  v_mfma_f32_16x16x32_bf16 v[160:163], a[136:139], a[56:59], v[160:163]
  s_waitcnt lgkmcnt(7)
  v_mfma_f32_16x16x32_bf16 v[160:163], a[160:163], a[200:203], v[160:163]
  s_waitcnt lgkmcnt(6)
  v_mfma_f32_16x16x32_bf16 v[160:163], a[140:143], a[60:63], v[160:163]
  s_waitcnt lgkmcnt(5)
  v_mfma_f32_16x16x32_bf16 v[160:163], a[144:147], a[208:211], v[160:163]
  s_waitcnt lgkmcnt(4)
  v_mfma_f32_16x16x32_bf16 v[160:163], a[148:151], a[220:223], v[160:163]
  s_waitcnt lgkmcnt(3)
  v_mfma_f32_16x16x32_bf16 v[160:163], a[156:159], a[64:67], v[160:163]
  s_waitcnt lgkmcnt(2)
  v_mfma_f32_16x16x32_bf16 v[160:163], a[152:155], a[80:83], v[160:163]
  s_waitcnt lgkmcnt(1)
  v_mfma_f32_16x16x32_bf16 v[160:163], a[172:175], a[72:75], v[160:163]
  s_waitcnt lgkmcnt(0)
  v_mfma_f32_16x16x32_bf16 v[160:163], a[168:171], a[88:91], v[160:163]
L_back_p:
  s_waitcnt vmcnt(6)
  v_mfma_f32_16x16x32_bf16 v[68:71], v[88:91], v[192:195], v[128:131]
  v_max_u32 v96, v192, v193
  v_max3_u32 v96, v96, v194, v195
  v_mfma_f32_16x16x32_bf16 v[72:75], v[92:95], v[192:195], v[136:139]
  v_max3_u32 v96, v96, v196, v197
  v_max3_u32 v96, v96, v198, v199
  v_mfma_f32_16x16x32_bf16 v[76:79], v[88:91], v[196:199], v[144:147]
  v_max3_u32 v96, v96, v200, v201
  v_max3_u32 v96, v96, v202, v203
  v_mfma_f32_16x16x32_bf16 v[80:83], v[92:95], v[196:199], v[152:155]
  v_mfma_f32_16x16x32_bf16 v[84:87], v[88:91], v[200:203], v[160:163]
  s_waitcnt vmcnt(3)
  v_mfma_f32_16x16x32_bf16 v[68:71], v[88:91], v[216:219], v[68:71]
  v_max3_u32 v96, v96, v216, v217
  v_max3_u32 v96, v96, v218, v219
  v_mfma_f32_16x16x32_bf16 v[72:75], v[92:95], v[216:219], v[72:75]
  v_max3_u32 v96, v96, v220, v221
  v_max3_u32 v96, v96, v222, v223
  v_mfma_f32_16x16x32_bf16 v[76:79], v[88:91], v[220:223], v[76:79]
  v_max3_u32 v96, v96, v224, v225
  v_max3_u32 v96, v96, v226, v227
  v_mfma_f32_16x16x32_bf16 v[80:83], v[92:95], v[220:223], v[80:83]
  v_mfma_f32_16x16x32_bf16 v[84:87], v[92:95], v[224:227], v[84:87]
  s_waitcnt vmcnt(0)
  v_mfma_f32_16x16x32_bf16 v[68:71], v[88:91], v[204:207], v[68:71]
  v_max3_u32 v96, v96, v204, v205
  v_max3_u32 v96, v96, v206, v207
  v_mfma_f32_16x16x32_bf16 v[72:75], v[92:95], v[204:207], v[72:75]
  v_max3_u32 v96, v96, v208, v209
  v_max3_u32 v96, v96, v210, v211
  v_mfma_f32_16x16x32_bf16 v[76:79], v[88:91], v[208:211], v[76:79]
  v_max3_u32 v96, v96, v212, v213
  v_max3_u32 v96, v96, v214, v215
  v_mfma_f32_16x16x32_bf16 v[80:83], v[92:95], v[208:211], v[80:83]
  v_cmp_eq_u32 vcc, -1, v96
  v_mfma_f32_16x16x32_bf16 v[84:87], v[88:91], v[212:215], v[84:87]
  s_nop 0
  s_cbranch_vccnz L_slow_p
L_done_p:
  v_pk_fma_f32 v[228:229], v[68:69], v[48:49], v[228:229]
  v_pk_fma_f32 v[230:231], v[70:71], v[50:51], v[230:231]
  v_cvt_pk_bf16_f32 v100, v228, v229
  v_cvt_pk_bf16_f32 v101, v230, v231
  v_pk_fma_f32 v[232:233], v[72:73], v[52:53], v[232:233]
  v_pk_fma_f32 v[234:235], v[74:75], v[54:55], v[234:235]
  v_cvt_pk_bf16_f32 v102, v232, v233
  v_cvt_pk_bf16_f32 v103, v234, v235
  buffer_store_dwordx4 v[100:103], v15, s[16:19], s100 offen offset:0
  v_pk_fma_f32 v[236:237], v[76:77], v[56:57], v[236:237]
  v_pk_fma_f32 v[238:239], v[78:79], v[58:59], v[238:239]
  v_cvt_pk_bf16_f32 v104, v236, v237
  v_cvt_pk_bf16_f32 v105, v238, v239
  v_pk_fma_f32 v[240:241], v[80:81], v[60:61], v[240:241]
  v_pk_fma_f32 v[242:243], v[82:83], v[62:63], v[242:243]
  v_cvt_pk_bf16_f32 v106, v240, v241
  v_cvt_pk_bf16_f32 v107, v242, v243
  buffer_store_dwordx4 v[104:107], v15, s[16:19], s100 offen offset:64
  v_pk_fma_f32 v[244:245], v[84:85], v[64:65], v[244:245]
  v_pk_fma_f32 v[246:247], v[86:87], v[66:67], v[246:247]
  v_cvt_pk_bf16_f32 v108, v244, v245
  v_cvt_pk_bf16_f32 v109, v246, v247
  buffer_store_dwordx2 v[108:109], v11, s[16:19], s100 offen offset:0
L_a_end:
  s_endpgm
L_slow_w:
  s_mov_b32 s90, 0x8000
L_spin_w:
  s_sleep 2
  buffer_load_dwordx4 v[12:15], v1, s[8:11], s61 offen sc1
  s_waitcnt vmcnt(0)
  v_xor_b32 v13, v12, v13
  v_xor_b32 v14, v12, v14
  v_xor_b32 v15, v12, v15
  v_xor_b32 v12, v12, v125
  v_or3_b32 v13, v13, v14, v15
  v_or_b32 v12, v12, v13
  v_cmp_ne_u32 vcc, 0, v12
  s_nop 1
  s_sub_u32 s90, s90, 1
  s_cbranch_scc1 L_back_w
  s_cbranch_vccnz L_spin_w
  s_branch L_back_w
L_slow_o:
  s_mov_b32 s90, 0x8000
L_spin_o:
  s_sleep 2
  buffer_load_dword v126, v122, s[8:11], s61 offen sc1
  s_waitcnt vmcnt(0)
  v_cmp_ne_u32 vcc, v125, v126
  s_nop 1
  s_sub_u32 s90, s90, 1
  s_cbranch_scc1 L_back_o
  s_cbranch_vccnz L_spin_o
  s_branch L_back_o
L_slow_q:
  s_mov_b32 s90, 0x8000
L_spin_q:
  s_sleep 2
  buffer_load_dword v126, v122, s[8:11], s61 offen sc1
  s_waitcnt vmcnt(0)
  v_cmp_ne_u32 vcc, v125, v126
  s_nop 1
  s_sub_u32 s90, s90, 1
  s_cbranch_scc1 L_back_q
  s_cbranch_vccnz L_spin_q
  s_branch L_back_q
L_slow_g:
  s_mov_b32 s90, 0x8000
L_spin_g:
  s_sleep 2
  buffer_load_dword v126, v117, s[8:11], s61 offen sc1
  s_waitcnt vmcnt(0)
  v_cmp_ne_u32 vcc, v125, v126
  s_nop 1
  s_sub_u32 s90, s90, 1
  s_cbranch_scc1 L_back_g
  s_cbranch_vccnz L_spin_g
  s_branch L_back_g
L_slow_m:
  s_mov_b32 s90, 0x8000
L_spin_m:
  s_sleep 2
  buffer_load_dword v126, v10, s[8:11], s61 offen sc1
  s_waitcnt vmcnt(0)
  v_cmp_ne_u32 vcc, v125, v126
  s_nop 1
  s_sub_u32 s90, s90, 1
  s_cbranch_scc1 L_back_m
  s_cbranch_vccnz L_spin_m
  s_branch L_back_m
L_slow_p:
  s_sub_u32 s90, s90, 1
  s_cbranch_scc1 L_done_p
  s_xor_b32 s58, s88, 0x10000
  buffer_load_dwordx4 v[192:195], v1, s[8:11], s58 offen offset:0 sc1
  buffer_load_dwordx4 v[196:199], v1, s[8:11], s58 offen offset:1024 sc1
  buffer_load_dwordx4 v[200:203], v124, s[8:11], s58 offen offset:3072 sc1
  s_xor_b32 s58, s88, 0x30000
  buffer_load_dwordx4 v[216:219], v124, s[8:11], s58 offen offset:0 sc1
  buffer_load_dwordx4 v[220:223], v124, s[8:11], s58 offen offset:1024 sc1
  buffer_load_dwordx4 v[224:227], v124, s[8:11], s58 offen offset:3072 sc1
  s_xor_b32 s58, s88, 0x20000
  buffer_load_dwordx4 v[204:207], v1, s[8:11], s58 offen offset:2048 sc1
  buffer_load_dwordx4 v[208:211], v1, s[8:11], s58 offen offset:3072 sc1
  buffer_load_dwordx4 v[212:215], v124, s[8:11], s58 offen offset:2048 sc1
  s_branch L_back_p
L_a_redo:
  s_waitcnt vmcnt(0) lgkmcnt(0)
  s_mov_b32 s53, 1
  s_barrier
  s_branch L_a_start
L_a_max:
  s_waitcnt lgkmcnt(0)
  s_nop 7
  v_cvt_pk_bf16_f32 v190, v252, v253
  v_cvt_pk_bf16_f32 v191, v254, v255
  s_mov_b32 s58, 0
  v_and_b32 v12, 15, v0
  v_bfe_u32 v13, v0, 4, 2
  v_lshlrev_b32 v12, 8, v12
  v_lshl_add_u32 v12, v13, 4, v12
L_a_max_loop:
  buffer_load_dwordx4 a[128:131], v12, s[12:15], s58 offen offset:0
  buffer_load_dwordx4 a[132:135], v12, s[12:15], s58 offen offset:64
  buffer_load_dwordx4 a[136:139], v12, s[12:15], s58 offen offset:128
  buffer_load_dwordx4 a[140:143], v12, s[12:15], s58 offen offset:192
  s_waitcnt vmcnt(0)
  v_mfma_f32_16x16x32_bf16 v[48:51], a[128:131], v[128:131], 0
  v_mfma_f32_16x16x32_bf16 v[48:51], a[132:135], v[144:147], v[48:51]
  v_mfma_f32_16x16x32_bf16 v[48:51], a[136:139], v[160:163], v[48:51]
  v_mfma_f32_16x16x32_bf16 v[48:51], a[140:143], v[176:179], v[48:51]
  v_mfma_f32_16x16x32_bf16 v[52:55], a[128:131], v[132:135], 0
  v_mfma_f32_16x16x32_bf16 v[52:55], a[132:135], v[148:151], v[52:55]
  v_mfma_f32_16x16x32_bf16 v[52:55], a[136:139], v[164:167], v[52:55]
  v_mfma_f32_16x16x32_bf16 v[52:55], a[140:143], v[180:183], v[52:55]
  v_mfma_f32_16x16x32_bf16 v[56:59], a[128:131], v[136:139], 0
  v_mfma_f32_16x16x32_bf16 v[56:59], a[132:135], v[152:155], v[56:59]
  v_mfma_f32_16x16x32_bf16 v[56:59], a[136:139], v[168:171], v[56:59]
  v_mfma_f32_16x16x32_bf16 v[56:59], a[140:143], v[184:187], v[56:59]
  v_mfma_f32_16x16x32_bf16 v[60:63], a[128:131], v[140:143], 0
  v_mfma_f32_16x16x32_bf16 v[60:63], a[132:135], v[156:159], v[60:63]
  v_mfma_f32_16x16x32_bf16 v[60:63], a[136:139], v[172:175], v[60:63]
  v_mfma_f32_16x16x32_bf16 v[60:63], a[140:143], v[188:191], v[60:63]
  v_max3_f32 v24, v48, v49, v24
  v_max3_f32 v24, v50, v51, v24
  v_max3_f32 v25, v52, v53, v25
  v_max3_f32 v25, v54, v55, v25
  v_max3_f32 v26, v56, v57, v26
  v_max3_f32 v26, v58, v59, v26
  s_nop 1
  v_max3_f32 v27, v60, v61, v27
  v_max3_f32 v27, v62, v63, v27
  s_add_u32 s58, s58, 4096
  s_cmp_lt_u32 s58, 524288
  s_cbranch_scc1 L_a_max_loop
  ds_read_b128 a[128:131], v2 offset:0
  ds_read_b128 a[132:135], v2 offset:64
  ds_read_b128 a[136:139], v2 offset:128
  ds_read_b128 a[140:143], v2 offset:192
  s_waitcnt lgkmcnt(0)
L_a_last:
  s_branch L_a_attn
.section .rodata,"a"
.p2align 6
.amdhsa_kernel recurrent_scan__gqa_block_cached__glu_gated_bilinear__prompt_kernel
  .amdhsa_next_free_vgpr 512
  .amdhsa_next_free_sgpr 102
  .amdhsa_accum_offset 256
  .amdhsa_group_segment_fixed_size 0
  .amdhsa_kernarg_size 96
  .amdhsa_user_sgpr_count 2
  .amdhsa_user_sgpr_kernarg_segment_ptr 1
  .amdhsa_system_sgpr_workgroup_id_x 1
  .amdhsa_float_denorm_mode_32 3
.end_amdhsa_kernel
```
